```python
import torch

def _softmax(x, axis=-1):
    return torch.softmax(x, dim=axis)
def _gelu(x):
    return torch.nn.functional.gelu(x, approximate="tanh")
def _silu(x):
    return torch.nn.functional.silu(x)
def _sigmoid(x):
    return torch.sigmoid(x)
def _layernorm(x, axis=-1, eps=1e-5):
    m = x.mean(dim=axis, keepdim=True)
    v = x.var(dim=axis, keepdim=True, unbiased=False)
    return (x - m) / torch.sqrt(v + eps)
def _scatter_add(tgt, idx, src, axis=0):
    return tgt.clone().index_add_(axis, idx, src)
def _segment_sum(src, seg, n):
    out = torch.zeros((n,) + src.shape[1:], dtype=src.dtype)
    return out.index_add_(0, seg, src)
def _pad(x, pw):
    flat = tuple(v for pair in reversed(pw) for v in pair)
    return torch.nn.functional.pad(x, flat)

kernel_name = 'sequential_preLN__ssm_conv_s4__swiglu_ffn__prompt'

def setup_inputs():

    _w = (lambda a: (lambda t: t.to(torch.bfloat16) if t.is_floating_point() else t)(torch.as_tensor(a)))
    def _A_setup():
        B, L, D, N = 1, 2048, 640, 192
        A_re = -(lambda _x: torch.exp(torch.as_tensor(_x)))((lambda *s: torch.randn(*s, dtype=torch.bfloat16) * 3.2)(D, N))
        A_im = torch.pi * (lambda *s: torch.randn(*s, dtype=torch.bfloat16) * 0.05)(D, N)
        B_re = (lambda *s: torch.randn(*s, dtype=torch.bfloat16) * 0.05)(D, N)
        B_im = (lambda *s: torch.randn(*s, dtype=torch.bfloat16) * 0.05)(D, N)
        C_re = (lambda *s: torch.randn(*s, dtype=torch.bfloat16) * 0.05)(D, N)
        C_im = (lambda *s: torch.randn(*s, dtype=torch.bfloat16) * 0.05)(D, N)
        log_dt = (lambda *s: torch.randn(*s, dtype=torch.bfloat16) * 0.05)(D) * 0.5 - 4.0
        Dskip = (lambda *s: torch.randn(*s, dtype=torch.bfloat16) * 0.05)(D)
        return {
            "u": _w((lambda *s: torch.randn(*s, dtype=torch.bfloat16) * 0.05)(B, L, D)),
            "A_re": _w(A_re),
            "A_im": _w(A_im),
            "B_re": _w(B_re),
            "B_im": _w(B_im),
            "C_re": _w(C_re),
            "C_im": _w(C_im),
            "log_dt": _w(log_dt),
            "Dskip": _w(Dskip),
        }
    _A_in = _A_setup()

    def _B_setup():
        B, S, D, F = 1, 2048, 640, 1536
        return {
            "x": _w((lambda *s: torch.randn(*s, dtype=torch.bfloat16) * 0.05)(B, S, D)),
            "w_gate": _w((lambda *s: torch.randn(*s, dtype=torch.bfloat16) * 0.05)(D, F)),
            "w_up": _w((lambda *s: torch.randn(*s, dtype=torch.bfloat16) * 0.05)(D, F)),
            "w_down": _w((lambda *s: torch.randn(*s, dtype=torch.bfloat16) * 0.05)(F, D)),
        }
    _B_in = _B_setup()

    return {
        "A_u": _A_in["u"],
        "A_A_re": _A_in["A_re"],
        "A_A_im": _A_in["A_im"],
        "A_B_re": _A_in["B_re"],
        "A_B_im": _A_in["B_im"],
        "A_C_re": _A_in["C_re"],
        "A_C_im": _A_in["C_im"],
        "A_log_dt": _A_in["log_dt"],
        "A_Dskip": _A_in["Dskip"],
        "B_x": _B_in["x"],
        "B_w_gate": _B_in["w_gate"],
        "B_w_up": _B_in["w_up"],
        "B_w_down": _B_in["w_down"],
    }

def reference(A_u, A_A_re, A_A_im, A_B_re, A_B_im, A_C_re, A_C_im, A_log_dt, A_Dskip, B_x, B_w_gate, B_w_up, B_w_down):
    def _A_ref(u, A_re, A_im, B_re, B_im, C_re, C_im, log_dt, Dskip):
        Bsz, L, D = u.shape
        dt = torch.exp(log_dt)[:, None]
        A = A_re + 1j * A_im
        Bc = B_re + 1j * B_im
        Cc = C_re + 1j * C_im
        logdA = dt * A
        dB = dt * Bc
        l = (lambda x, dt: x.to(dt))(torch.arange(L), A_re.dtype)
        P = torch.exp(logdA[:, :, None] * l[None, None, :])
        K = torch.einsum("dn,dnl,dn->dl", Cc, P, dB).real
        L2 = 2 * L
        Kp = _pad(K, ((0, 0), (0, L)))
        up = (lambda x, *d: x.permute(*d))(u, 0, 2, 1)
        up = _pad(up, ((0, 0), (0, 0), (0, L)))
        Kf = (lambda x, axes=(-2,-1): torch.fft.rfft2(x.float(), dim=axes))(Kp[:, None, :], axes=(-2, -1))
        Uf = (lambda x, axes=(-2,-1): torch.fft.rfft2(x.float(), dim=axes))(up[:, :, None, :], axes=(-2, -1))
        Yf = Uf * Kf[None, :, :, :]
        y = (lambda x, s, axes=(-2,-1): torch.fft.irfft2(x, s=s, dim=axes).to(torch.bfloat16))(Yf, (1, L2), axes=(-2, -1))[:, :, 0, :L]
        y = (lambda x, *d: x.permute(*d))(y, 0, 2, 1) + u * Dskip[None, None, :]
        return y

    def _B_ref(x, w_gate, w_up, w_down):
        g = _silu(x @ w_gate)
        u = x @ w_up
        return (g * u) @ w_down

    x = A_u
    h = x + _A_ref(_layernorm(x, axis=-1), A_A_re, A_A_im, A_B_re, A_B_im, A_C_re, A_C_im, A_log_dt, A_Dskip)
    h2 = h + _B_ref(_layernorm(h, axis=-1), B_w_gate, B_w_up, B_w_down)
    return h2
```

```asm
; @launch grid=(256,1,1) block=(256,1,1) lds=163840
.amdgcn_target "amdgcn-amd-amdhsa--gfx950"
.text
.p2align 8
.type Lpad,@object
Lpad:
.fill 128, 4, 0
.size Lpad, .-Lpad
.globl sequential_preLN__ssm_conv_s4__swiglu_ffn__prompt_kernel
.p2align 8
.type sequential_preLN__ssm_conv_s4__swiglu_ffn__prompt_kernel,@function
sequential_preLN__ssm_conv_s4__swiglu_ffn__prompt_kernel:
    s_load_dwordx16 s[4:19], s[0:1], 0
    s_load_dwordx16 s[20:35], s[0:1], 64
    s_cmp_lt_u32 s2, 256
    s_cbranch_scc1 Lstart
    s_endpgm
Lstart:
    s_getpc_b64 s[50:51]
Lpc:
    v_and_b32 v2, 15, v0
    s_lshr_b32 s55, s2, 3
    s_lshl_b32 s54, s55, 11
    v_lshl_add_u32 v5, v2, 7, s54
    v_min_u32 v5, Lcode_end-Lpc-4, v5
    v_lshrrev_b32 v6, 6, v0
    global_load_dword v172, v5, s[50:51]
    v_readfirstlane_b32 s45, v6
    v_and_b32 v1, 63, v0
    v_lshlrev_b32 v4, 4, v1
    s_mul_i32 s56, s2, 3
    s_cmp_eq_u32 s45, 3
    s_cselect_b32 s57, 0, s45
    s_cselect_b32 s60, 255, s2
    s_add_u32 s56, s56, s57
    s_min_u32 s58, s56, 639
    s_mul_i32 s59, s58, 384
    v_lshl_add_u32 v6, v1, 1, s59
    s_lshl_b32 s59, s58, 1
    v_mov_b32 v7, s59
    v_mov_b64 v[56:57], 0
    v_mov_b64 v[58:59], 0
    v_mov_b64 v[60:61], 0
    v_mov_b64 v[62:63], 0
    v_mov_b64 v[64:65], 0
    v_mov_b64 v[66:67], 0
    v_mov_b64 v[68:69], 0
    v_mov_b64 v[70:71], 0
    v_mov_b64 v[72:73], 0
    s_lshl2_add_u32 s54, s2, s45
    s_mul_i32 s54, s54, 2560
    s_mul_i32 m0, s45, 2592
    s_add_u32 m0, m0, 148224
    s_waitcnt lgkmcnt(0)
    s_add_u32 s64, s4, s54
    s_addc_u32 s65, s5, 0
    s_load_dword s44, s[34:35], 0
    s_add_u32 s32, s50, Ltab-Lpc+2048
    s_addc_u32 s33, s51, 0
    global_load_lds_dwordx4 v4, s[64:65]
    global_load_lds_dwordx4 v4, s[64:65] offset:1024
    s_mov_b32 exec_hi, 0
    global_load_lds_dwordx4 v4, s[64:65] offset:2048
    s_barrier
    s_mov_b32 exec_hi, -1
    s_cmp_ge_u32 s60, 214
    s_cbranch_scc1 Lother
    global_load_short_d16_hi v56, v6, s[6:7] offset:0
    global_load_short_d16_hi v57, v6, s[8:9] offset:0
    global_load_short_d16_hi v58, v6, s[10:11] offset:0
    global_load_short_d16_hi v59, v6, s[12:13] offset:0
    global_load_short_d16_hi v60, v6, s[14:15] offset:0
    global_load_short_d16_hi v61, v6, s[16:17] offset:0
    global_load_short_d16_hi v62, v6, s[6:7] offset:128
    global_load_short_d16_hi v63, v6, s[8:9] offset:128
    global_load_short_d16_hi v64, v6, s[10:11] offset:128
    global_load_short_d16_hi v65, v6, s[12:13] offset:128
    global_load_short_d16_hi v66, v6, s[14:15] offset:128
    global_load_short_d16_hi v67, v6, s[16:17] offset:128
    global_load_short_d16_hi v68, v6, s[6:7] offset:256
    global_load_short_d16_hi v69, v6, s[8:9] offset:256
    global_load_short_d16_hi v70, v6, s[10:11] offset:256
    global_load_short_d16_hi v71, v6, s[12:13] offset:256
    global_load_short_d16_hi v72, v6, s[14:15] offset:256
    global_load_short_d16_hi v73, v6, s[16:17] offset:256
    global_load_short_d16_hi v74, v7, s[18:19]
    global_load_ushort v75, v7, s[20:21]
    global_load_dwordx4 v[42:45], v4, s[32:33] offset:-2048
    global_load_dwordx4 v[46:49], v4, s[32:33] offset:-1024
    global_load_dwordx4 v[50:53], v4, s[32:33] offset:0
    global_load_dword v54, v4, s[32:33] offset:1024
    global_load_dwordx4 a[120:123], v4, s[32:33] offset:2048
    global_load_dwordx4 a[124:127], v4, s[32:33] offset:3072
    v_lshrrev_b32 v3, 4, v1
    s_mul_i32 s54, s45, 17408
    s_add_u32 m0, s54, 26568
    s_add_u32 s63, s54, 77568
    v_and_b32 v5, 31, v1
    v_mul_u32_u24 v82, 272, v5
    v_lshrrev_b32 v5, 5, v1
    v_lshl_add_u32 v82, v5, 4, v82
    v_add_u32 v82, s63, v82
    v_mov_b32 v78, 1069066811
    v_mov_b32 v79, 0.15915494
    v_mov_b32 v5, 0x3f80
    ds_write_addtid_b32 v5 offset:51000
    s_mov_b32 s36, s34
    s_mov_b32 s37, s35
    s_mov_b32 s38, 268435456
    s_mov_b32 s39, 0x20000
    s_mov_b32 s40, s30
    s_mov_b32 s41, s31
    s_mov_b32 s42, 2621440
    s_mov_b32 s43, 0x20000
    v_mov_b32 v6, 1073741824
    v_mov_b32 v27, 1
    s_and_b32 s54, s2, 7
    s_lshr_b32 s46, s54, 2
    s_lshr_b32 s60, s55, 2
    s_lshl3_add_u32 s46, s46, s60
    s_and_b32 s47, s54, 3
    s_and_b32 s60, s55, 3
    s_lshl2_add_u32 s47, s47, s60
    s_and_b32 s4, s46, 0
    s_xor_b32 s4, s4, s45
    s_lshr_b32 s48, s47, 3
    s_and_b32 s49, s47, 7
    s_and_b32 s16, s55, 15
    s_mul_i32 s16, s16, 1152
    s_add_u32 s16, s16, 262144
    v_cmp_ne_u32 vcc, 0, v1
    s_nop 1
    v_cndmask_b32 v31, 0, v6, vcc
    v_cmp_gt_u32 vcc, 16, v1
    v_mul_u32_u24 v30, 1152, v1
    s_nop 0
    v_cndmask_b32 v30, v6, v30, vcc
    s_lshr_b32 s59, s47, 1
    s_lshl_b32 s59, s59, 7
    s_and_b32 s60, s46, 3
    s_mul_i32 s60, s60, 1152
    s_add_u32 s59, s59, s60
    s_add_u32 s59, s59, 262144
    s_lshl_b32 s60, s45, 8
    s_max_u32 s60, s60, 128
    s_sub_u32 s60, s60, 128
    v_cmp_gt_u32 vcc, 4, v1
    v_lshl_add_u32 v22, v30, 2, s59
    v_lshl_add_u32 v23, v1, 7, s60
    v_cndmask_b32 v22, v6, v22, vcc
    v_cndmask_b32 v39, v6, v30, vcc
    v_cmp_gt_u32 vcc, 3, v1
    s_cmp_eq_u32 s2, 213
    s_cselect_b32 s60, 3, 1
    v_cndmask_b32 v23, v6, v23, vcc
    v_mov_b32 v25, s60
    v_lshlrev_b32 v21, 2, v1
    v_add_u32 v21, 10624, v21
    s_lshl2_add_u32 s59, s47, s45
    s_mul_i32 s59, s59, 61440
    s_add_u32 s59, s59, 4059136
    s_xor_b32 s6, s4, 0
    s_mul_i32 s6, s6, 15360
    s_add_u32 s6, s6, s59
    s_xor_b32 s7, s4, 1
    s_mul_i32 s7, s7, 15360
    s_add_u32 s7, s7, s59
    s_xor_b32 s8, s4, 2
    s_mul_i32 s8, s8, 15360
    s_add_u32 s8, s8, s59
    s_xor_b32 s9, s4, 3
    s_mul_i32 s9, s9, 15360
    s_add_u32 s9, s9, s59
    s_mul_i32 s12, s45, 10240
    s_mul_i32 s11, s46, 163840
    s_add_u32 s11, s11, s12
    s_add_u32 s11, s11, 7991296
    s_mul_i32 s59, s57, 16640
    s_mul_i32 s60, s57, 4608
    v_and_b32 v5, 3, v2
    v_mul_u32_u24 v8, 4160, v5
    v_lshrrev_b32 v5, 2, v2
    v_lshlrev_b32 v6, 1, v3
    v_sub_u32 v5, v5, v6
    v_add_u32 v5, 7, v5
    v_lshl_add_u32 v8, v5, 3, v8
    v_add_u32 v8, s59, v8
    v_lshl_add_u32 v10, v2, 5, s60
    v_lshl_add_u32 v9, v3, 4, v10
    v_add_u32 v9, 49920, v9
    s_lshl_b32 s59, s57, 12
    s_add_u32 s59, s59, 122880
    v_add_u32 v29, s59, v4
    s_mov_b64 exec, 0
    s_cmp_eq_u32 s45, 0
    s_cbranch_scc1 Lwarm0
    s_cmp_eq_u32 s45, 1
    s_cbranch_scc1 Lwarm1
    s_branch Lwarm2
Lwarm_ret:
    s_mov_b64 exec, -1
    s_cmp_ge_u32 s2, 214
    s_cbranch_scc1 Lwarm_reth
    s_waitcnt lgkmcnt(0)
    s_add_u32 s44, s44, 0x9E3779B1
    v_mov_b32 v11, s44
    s_waitcnt vmcnt(26)
    s_barrier
    s_waitcnt vmcnt(7)
    v_and_b32 v74, 0xffff0000, v74
    v_mul_f32 v74, v74, v78
    v_exp_f32 v74, v74
    s_nop 0
    v_cvt_pk_bf16_f32 v80, 0, v74
    v_pk_mul_f32 v[100:101], v[56:57], v[80:81] op_sel_hi:[1,0]
    v_pk_mul_f32 v[58:59], v[58:59], v[80:81] op_sel_hi:[1,0]
    v_pk_mul_f32 v[100:101], v[100:101], v[78:79]
    v_pk_mul_f32 v[102:103], v[60:61], v[58:59] op_sel:[0,0] op_sel_hi:[0,1]
    v_fract_f32 v101, v101
    v_exp_f32 v100, v100
    v_cos_f32 v104, v101
    v_sin_f32 v105, v101
    v_pk_fma_f32 v[102:103], v[60:61], v[58:59], v[102:103] op_sel:[1,1,0] op_sel_hi:[1,0,1] neg_lo:[1,0,0]
    v_pk_mul_f32 v[104:105], v[104:105], v[100:101] op_sel_hi:[1,0]
    v_pk_mul_f32 v[106:107], v[104:105], v[104:105] op_sel:[0,0] op_sel_hi:[0,1]
    v_cvt_pk_bf16_f32 v171, v102, -v103
    v_pk_fma_f32 v[106:107], v[104:105], v[104:105], v[106:107] op_sel:[1,1,0] op_sel_hi:[1,0,1] neg_lo:[1,0,0]
    v_pk_mul_f32 v[126:127], v[102:103], v[104:105] op_sel:[0,0] op_sel_hi:[0,1]
    v_pk_mul_f32 v[108:109], v[106:107], v[106:107] op_sel:[0,0] op_sel_hi:[0,1]
    v_pk_fma_f32 v[126:127], v[102:103], v[104:105], v[126:127] op_sel:[1,1,0] op_sel_hi:[1,0,1] neg_lo:[1,0,0]
    v_pk_fma_f32 v[108:109], v[106:107], v[106:107], v[108:109] op_sel:[1,1,0] op_sel_hi:[1,0,1] neg_lo:[1,0,0]
    v_cvt_pk_bf16_f32 v172, v126, -v127
    v_pk_mul_f32 v[110:111], v[108:109], v[108:109] op_sel:[0,0] op_sel_hi:[0,1]
    v_pk_mul_f32 v[124:125], v[126:127], v[104:105] op_sel:[0,0] op_sel_hi:[0,1]
    v_pk_fma_f32 v[110:111], v[108:109], v[108:109], v[110:111] op_sel:[1,1,0] op_sel_hi:[1,0,1] neg_lo:[1,0,0]
    v_pk_fma_f32 v[124:125], v[126:127], v[104:105], v[124:125] op_sel:[1,1,0] op_sel_hi:[1,0,1] neg_lo:[1,0,0]
    v_pk_mul_f32 v[112:113], v[110:111], v[110:111] op_sel:[0,0] op_sel_hi:[0,1]
    v_cvt_pk_bf16_f32 v173, v124, -v125
    v_pk_fma_f32 v[112:113], v[110:111], v[110:111], v[112:113] op_sel:[1,1,0] op_sel_hi:[1,0,1] neg_lo:[1,0,0]
    v_pk_mul_f32 v[126:127], v[124:125], v[104:105] op_sel:[0,0] op_sel_hi:[0,1]
    v_cvt_pk_bf16_f32 v141, v112, v113
    v_pk_fma_f32 v[126:127], v[124:125], v[104:105], v[126:127] op_sel:[1,1,0] op_sel_hi:[1,0,1] neg_lo:[1,0,0]
    v_pk_mul_f32 v[116:117], v[112:113], v[112:113] op_sel:[0,0] op_sel_hi:[0,1]
    v_cvt_pk_bf16_f32 v174, v126, -v127
    v_pk_fma_f32 v[116:117], v[112:113], v[112:113], v[116:117] op_sel:[1,1,0] op_sel_hi:[1,0,1] neg_lo:[1,0,0]
    v_pk_mul_f32 v[124:125], v[126:127], v[104:105] op_sel:[0,0] op_sel_hi:[0,1]
    v_cvt_pk_bf16_f32 v143, v116, v117
    v_pk_fma_f32 v[124:125], v[126:127], v[104:105], v[124:125] op_sel:[1,1,0] op_sel_hi:[1,0,1] neg_lo:[1,0,0]
    v_pk_mul_f32 v[118:119], v[116:117], v[112:113] op_sel:[0,0] op_sel_hi:[0,1]
    v_cvt_pk_bf16_f32 v175, v124, -v125
    v_pk_fma_f32 v[118:119], v[116:117], v[112:113], v[118:119] op_sel:[1,1,0] op_sel_hi:[1,0,1] neg_lo:[1,0,0]
    v_pk_mul_f32 v[126:127], v[124:125], v[104:105] op_sel:[0,0] op_sel_hi:[0,1]
    v_cvt_pk_bf16_f32 v145, v118, v119
    v_pk_fma_f32 v[126:127], v[124:125], v[104:105], v[126:127] op_sel:[1,1,0] op_sel_hi:[1,0,1] neg_lo:[1,0,0]
    v_pk_mul_f32 v[116:117], v[118:119], v[112:113] op_sel:[0,0] op_sel_hi:[0,1]
    v_cvt_pk_bf16_f32 v176, v126, -v127
    v_pk_fma_f32 v[116:117], v[118:119], v[112:113], v[116:117] op_sel:[1,1,0] op_sel_hi:[1,0,1] neg_lo:[1,0,0]
    v_pk_mul_f32 v[124:125], v[126:127], v[104:105] op_sel:[0,0] op_sel_hi:[0,1]
    v_cvt_pk_bf16_f32 v147, v116, v117
    v_pk_fma_f32 v[124:125], v[126:127], v[104:105], v[124:125] op_sel:[1,1,0] op_sel_hi:[1,0,1] neg_lo:[1,0,0]
    v_pk_mul_f32 v[118:119], v[116:117], v[112:113] op_sel:[0,0] op_sel_hi:[0,1]
    v_cvt_pk_bf16_f32 v177, v124, -v125
    v_pk_fma_f32 v[118:119], v[116:117], v[112:113], v[118:119] op_sel:[1,1,0] op_sel_hi:[1,0,1] neg_lo:[1,0,0]
    v_pk_mul_f32 v[126:127], v[124:125], v[104:105] op_sel:[0,0] op_sel_hi:[0,1]
    v_cvt_pk_bf16_f32 v149, v118, v119
    v_pk_fma_f32 v[126:127], v[124:125], v[104:105], v[126:127] op_sel:[1,1,0] op_sel_hi:[1,0,1] neg_lo:[1,0,0]
    v_pk_mul_f32 v[116:117], v[118:119], v[112:113] op_sel:[0,0] op_sel_hi:[0,1]
    v_cvt_pk_bf16_f32 v178, v126, -v127
    v_pk_fma_f32 v[116:117], v[118:119], v[112:113], v[116:117] op_sel:[1,1,0] op_sel_hi:[1,0,1] neg_lo:[1,0,0]
    v_cvt_pk_bf16_f32 v140, v110, v111
    v_cvt_pk_bf16_f32 v151, v116, v117
    v_pk_mul_f32 v[122:123], v[110:111], v[112:113] op_sel:[0,0] op_sel_hi:[0,1]
    v_pk_mul_f32 v[118:119], v[116:117], v[112:113] op_sel:[0,0] op_sel_hi:[0,1]
    v_pk_fma_f32 v[122:123], v[110:111], v[112:113], v[122:123] op_sel:[1,1,0] op_sel_hi:[1,0,1] neg_lo:[1,0,0]
    v_pk_fma_f32 v[118:119], v[116:117], v[112:113], v[118:119] op_sel:[1,1,0] op_sel_hi:[1,0,1] neg_lo:[1,0,0]
    v_cvt_pk_bf16_f32 v142, v122, v123
    v_cvt_pk_bf16_f32 v153, v118, v119
    v_pk_mul_f32 v[120:121], v[122:123], v[112:113] op_sel:[0,0] op_sel_hi:[0,1]
    v_pk_mul_f32 v[116:117], v[118:119], v[112:113] op_sel:[0,0] op_sel_hi:[0,1]
    v_pk_fma_f32 v[120:121], v[122:123], v[112:113], v[120:121] op_sel:[1,1,0] op_sel_hi:[1,0,1] neg_lo:[1,0,0]
    v_pk_fma_f32 v[116:117], v[118:119], v[112:113], v[116:117] op_sel:[1,1,0] op_sel_hi:[1,0,1] neg_lo:[1,0,0]
    v_cvt_pk_bf16_f32 v144, v120, v121
    v_cvt_pk_bf16_f32 v155, v116, v117
    v_pk_mul_f32 v[122:123], v[120:121], v[112:113] op_sel:[0,0] op_sel_hi:[0,1]
    v_pk_mul_f32 v[114:115], v[116:117], v[116:117] op_sel:[0,0] op_sel_hi:[0,1]
    v_pk_fma_f32 v[122:123], v[120:121], v[112:113], v[122:123] op_sel:[1,1,0] op_sel_hi:[1,0,1] neg_lo:[1,0,0]
    v_pk_fma_f32 v[114:115], v[116:117], v[116:117], v[114:115] op_sel:[1,1,0] op_sel_hi:[1,0,1] neg_lo:[1,0,0]
    v_cvt_pk_bf16_f32 v146, v122, v123
    v_pk_mul_f32 v[130:131], v[102:103], v[114:115] op_sel:[0,0] op_sel_hi:[0,1]
    v_pk_mul_f32 v[120:121], v[122:123], v[112:113] op_sel:[0,0] op_sel_hi:[0,1]
    v_pk_mul_f32 v[118:119], v[116:117], v[112:113] op_sel:[0,0] op_sel_hi:[0,1]
    v_pk_fma_f32 v[130:131], v[102:103], v[114:115], v[130:131] op_sel:[1,1,0] op_sel_hi:[1,0,1] neg_lo:[1,0,0]
    v_pk_fma_f32 v[120:121], v[122:123], v[112:113], v[120:121] op_sel:[1,1,0] op_sel_hi:[1,0,1] neg_lo:[1,0,0]
    v_pk_fma_f32 v[118:119], v[116:117], v[112:113], v[118:119] op_sel:[1,1,0] op_sel_hi:[1,0,1] neg_lo:[1,0,0]
    v_cvt_pk_bf16_f32 v179, v130, -v131
    v_cvt_pk_bf16_f32 v148, v120, v121
    v_cvt_pk_bf16_f32 v157, v118, v119
    v_pk_mul_f32 v[132:133], v[130:131], v[106:107] op_sel:[0,0] op_sel_hi:[0,1]
    v_pk_mul_f32 v[122:123], v[120:121], v[112:113] op_sel:[0,0] op_sel_hi:[0,1]
    v_pk_mul_f32 v[116:117], v[118:119], v[112:113] op_sel:[0,0] op_sel_hi:[0,1]
    v_pk_fma_f32 v[132:133], v[130:131], v[106:107], v[132:133] op_sel:[1,1,0] op_sel_hi:[1,0,1] neg_lo:[1,0,0]
    v_pk_fma_f32 v[122:123], v[120:121], v[112:113], v[122:123] op_sel:[1,1,0] op_sel_hi:[1,0,1] neg_lo:[1,0,0]
    v_pk_fma_f32 v[116:117], v[118:119], v[112:113], v[116:117] op_sel:[1,1,0] op_sel_hi:[1,0,1] neg_lo:[1,0,0]
    v_cvt_pk_bf16_f32 v180, v132, -v133
    v_cvt_pk_bf16_f32 v150, v122, v123
    v_cvt_pk_bf16_f32 v159, v116, v117
    v_pk_mul_f32 v[134:135], v[130:131], v[108:109] op_sel:[0,0] op_sel_hi:[0,1]
    v_pk_mul_f32 v[120:121], v[122:123], v[112:113] op_sel:[0,0] op_sel_hi:[0,1]
    v_pk_mul_f32 v[118:119], v[116:117], v[112:113] op_sel:[0,0] op_sel_hi:[0,1]
    v_pk_fma_f32 v[134:135], v[130:131], v[108:109], v[134:135] op_sel:[1,1,0] op_sel_hi:[1,0,1] neg_lo:[1,0,0]
    v_pk_fma_f32 v[120:121], v[122:123], v[112:113], v[120:121] op_sel:[1,1,0] op_sel_hi:[1,0,1] neg_lo:[1,0,0]
    v_pk_fma_f32 v[118:119], v[116:117], v[112:113], v[118:119] op_sel:[1,1,0] op_sel_hi:[1,0,1] neg_lo:[1,0,0]
    v_cvt_pk_bf16_f32 v181, v134, -v135
    v_cvt_pk_bf16_f32 v152, v120, v121
    v_cvt_pk_bf16_f32 v161, v118, v119
    v_pk_mul_f32 v[136:137], v[132:133], v[108:109] op_sel:[0,0] op_sel_hi:[0,1]
    v_pk_mul_f32 v[122:123], v[120:121], v[112:113] op_sel:[0,0] op_sel_hi:[0,1]
    v_pk_mul_f32 v[116:117], v[118:119], v[112:113] op_sel:[0,0] op_sel_hi:[0,1]
    v_pk_fma_f32 v[136:137], v[132:133], v[108:109], v[136:137] op_sel:[1,1,0] op_sel_hi:[1,0,1] neg_lo:[1,0,0]
    v_pk_fma_f32 v[122:123], v[120:121], v[112:113], v[122:123] op_sel:[1,1,0] op_sel_hi:[1,0,1] neg_lo:[1,0,0]
    v_pk_fma_f32 v[116:117], v[118:119], v[112:113], v[116:117] op_sel:[1,1,0] op_sel_hi:[1,0,1] neg_lo:[1,0,0]
    v_cvt_pk_bf16_f32 v182, v136, -v137
    v_cvt_pk_bf16_f32 v154, v122, v123
    v_cvt_pk_bf16_f32 v163, v116, v117
    v_pk_mul_f32 v[128:129], v[130:131], v[114:115] op_sel:[0,0] op_sel_hi:[0,1]
    v_pk_mul_f32 v[120:121], v[122:123], v[112:113] op_sel:[0,0] op_sel_hi:[0,1]
    v_pk_mul_f32 v[118:119], v[116:117], v[112:113] op_sel:[0,0] op_sel_hi:[0,1]
    v_pk_fma_f32 v[128:129], v[130:131], v[114:115], v[128:129] op_sel:[1,1,0] op_sel_hi:[1,0,1] neg_lo:[1,0,0]
    v_pk_fma_f32 v[120:121], v[122:123], v[112:113], v[120:121] op_sel:[1,1,0] op_sel_hi:[1,0,1] neg_lo:[1,0,0]
    v_pk_fma_f32 v[118:119], v[116:117], v[112:113], v[118:119] op_sel:[1,1,0] op_sel_hi:[1,0,1] neg_lo:[1,0,0]
    v_cvt_pk_bf16_f32 v183, v128, -v129
    v_cvt_pk_bf16_f32 v156, v120, v121
    v_cvt_pk_bf16_f32 v165, v118, v119
Lwarm0:
    s_cbranch_execz Lwarm0_1
    v_pk_mul_f32 v[132:133], v[128:129], v[108:109] op_sel:[0,0] op_sel_hi:[0,1]
    v_pk_mul_f32 v[122:123], v[120:121], v[112:113] op_sel:[0,0] op_sel_hi:[0,1]
    v_pk_mul_f32 v[116:117], v[118:119], v[112:113] op_sel:[0,0] op_sel_hi:[0,1]
    v_pk_fma_f32 v[132:133], v[128:129], v[108:109], v[132:133] op_sel:[1,1,0] op_sel_hi:[1,0,1] neg_lo:[1,0,0]
    v_pk_fma_f32 v[122:123], v[120:121], v[112:113], v[122:123] op_sel:[1,1,0] op_sel_hi:[1,0,1] neg_lo:[1,0,0]
    v_pk_fma_f32 v[116:117], v[118:119], v[112:113], v[116:117] op_sel:[1,1,0] op_sel_hi:[1,0,1] neg_lo:[1,0,0]
    v_cvt_pk_bf16_f32 v184, v132, -v133
    v_cvt_pk_bf16_f32 v158, v122, v123
    v_cvt_pk_bf16_f32 v167, v116, v117
    v_pk_mul_f32 v[130:131], v[128:129], v[114:115] op_sel:[0,0] op_sel_hi:[0,1]
    v_pk_mul_f32 v[120:121], v[122:123], v[112:113] op_sel:[0,0] op_sel_hi:[0,1]
    v_pk_mul_f32 v[118:119], v[116:117], v[112:113] op_sel:[0,0] op_sel_hi:[0,1]
    v_pk_fma_f32 v[130:131], v[128:129], v[114:115], v[130:131] op_sel:[1,1,0] op_sel_hi:[1,0,1] neg_lo:[1,0,0]
    v_pk_fma_f32 v[120:121], v[122:123], v[112:113], v[120:121] op_sel:[1,1,0] op_sel_hi:[1,0,1] neg_lo:[1,0,0]
    v_pk_fma_f32 v[118:119], v[116:117], v[112:113], v[118:119] op_sel:[1,1,0] op_sel_hi:[1,0,1] neg_lo:[1,0,0]
    v_cvt_pk_bf16_f32 v185, v130, -v131
    v_cvt_pk_bf16_f32 v160, v120, v121
    v_cvt_pk_bf16_f32 v169, v118, v119
    v_pk_mul_f32 v[132:133], v[130:131], v[108:109] op_sel:[0,0] op_sel_hi:[0,1]
    v_pk_mul_f32 v[122:123], v[120:121], v[112:113] op_sel:[0,0] op_sel_hi:[0,1]
    v_pk_fma_f32 v[132:133], v[130:131], v[108:109], v[132:133] op_sel:[1,1,0] op_sel_hi:[1,0,1] neg_lo:[1,0,0]
    v_pk_fma_f32 v[122:123], v[120:121], v[112:113], v[122:123] op_sel:[1,1,0] op_sel_hi:[1,0,1] neg_lo:[1,0,0]
    v_cvt_pk_bf16_f32 v186, v132, -v133
    v_cvt_pk_bf16_f32 v162, v122, v123
    v_pk_mul_f32 v[128:129], v[130:131], v[114:115] op_sel:[0,0] op_sel_hi:[0,1]
    v_pk_mul_f32 v[120:121], v[122:123], v[112:113] op_sel:[0,0] op_sel_hi:[0,1]
    v_pk_fma_f32 v[128:129], v[130:131], v[114:115], v[128:129] op_sel:[1,1,0] op_sel_hi:[1,0,1] neg_lo:[1,0,0]
    v_pk_fma_f32 v[120:121], v[122:123], v[112:113], v[120:121] op_sel:[1,1,0] op_sel_hi:[1,0,1] neg_lo:[1,0,0]
    v_cvt_pk_bf16_f32 v187, v128, -v129
    v_cvt_pk_bf16_f32 v164, v120, v121
    v_pk_mul_f32 v[130:131], v[128:129], v[114:115] op_sel:[0,0] op_sel_hi:[0,1]
    v_pk_mul_f32 v[122:123], v[120:121], v[112:113] op_sel:[0,0] op_sel_hi:[0,1]
    v_pk_fma_f32 v[130:131], v[128:129], v[114:115], v[130:131] op_sel:[1,1,0] op_sel_hi:[1,0,1] neg_lo:[1,0,0]
    v_pk_fma_f32 v[122:123], v[120:121], v[112:113], v[122:123] op_sel:[1,1,0] op_sel_hi:[1,0,1] neg_lo:[1,0,0]
    v_cvt_pk_bf16_f32 v188, v130, -v131
    v_cvt_pk_bf16_f32 v166, v122, v123
    v_pk_mul_f32 v[128:129], v[130:131], v[114:115] op_sel:[0,0] op_sel_hi:[0,1]
    v_pk_mul_f32 v[120:121], v[122:123], v[112:113] op_sel:[0,0] op_sel_hi:[0,1]
    v_pk_fma_f32 v[128:129], v[130:131], v[114:115], v[128:129] op_sel:[1,1,0] op_sel_hi:[1,0,1] neg_lo:[1,0,0]
    v_pk_fma_f32 v[120:121], v[122:123], v[112:113], v[120:121] op_sel:[1,1,0] op_sel_hi:[1,0,1] neg_lo:[1,0,0]
    v_cvt_pk_bf16_f32 v189, v128, -v129
    v_cvt_pk_bf16_f32 v168, v120, v121
    v_pk_mul_f32 v[130:131], v[128:129], v[114:115] op_sel:[0,0] op_sel_hi:[0,1]
    v_pk_mul_f32 v[122:123], v[120:121], v[112:113] op_sel:[0,0] op_sel_hi:[0,1]
    v_pk_fma_f32 v[130:131], v[128:129], v[114:115], v[130:131] op_sel:[1,1,0] op_sel_hi:[1,0,1] neg_lo:[1,0,0]
    v_pk_fma_f32 v[122:123], v[120:121], v[112:113], v[122:123] op_sel:[1,1,0] op_sel_hi:[1,0,1] neg_lo:[1,0,0]
    v_cvt_pk_bf16_f32 v190, v130, -v131
    v_cvt_pk_bf16_f32 v170, v122, v123
    v_pk_mul_f32 v[128:129], v[130:131], v[114:115] op_sel:[0,0] op_sel_hi:[0,1]
    v_pk_fma_f32 v[128:129], v[130:131], v[114:115], v[128:129] op_sel:[1,1,0] op_sel_hi:[1,0,1] neg_lo:[1,0,0]
    v_cvt_pk_bf16_f32 v191, v128, -v129
    ds_write_addtid_b32 v171 offset:59704
    ds_write_addtid_b32 v172 offset:59976
    ds_write_addtid_b32 v173 offset:60248
    ds_write_addtid_b32 v141 offset:51544
    ds_write_addtid_b32 v174 offset:60520
    ds_write_addtid_b32 v143 offset:52088
    ds_write_addtid_b32 v175 offset:60792
    ds_write_addtid_b32 v145 offset:52632
    ds_write_addtid_b32 v176 offset:61064
    ds_write_addtid_b32 v147 offset:53176
    ds_write_addtid_b32 v177 offset:61336
    ds_write_addtid_b32 v149 offset:53720
    ds_write_addtid_b32 v178 offset:61608
    ds_write_addtid_b32 v140 offset:51272
    ds_write_addtid_b32 v151 offset:54264
    ds_write_addtid_b32 v142 offset:51816
    ds_write_addtid_b32 v153 offset:54808
    ds_write_addtid_b32 v144 offset:52360
    ds_write_addtid_b32 v155 offset:55352
    ds_write_addtid_b32 v146 offset:52904
    ds_write_addtid_b32 v179 offset:61880
    ds_write_addtid_b32 v148 offset:53448
    ds_write_addtid_b32 v157 offset:55896
    ds_write_addtid_b32 v180 offset:62152
    ds_write_addtid_b32 v150 offset:53992
    ds_write_addtid_b32 v159 offset:56440
    ds_write_addtid_b32 v181 offset:62424
    ds_write_addtid_b32 v152 offset:54536
    ds_write_addtid_b32 v161 offset:56984
    ds_write_addtid_b32 v182 offset:62696
    ds_write_addtid_b32 v154 offset:55080
    ds_write_addtid_b32 v163 offset:57528
    ds_write_addtid_b32 v183 offset:62968
    ds_write_addtid_b32 v156 offset:55624
    ds_write_addtid_b32 v165 offset:58072
    ds_write_addtid_b32 v184 offset:63240
    ds_write_addtid_b32 v158 offset:56168
    ds_write_addtid_b32 v167 offset:58616
    ds_write_addtid_b32 v185 offset:63512
    ds_write_addtid_b32 v160 offset:56712
    ds_write_addtid_b32 v169 offset:59160
    ds_write_addtid_b32 v186 offset:63784
    ds_write_addtid_b32 v162 offset:57256
    ds_write_addtid_b32 v187 offset:64056
    ds_write_addtid_b32 v164 offset:57800
    ds_write_addtid_b32 v188 offset:64328
    ds_write_addtid_b32 v166 offset:58344
    ds_write_addtid_b32 v189 offset:64600
    ds_write_addtid_b32 v168 offset:58888
    ds_write_addtid_b32 v190 offset:64872
    ds_write_addtid_b32 v170 offset:59432
    ds_write_addtid_b32 v191 offset:65144
    ds_read_b128 v[192:195], v82 offset:8704
    ds_read_b128 v[196:199], v82 offset:0
    ds_read_b128 v[200:203], v82 offset:8736
    ds_read_b128 v[204:207], v82 offset:32
    ds_read_b128 v[208:211], v82 offset:8768
    ds_read_b128 v[212:215], v82 offset:64
    ds_read_b128 v[216:219], v82 offset:8800
    ds_read_b128 v[220:223], v82 offset:96
    ds_read_b128 v[224:227], v82 offset:8832
    ds_read_b128 v[228:231], v82 offset:128
    ds_read_b128 v[232:235], v82 offset:8864
    ds_read_b128 v[236:239], v82 offset:160
    ds_read_b128 v[240:243], v82 offset:8896
    ds_read_b128 v[244:247], v82 offset:192
    ds_read_b128 v[248:251], v82 offset:8928
    ds_read_b128 v[252:255], v82 offset:224
    v_pk_mul_f32 v[100:101], v[62:63], v[80:81] op_sel_hi:[1,0]
    v_pk_mul_f32 v[64:65], v[64:65], v[80:81] op_sel_hi:[1,0]
    v_pk_mul_f32 v[100:101], v[100:101], v[78:79]
    v_pk_mul_f32 v[102:103], v[66:67], v[64:65] op_sel:[0,0] op_sel_hi:[0,1]
    v_fract_f32 v101, v101
    v_exp_f32 v100, v100
    v_cos_f32 v104, v101
    v_sin_f32 v105, v101
    v_pk_fma_f32 v[102:103], v[66:67], v[64:65], v[102:103] op_sel:[1,1,0] op_sel_hi:[1,0,1] neg_lo:[1,0,0]
    v_pk_mul_f32 v[104:105], v[104:105], v[100:101] op_sel_hi:[1,0]
    v_pk_mul_f32 v[106:107], v[104:105], v[104:105] op_sel:[0,0] op_sel_hi:[0,1]
    v_cvt_pk_bf16_f32 v171, v102, -v103
    v_pk_fma_f32 v[106:107], v[104:105], v[104:105], v[106:107] op_sel:[1,1,0] op_sel_hi:[1,0,1] neg_lo:[1,0,0]
    v_pk_mul_f32 v[126:127], v[102:103], v[104:105] op_sel:[0,0] op_sel_hi:[0,1]
    v_pk_mul_f32 v[108:109], v[106:107], v[106:107] op_sel:[0,0] op_sel_hi:[0,1]
    v_pk_fma_f32 v[126:127], v[102:103], v[104:105], v[126:127] op_sel:[1,1,0] op_sel_hi:[1,0,1] neg_lo:[1,0,0]
    v_pk_fma_f32 v[108:109], v[106:107], v[106:107], v[108:109] op_sel:[1,1,0] op_sel_hi:[1,0,1] neg_lo:[1,0,0]
    v_cvt_pk_bf16_f32 v172, v126, -v127
    v_pk_mul_f32 v[110:111], v[108:109], v[108:109] op_sel:[0,0] op_sel_hi:[0,1]
    v_pk_mul_f32 v[124:125], v[126:127], v[104:105] op_sel:[0,0] op_sel_hi:[0,1]
    v_pk_fma_f32 v[110:111], v[108:109], v[108:109], v[110:111] op_sel:[1,1,0] op_sel_hi:[1,0,1] neg_lo:[1,0,0]
    v_pk_fma_f32 v[124:125], v[126:127], v[104:105], v[124:125] op_sel:[1,1,0] op_sel_hi:[1,0,1] neg_lo:[1,0,0]
    v_pk_mul_f32 v[112:113], v[110:111], v[110:111] op_sel:[0,0] op_sel_hi:[0,1]
    v_cvt_pk_bf16_f32 v173, v124, -v125
    v_pk_fma_f32 v[112:113], v[110:111], v[110:111], v[112:113] op_sel:[1,1,0] op_sel_hi:[1,0,1] neg_lo:[1,0,0]
    v_pk_mul_f32 v[126:127], v[124:125], v[104:105] op_sel:[0,0] op_sel_hi:[0,1]
    v_cvt_pk_bf16_f32 v141, v112, v113
    v_pk_fma_f32 v[126:127], v[124:125], v[104:105], v[126:127] op_sel:[1,1,0] op_sel_hi:[1,0,1] neg_lo:[1,0,0]
    v_pk_mul_f32 v[116:117], v[112:113], v[112:113] op_sel:[0,0] op_sel_hi:[0,1]
    v_cvt_pk_bf16_f32 v174, v126, -v127
    v_pk_fma_f32 v[116:117], v[112:113], v[112:113], v[116:117] op_sel:[1,1,0] op_sel_hi:[1,0,1] neg_lo:[1,0,0]
    v_pk_mul_f32 v[124:125], v[126:127], v[104:105] op_sel:[0,0] op_sel_hi:[0,1]
    v_cvt_pk_bf16_f32 v143, v116, v117
    v_pk_fma_f32 v[124:125], v[126:127], v[104:105], v[124:125] op_sel:[1,1,0] op_sel_hi:[1,0,1] neg_lo:[1,0,0]
    v_pk_mul_f32 v[118:119], v[116:117], v[112:113] op_sel:[0,0] op_sel_hi:[0,1]
    v_cvt_pk_bf16_f32 v175, v124, -v125
    v_pk_fma_f32 v[118:119], v[116:117], v[112:113], v[118:119] op_sel:[1,1,0] op_sel_hi:[1,0,1] neg_lo:[1,0,0]
    v_pk_mul_f32 v[126:127], v[124:125], v[104:105] op_sel:[0,0] op_sel_hi:[0,1]
    v_cvt_pk_bf16_f32 v145, v118, v119
    v_pk_fma_f32 v[126:127], v[124:125], v[104:105], v[126:127] op_sel:[1,1,0] op_sel_hi:[1,0,1] neg_lo:[1,0,0]
    v_pk_mul_f32 v[116:117], v[118:119], v[112:113] op_sel:[0,0] op_sel_hi:[0,1]
    v_cvt_pk_bf16_f32 v176, v126, -v127
    v_pk_fma_f32 v[116:117], v[118:119], v[112:113], v[116:117] op_sel:[1,1,0] op_sel_hi:[1,0,1] neg_lo:[1,0,0]
    v_pk_mul_f32 v[124:125], v[126:127], v[104:105] op_sel:[0,0] op_sel_hi:[0,1]
    v_cvt_pk_bf16_f32 v147, v116, v117
    v_pk_fma_f32 v[124:125], v[126:127], v[104:105], v[124:125] op_sel:[1,1,0] op_sel_hi:[1,0,1] neg_lo:[1,0,0]
    v_pk_mul_f32 v[118:119], v[116:117], v[112:113] op_sel:[0,0] op_sel_hi:[0,1]
    v_cvt_pk_bf16_f32 v177, v124, -v125
    v_pk_fma_f32 v[118:119], v[116:117], v[112:113], v[118:119] op_sel:[1,1,0] op_sel_hi:[1,0,1] neg_lo:[1,0,0]
    v_pk_mul_f32 v[126:127], v[124:125], v[104:105] op_sel:[0,0] op_sel_hi:[0,1]
    v_cvt_pk_bf16_f32 v149, v118, v119
    v_pk_fma_f32 v[126:127], v[124:125], v[104:105], v[126:127] op_sel:[1,1,0] op_sel_hi:[1,0,1] neg_lo:[1,0,0]
    v_pk_mul_f32 v[116:117], v[118:119], v[112:113] op_sel:[0,0] op_sel_hi:[0,1]
    v_cvt_pk_bf16_f32 v178, v126, -v127
    v_pk_fma_f32 v[116:117], v[118:119], v[112:113], v[116:117] op_sel:[1,1,0] op_sel_hi:[1,0,1] neg_lo:[1,0,0]
    v_cvt_pk_bf16_f32 v140, v110, v111
    v_cvt_pk_bf16_f32 v151, v116, v117
    v_pk_mul_f32 v[122:123], v[110:111], v[112:113] op_sel:[0,0] op_sel_hi:[0,1]
    v_pk_mul_f32 v[118:119], v[116:117], v[112:113] op_sel:[0,0] op_sel_hi:[0,1]
    v_pk_fma_f32 v[122:123], v[110:111], v[112:113], v[122:123] op_sel:[1,1,0] op_sel_hi:[1,0,1] neg_lo:[1,0,0]
    v_pk_fma_f32 v[118:119], v[116:117], v[112:113], v[118:119] op_sel:[1,1,0] op_sel_hi:[1,0,1] neg_lo:[1,0,0]
    v_cvt_pk_bf16_f32 v142, v122, v123
    v_cvt_pk_bf16_f32 v153, v118, v119
    v_pk_mul_f32 v[120:121], v[122:123], v[112:113] op_sel:[0,0] op_sel_hi:[0,1]
    v_pk_mul_f32 v[116:117], v[118:119], v[112:113] op_sel:[0,0] op_sel_hi:[0,1]
    v_pk_fma_f32 v[120:121], v[122:123], v[112:113], v[120:121] op_sel:[1,1,0] op_sel_hi:[1,0,1] neg_lo:[1,0,0]
    v_pk_fma_f32 v[116:117], v[118:119], v[112:113], v[116:117] op_sel:[1,1,0] op_sel_hi:[1,0,1] neg_lo:[1,0,0]
    v_cvt_pk_bf16_f32 v144, v120, v121
    v_cvt_pk_bf16_f32 v155, v116, v117
    v_pk_mul_f32 v[122:123], v[120:121], v[112:113] op_sel:[0,0] op_sel_hi:[0,1]
    v_pk_mul_f32 v[114:115], v[116:117], v[116:117] op_sel:[0,0] op_sel_hi:[0,1]
    v_pk_fma_f32 v[122:123], v[120:121], v[112:113], v[122:123] op_sel:[1,1,0] op_sel_hi:[1,0,1] neg_lo:[1,0,0]
    v_pk_fma_f32 v[114:115], v[116:117], v[116:117], v[114:115] op_sel:[1,1,0] op_sel_hi:[1,0,1] neg_lo:[1,0,0]
    v_cvt_pk_bf16_f32 v146, v122, v123
    v_pk_mul_f32 v[130:131], v[102:103], v[114:115] op_sel:[0,0] op_sel_hi:[0,1]
    v_pk_mul_f32 v[120:121], v[122:123], v[112:113] op_sel:[0,0] op_sel_hi:[0,1]
    v_pk_mul_f32 v[118:119], v[116:117], v[112:113] op_sel:[0,0] op_sel_hi:[0,1]
    v_pk_fma_f32 v[130:131], v[102:103], v[114:115], v[130:131] op_sel:[1,1,0] op_sel_hi:[1,0,1] neg_lo:[1,0,0]
    v_pk_fma_f32 v[120:121], v[122:123], v[112:113], v[120:121] op_sel:[1,1,0] op_sel_hi:[1,0,1] neg_lo:[1,0,0]
    v_pk_fma_f32 v[118:119], v[116:117], v[112:113], v[118:119] op_sel:[1,1,0] op_sel_hi:[1,0,1] neg_lo:[1,0,0]
    v_cvt_pk_bf16_f32 v179, v130, -v131
    v_cvt_pk_bf16_f32 v148, v120, v121
    v_cvt_pk_bf16_f32 v157, v118, v119
    v_pk_mul_f32 v[132:133], v[130:131], v[106:107] op_sel:[0,0] op_sel_hi:[0,1]
    v_pk_mul_f32 v[122:123], v[120:121], v[112:113] op_sel:[0,0] op_sel_hi:[0,1]
    v_pk_mul_f32 v[116:117], v[118:119], v[112:113] op_sel:[0,0] op_sel_hi:[0,1]
    v_pk_fma_f32 v[132:133], v[130:131], v[106:107], v[132:133] op_sel:[1,1,0] op_sel_hi:[1,0,1] neg_lo:[1,0,0]
    v_pk_fma_f32 v[122:123], v[120:121], v[112:113], v[122:123] op_sel:[1,1,0] op_sel_hi:[1,0,1] neg_lo:[1,0,0]
    v_pk_fma_f32 v[116:117], v[118:119], v[112:113], v[116:117] op_sel:[1,1,0] op_sel_hi:[1,0,1] neg_lo:[1,0,0]
    v_cvt_pk_bf16_f32 v180, v132, -v133
    v_cvt_pk_bf16_f32 v150, v122, v123
    v_cvt_pk_bf16_f32 v159, v116, v117
    v_pk_mul_f32 v[134:135], v[130:131], v[108:109] op_sel:[0,0] op_sel_hi:[0,1]
    v_pk_mul_f32 v[120:121], v[122:123], v[112:113] op_sel:[0,0] op_sel_hi:[0,1]
    v_pk_mul_f32 v[118:119], v[116:117], v[112:113] op_sel:[0,0] op_sel_hi:[0,1]
    v_pk_fma_f32 v[134:135], v[130:131], v[108:109], v[134:135] op_sel:[1,1,0] op_sel_hi:[1,0,1] neg_lo:[1,0,0]
    v_pk_fma_f32 v[120:121], v[122:123], v[112:113], v[120:121] op_sel:[1,1,0] op_sel_hi:[1,0,1] neg_lo:[1,0,0]
    v_pk_fma_f32 v[118:119], v[116:117], v[112:113], v[118:119] op_sel:[1,1,0] op_sel_hi:[1,0,1] neg_lo:[1,0,0]
    v_cvt_pk_bf16_f32 v181, v134, -v135
    v_cvt_pk_bf16_f32 v152, v120, v121
    v_cvt_pk_bf16_f32 v161, v118, v119
    v_pk_mul_f32 v[136:137], v[132:133], v[108:109] op_sel:[0,0] op_sel_hi:[0,1]
    v_pk_mul_f32 v[122:123], v[120:121], v[112:113] op_sel:[0,0] op_sel_hi:[0,1]
    v_pk_mul_f32 v[116:117], v[118:119], v[112:113] op_sel:[0,0] op_sel_hi:[0,1]
    v_pk_fma_f32 v[136:137], v[132:133], v[108:109], v[136:137] op_sel:[1,1,0] op_sel_hi:[1,0,1] neg_lo:[1,0,0]
    v_pk_fma_f32 v[122:123], v[120:121], v[112:113], v[122:123] op_sel:[1,1,0] op_sel_hi:[1,0,1] neg_lo:[1,0,0]
    v_pk_fma_f32 v[116:117], v[118:119], v[112:113], v[116:117] op_sel:[1,1,0] op_sel_hi:[1,0,1] neg_lo:[1,0,0]
    v_cvt_pk_bf16_f32 v182, v136, -v137
    v_cvt_pk_bf16_f32 v154, v122, v123
    v_cvt_pk_bf16_f32 v163, v116, v117
    v_pk_mul_f32 v[128:129], v[130:131], v[114:115] op_sel:[0,0] op_sel_hi:[0,1]
    v_pk_mul_f32 v[120:121], v[122:123], v[112:113] op_sel:[0,0] op_sel_hi:[0,1]
    v_pk_mul_f32 v[118:119], v[116:117], v[112:113] op_sel:[0,0] op_sel_hi:[0,1]
    v_pk_fma_f32 v[128:129], v[130:131], v[114:115], v[128:129] op_sel:[1,1,0] op_sel_hi:[1,0,1] neg_lo:[1,0,0]
    v_pk_fma_f32 v[120:121], v[122:123], v[112:113], v[120:121] op_sel:[1,1,0] op_sel_hi:[1,0,1] neg_lo:[1,0,0]
    v_pk_fma_f32 v[118:119], v[116:117], v[112:113], v[118:119] op_sel:[1,1,0] op_sel_hi:[1,0,1] neg_lo:[1,0,0]
    v_cvt_pk_bf16_f32 v183, v128, -v129
    v_cvt_pk_bf16_f32 v156, v120, v121
    v_cvt_pk_bf16_f32 v165, v118, v119
    v_pk_mul_f32 v[132:133], v[128:129], v[108:109] op_sel:[0,0] op_sel_hi:[0,1]
    v_pk_mul_f32 v[122:123], v[120:121], v[112:113] op_sel:[0,0] op_sel_hi:[0,1]
    v_pk_mul_f32 v[116:117], v[118:119], v[112:113] op_sel:[0,0] op_sel_hi:[0,1]
    v_pk_fma_f32 v[132:133], v[128:129], v[108:109], v[132:133] op_sel:[1,1,0] op_sel_hi:[1,0,1] neg_lo:[1,0,0]
    v_pk_fma_f32 v[122:123], v[120:121], v[112:113], v[122:123] op_sel:[1,1,0] op_sel_hi:[1,0,1] neg_lo:[1,0,0]
    v_pk_fma_f32 v[116:117], v[118:119], v[112:113], v[116:117] op_sel:[1,1,0] op_sel_hi:[1,0,1] neg_lo:[1,0,0]
    v_cvt_pk_bf16_f32 v184, v132, -v133
    v_cvt_pk_bf16_f32 v158, v122, v123
    v_cvt_pk_bf16_f32 v167, v116, v117
    v_pk_mul_f32 v[130:131], v[128:129], v[114:115] op_sel:[0,0] op_sel_hi:[0,1]
    v_pk_mul_f32 v[120:121], v[122:123], v[112:113] op_sel:[0,0] op_sel_hi:[0,1]
    v_pk_mul_f32 v[118:119], v[116:117], v[112:113] op_sel:[0,0] op_sel_hi:[0,1]
    v_pk_fma_f32 v[130:131], v[128:129], v[114:115], v[130:131] op_sel:[1,1,0] op_sel_hi:[1,0,1] neg_lo:[1,0,0]
    v_pk_fma_f32 v[120:121], v[122:123], v[112:113], v[120:121] op_sel:[1,1,0] op_sel_hi:[1,0,1] neg_lo:[1,0,0]
    v_pk_fma_f32 v[118:119], v[116:117], v[112:113], v[118:119] op_sel:[1,1,0] op_sel_hi:[1,0,1] neg_lo:[1,0,0]
    v_cvt_pk_bf16_f32 v185, v130, -v131
    v_cvt_pk_bf16_f32 v160, v120, v121
    v_cvt_pk_bf16_f32 v169, v118, v119
    v_pk_mul_f32 v[132:133], v[130:131], v[108:109] op_sel:[0,0] op_sel_hi:[0,1]
    v_pk_mul_f32 v[122:123], v[120:121], v[112:113] op_sel:[0,0] op_sel_hi:[0,1]
Lwarm1:
    s_cbranch_execz Lwarm1_1
    v_pk_fma_f32 v[132:133], v[130:131], v[108:109], v[132:133] op_sel:[1,1,0] op_sel_hi:[1,0,1] neg_lo:[1,0,0]
    v_pk_fma_f32 v[122:123], v[120:121], v[112:113], v[122:123] op_sel:[1,1,0] op_sel_hi:[1,0,1] neg_lo:[1,0,0]
    v_cvt_pk_bf16_f32 v186, v132, -v133
    v_cvt_pk_bf16_f32 v162, v122, v123
    v_pk_mul_f32 v[128:129], v[130:131], v[114:115] op_sel:[0,0] op_sel_hi:[0,1]
    v_pk_mul_f32 v[120:121], v[122:123], v[112:113] op_sel:[0,0] op_sel_hi:[0,1]
    v_pk_fma_f32 v[128:129], v[130:131], v[114:115], v[128:129] op_sel:[1,1,0] op_sel_hi:[1,0,1] neg_lo:[1,0,0]
    v_pk_fma_f32 v[120:121], v[122:123], v[112:113], v[120:121] op_sel:[1,1,0] op_sel_hi:[1,0,1] neg_lo:[1,0,0]
    v_cvt_pk_bf16_f32 v187, v128, -v129
    v_cvt_pk_bf16_f32 v164, v120, v121
    v_pk_mul_f32 v[130:131], v[128:129], v[114:115] op_sel:[0,0] op_sel_hi:[0,1]
    v_pk_mul_f32 v[122:123], v[120:121], v[112:113] op_sel:[0,0] op_sel_hi:[0,1]
    v_pk_fma_f32 v[130:131], v[128:129], v[114:115], v[130:131] op_sel:[1,1,0] op_sel_hi:[1,0,1] neg_lo:[1,0,0]
    v_pk_fma_f32 v[122:123], v[120:121], v[112:113], v[122:123] op_sel:[1,1,0] op_sel_hi:[1,0,1] neg_lo:[1,0,0]
    v_cvt_pk_bf16_f32 v188, v130, -v131
    v_cvt_pk_bf16_f32 v166, v122, v123
    v_pk_mul_f32 v[128:129], v[130:131], v[114:115] op_sel:[0,0] op_sel_hi:[0,1]
    v_pk_mul_f32 v[120:121], v[122:123], v[112:113] op_sel:[0,0] op_sel_hi:[0,1]
    v_pk_fma_f32 v[128:129], v[130:131], v[114:115], v[128:129] op_sel:[1,1,0] op_sel_hi:[1,0,1] neg_lo:[1,0,0]
    v_pk_fma_f32 v[120:121], v[122:123], v[112:113], v[120:121] op_sel:[1,1,0] op_sel_hi:[1,0,1] neg_lo:[1,0,0]
    v_cvt_pk_bf16_f32 v189, v128, -v129
    v_cvt_pk_bf16_f32 v168, v120, v121
    v_pk_mul_f32 v[130:131], v[128:129], v[114:115] op_sel:[0,0] op_sel_hi:[0,1]
    v_pk_mul_f32 v[122:123], v[120:121], v[112:113] op_sel:[0,0] op_sel_hi:[0,1]
    v_pk_fma_f32 v[130:131], v[128:129], v[114:115], v[130:131] op_sel:[1,1,0] op_sel_hi:[1,0,1] neg_lo:[1,0,0]
    v_pk_fma_f32 v[122:123], v[120:121], v[112:113], v[122:123] op_sel:[1,1,0] op_sel_hi:[1,0,1] neg_lo:[1,0,0]
    v_cvt_pk_bf16_f32 v190, v130, -v131
    v_cvt_pk_bf16_f32 v170, v122, v123
    v_pk_mul_f32 v[128:129], v[130:131], v[114:115] op_sel:[0,0] op_sel_hi:[0,1]
    v_pk_fma_f32 v[128:129], v[130:131], v[114:115], v[128:129] op_sel:[1,1,0] op_sel_hi:[1,0,1] neg_lo:[1,0,0]
    v_cvt_pk_bf16_f32 v191, v128, -v129
    s_waitcnt lgkmcnt(14)
    v_mfma_f32_32x32x16_bf16 v[84:99], v[192:195], v[196:199], 0
    s_waitcnt lgkmcnt(12)
    ds_write_addtid_b32 v171 offset:59704
    ds_write_addtid_b32 v172 offset:59976
    ds_write_addtid_b32 v173 offset:60248
    ds_write_addtid_b32 v141 offset:51544
    ds_write_addtid_b32 v174 offset:60520
    ds_write_addtid_b32 v143 offset:52088
    ds_write_addtid_b32 v175 offset:60792
    v_mfma_f32_32x32x16_bf16 v[84:99], v[200:203], v[204:207], v[84:99]
    s_waitcnt lgkmcnt(15)
    ds_write_addtid_b32 v145 offset:52632
    ds_write_addtid_b32 v176 offset:61064
    ds_write_addtid_b32 v147 offset:53176
    ds_write_addtid_b32 v177 offset:61336
    ds_write_addtid_b32 v149 offset:53720
    ds_write_addtid_b32 v178 offset:61608
    ds_write_addtid_b32 v140 offset:51272
    v_mfma_f32_32x32x16_bf16 v[84:99], v[208:211], v[212:215], v[84:99]
    ds_write_addtid_b32 v151 offset:54264
    ds_write_addtid_b32 v142 offset:51816
    ds_write_addtid_b32 v153 offset:54808
    ds_write_addtid_b32 v144 offset:52360
    ds_write_addtid_b32 v155 offset:55352
    ds_write_addtid_b32 v146 offset:52904
    ds_write_addtid_b32 v179 offset:61880
    v_mfma_f32_32x32x16_bf16 v[84:99], v[216:219], v[220:223], v[84:99]
    s_waitcnt lgkmcnt(15)
    ds_write_addtid_b32 v148 offset:53448
    ds_write_addtid_b32 v157 offset:55896
    ds_write_addtid_b32 v180 offset:62152
    ds_write_addtid_b32 v150 offset:53992
    ds_write_addtid_b32 v159 offset:56440
    ds_write_addtid_b32 v181 offset:62424
    ds_write_addtid_b32 v152 offset:54536
    v_mfma_f32_32x32x16_bf16 v[84:99], v[224:227], v[228:231], v[84:99]
    ds_write_addtid_b32 v161 offset:56984
    ds_write_addtid_b32 v182 offset:62696
    ds_write_addtid_b32 v154 offset:55080
    ds_write_addtid_b32 v163 offset:57528
    ds_write_addtid_b32 v183 offset:62968
    ds_write_addtid_b32 v156 offset:55624
    v_mfma_f32_32x32x16_bf16 v[84:99], v[232:235], v[236:239], v[84:99]
    ds_write_addtid_b32 v165 offset:58072
    ds_write_addtid_b32 v184 offset:63240
    ds_write_addtid_b32 v158 offset:56168
    ds_write_addtid_b32 v167 offset:58616
    ds_write_addtid_b32 v185 offset:63512
    ds_write_addtid_b32 v160 offset:56712
    v_mfma_f32_32x32x16_bf16 v[84:99], v[240:243], v[244:247], v[84:99]
    ds_write_addtid_b32 v169 offset:59160
    ds_write_addtid_b32 v186 offset:63784
    ds_write_addtid_b32 v162 offset:57256
    ds_write_addtid_b32 v187 offset:64056
    ds_write_addtid_b32 v164 offset:57800
    ds_write_addtid_b32 v188 offset:64328
    v_mfma_f32_32x32x16_bf16 v[84:99], v[248:251], v[252:255], v[84:99]
    ds_write_addtid_b32 v166 offset:58344
    ds_write_addtid_b32 v189 offset:64600
    ds_write_addtid_b32 v168 offset:58888
    ds_write_addtid_b32 v190 offset:64872
    ds_write_addtid_b32 v170 offset:59432
    ds_write_addtid_b32 v191 offset:65144
    ds_read_b128 v[192:195], v82 offset:8704
    ds_read_b128 v[196:199], v82 offset:0
    ds_read_b128 v[200:203], v82 offset:8736
    ds_read_b128 v[204:207], v82 offset:32
    ds_read_b128 v[208:211], v82 offset:8768
    ds_read_b128 v[212:215], v82 offset:64
    ds_read_b128 v[216:219], v82 offset:8800
    ds_read_b128 v[220:223], v82 offset:96
    ds_read_b128 v[224:227], v82 offset:8832
    ds_read_b128 v[228:231], v82 offset:128
    ds_read_b128 v[232:235], v82 offset:8864
    ds_read_b128 v[236:239], v82 offset:160
    ds_read_b128 v[240:243], v82 offset:8896
    ds_read_b128 v[244:247], v82 offset:192
    ds_read_b128 v[248:251], v82 offset:8928
    ds_read_b128 v[252:255], v82 offset:224
    v_pk_mul_f32 v[100:101], v[68:69], v[80:81] op_sel_hi:[1,0]
    v_pk_mul_f32 v[70:71], v[70:71], v[80:81] op_sel_hi:[1,0]
    v_pk_mul_f32 v[100:101], v[100:101], v[78:79]
    v_pk_mul_f32 v[102:103], v[72:73], v[70:71] op_sel:[0,0] op_sel_hi:[0,1]
    v_fract_f32 v101, v101
    v_exp_f32 v100, v100
    v_cos_f32 v104, v101
    v_sin_f32 v105, v101
    v_pk_fma_f32 v[102:103], v[72:73], v[70:71], v[102:103] op_sel:[1,1,0] op_sel_hi:[1,0,1] neg_lo:[1,0,0]
    v_pk_mul_f32 v[104:105], v[104:105], v[100:101] op_sel_hi:[1,0]
    v_pk_mul_f32 v[106:107], v[104:105], v[104:105] op_sel:[0,0] op_sel_hi:[0,1]
    v_cvt_pk_bf16_f32 v171, v102, -v103
    v_pk_fma_f32 v[106:107], v[104:105], v[104:105], v[106:107] op_sel:[1,1,0] op_sel_hi:[1,0,1] neg_lo:[1,0,0]
    v_pk_mul_f32 v[126:127], v[102:103], v[104:105] op_sel:[0,0] op_sel_hi:[0,1]
    v_pk_mul_f32 v[108:109], v[106:107], v[106:107] op_sel:[0,0] op_sel_hi:[0,1]
    v_pk_fma_f32 v[126:127], v[102:103], v[104:105], v[126:127] op_sel:[1,1,0] op_sel_hi:[1,0,1] neg_lo:[1,0,0]
    v_pk_fma_f32 v[108:109], v[106:107], v[106:107], v[108:109] op_sel:[1,1,0] op_sel_hi:[1,0,1] neg_lo:[1,0,0]
    v_cvt_pk_bf16_f32 v172, v126, -v127
    v_pk_mul_f32 v[110:111], v[108:109], v[108:109] op_sel:[0,0] op_sel_hi:[0,1]
    v_pk_mul_f32 v[124:125], v[126:127], v[104:105] op_sel:[0,0] op_sel_hi:[0,1]
    v_pk_fma_f32 v[110:111], v[108:109], v[108:109], v[110:111] op_sel:[1,1,0] op_sel_hi:[1,0,1] neg_lo:[1,0,0]
    v_pk_fma_f32 v[124:125], v[126:127], v[104:105], v[124:125] op_sel:[1,1,0] op_sel_hi:[1,0,1] neg_lo:[1,0,0]
    v_pk_mul_f32 v[112:113], v[110:111], v[110:111] op_sel:[0,0] op_sel_hi:[0,1]
    v_cvt_pk_bf16_f32 v173, v124, -v125
    v_pk_fma_f32 v[112:113], v[110:111], v[110:111], v[112:113] op_sel:[1,1,0] op_sel_hi:[1,0,1] neg_lo:[1,0,0]
    v_pk_mul_f32 v[126:127], v[124:125], v[104:105] op_sel:[0,0] op_sel_hi:[0,1]
    v_cvt_pk_bf16_f32 v141, v112, v113
    v_pk_fma_f32 v[126:127], v[124:125], v[104:105], v[126:127] op_sel:[1,1,0] op_sel_hi:[1,0,1] neg_lo:[1,0,0]
    v_pk_mul_f32 v[116:117], v[112:113], v[112:113] op_sel:[0,0] op_sel_hi:[0,1]
    v_cvt_pk_bf16_f32 v174, v126, -v127
    v_pk_fma_f32 v[116:117], v[112:113], v[112:113], v[116:117] op_sel:[1,1,0] op_sel_hi:[1,0,1] neg_lo:[1,0,0]
    v_pk_mul_f32 v[124:125], v[126:127], v[104:105] op_sel:[0,0] op_sel_hi:[0,1]
    v_cvt_pk_bf16_f32 v143, v116, v117
    v_pk_fma_f32 v[124:125], v[126:127], v[104:105], v[124:125] op_sel:[1,1,0] op_sel_hi:[1,0,1] neg_lo:[1,0,0]
    v_pk_mul_f32 v[118:119], v[116:117], v[112:113] op_sel:[0,0] op_sel_hi:[0,1]
    v_cvt_pk_bf16_f32 v175, v124, -v125
    v_pk_fma_f32 v[118:119], v[116:117], v[112:113], v[118:119] op_sel:[1,1,0] op_sel_hi:[1,0,1] neg_lo:[1,0,0]
    v_pk_mul_f32 v[126:127], v[124:125], v[104:105] op_sel:[0,0] op_sel_hi:[0,1]
    v_cvt_pk_bf16_f32 v145, v118, v119
    v_pk_fma_f32 v[126:127], v[124:125], v[104:105], v[126:127] op_sel:[1,1,0] op_sel_hi:[1,0,1] neg_lo:[1,0,0]
    v_pk_mul_f32 v[116:117], v[118:119], v[112:113] op_sel:[0,0] op_sel_hi:[0,1]
    v_cvt_pk_bf16_f32 v176, v126, -v127
    v_pk_fma_f32 v[116:117], v[118:119], v[112:113], v[116:117] op_sel:[1,1,0] op_sel_hi:[1,0,1] neg_lo:[1,0,0]
    v_pk_mul_f32 v[124:125], v[126:127], v[104:105] op_sel:[0,0] op_sel_hi:[0,1]
    v_cvt_pk_bf16_f32 v147, v116, v117
    v_pk_fma_f32 v[124:125], v[126:127], v[104:105], v[124:125] op_sel:[1,1,0] op_sel_hi:[1,0,1] neg_lo:[1,0,0]
    v_pk_mul_f32 v[118:119], v[116:117], v[112:113] op_sel:[0,0] op_sel_hi:[0,1]
    v_cvt_pk_bf16_f32 v177, v124, -v125
    v_pk_fma_f32 v[118:119], v[116:117], v[112:113], v[118:119] op_sel:[1,1,0] op_sel_hi:[1,0,1] neg_lo:[1,0,0]
    v_pk_mul_f32 v[126:127], v[124:125], v[104:105] op_sel:[0,0] op_sel_hi:[0,1]
    v_cvt_pk_bf16_f32 v149, v118, v119
    v_pk_fma_f32 v[126:127], v[124:125], v[104:105], v[126:127] op_sel:[1,1,0] op_sel_hi:[1,0,1] neg_lo:[1,0,0]
    v_pk_mul_f32 v[116:117], v[118:119], v[112:113] op_sel:[0,0] op_sel_hi:[0,1]
    v_cvt_pk_bf16_f32 v178, v126, -v127
    v_pk_fma_f32 v[116:117], v[118:119], v[112:113], v[116:117] op_sel:[1,1,0] op_sel_hi:[1,0,1] neg_lo:[1,0,0]
    v_cvt_pk_bf16_f32 v140, v110, v111
    v_cvt_pk_bf16_f32 v151, v116, v117
    v_pk_mul_f32 v[122:123], v[110:111], v[112:113] op_sel:[0,0] op_sel_hi:[0,1]
    v_pk_mul_f32 v[118:119], v[116:117], v[112:113] op_sel:[0,0] op_sel_hi:[0,1]
    v_pk_fma_f32 v[122:123], v[110:111], v[112:113], v[122:123] op_sel:[1,1,0] op_sel_hi:[1,0,1] neg_lo:[1,0,0]
    v_pk_fma_f32 v[118:119], v[116:117], v[112:113], v[118:119] op_sel:[1,1,0] op_sel_hi:[1,0,1] neg_lo:[1,0,0]
    v_cvt_pk_bf16_f32 v142, v122, v123
    v_cvt_pk_bf16_f32 v153, v118, v119
    v_pk_mul_f32 v[120:121], v[122:123], v[112:113] op_sel:[0,0] op_sel_hi:[0,1]
    v_pk_mul_f32 v[116:117], v[118:119], v[112:113] op_sel:[0,0] op_sel_hi:[0,1]
    v_pk_fma_f32 v[120:121], v[122:123], v[112:113], v[120:121] op_sel:[1,1,0] op_sel_hi:[1,0,1] neg_lo:[1,0,0]
    v_pk_fma_f32 v[116:117], v[118:119], v[112:113], v[116:117] op_sel:[1,1,0] op_sel_hi:[1,0,1] neg_lo:[1,0,0]
    v_cvt_pk_bf16_f32 v144, v120, v121
    v_cvt_pk_bf16_f32 v155, v116, v117
    v_pk_mul_f32 v[122:123], v[120:121], v[112:113] op_sel:[0,0] op_sel_hi:[0,1]
    v_pk_mul_f32 v[114:115], v[116:117], v[116:117] op_sel:[0,0] op_sel_hi:[0,1]
    v_pk_fma_f32 v[122:123], v[120:121], v[112:113], v[122:123] op_sel:[1,1,0] op_sel_hi:[1,0,1] neg_lo:[1,0,0]
    v_pk_fma_f32 v[114:115], v[116:117], v[116:117], v[114:115] op_sel:[1,1,0] op_sel_hi:[1,0,1] neg_lo:[1,0,0]
    v_cvt_pk_bf16_f32 v146, v122, v123
    v_pk_mul_f32 v[130:131], v[102:103], v[114:115] op_sel:[0,0] op_sel_hi:[0,1]
    v_pk_mul_f32 v[120:121], v[122:123], v[112:113] op_sel:[0,0] op_sel_hi:[0,1]
    v_pk_mul_f32 v[118:119], v[116:117], v[112:113] op_sel:[0,0] op_sel_hi:[0,1]
    v_pk_fma_f32 v[130:131], v[102:103], v[114:115], v[130:131] op_sel:[1,1,0] op_sel_hi:[1,0,1] neg_lo:[1,0,0]
    v_pk_fma_f32 v[120:121], v[122:123], v[112:113], v[120:121] op_sel:[1,1,0] op_sel_hi:[1,0,1] neg_lo:[1,0,0]
    v_pk_fma_f32 v[118:119], v[116:117], v[112:113], v[118:119] op_sel:[1,1,0] op_sel_hi:[1,0,1] neg_lo:[1,0,0]
    v_cvt_pk_bf16_f32 v179, v130, -v131
    v_cvt_pk_bf16_f32 v148, v120, v121
    v_cvt_pk_bf16_f32 v157, v118, v119
    v_pk_mul_f32 v[132:133], v[130:131], v[106:107] op_sel:[0,0] op_sel_hi:[0,1]
    v_pk_mul_f32 v[122:123], v[120:121], v[112:113] op_sel:[0,0] op_sel_hi:[0,1]
    v_pk_mul_f32 v[116:117], v[118:119], v[112:113] op_sel:[0,0] op_sel_hi:[0,1]
    v_pk_fma_f32 v[132:133], v[130:131], v[106:107], v[132:133] op_sel:[1,1,0] op_sel_hi:[1,0,1] neg_lo:[1,0,0]
    v_pk_fma_f32 v[122:123], v[120:121], v[112:113], v[122:123] op_sel:[1,1,0] op_sel_hi:[1,0,1] neg_lo:[1,0,0]
    v_pk_fma_f32 v[116:117], v[118:119], v[112:113], v[116:117] op_sel:[1,1,0] op_sel_hi:[1,0,1] neg_lo:[1,0,0]
    v_cvt_pk_bf16_f32 v180, v132, -v133
    v_cvt_pk_bf16_f32 v150, v122, v123
    v_cvt_pk_bf16_f32 v159, v116, v117
    v_pk_mul_f32 v[134:135], v[130:131], v[108:109] op_sel:[0,0] op_sel_hi:[0,1]
    v_pk_mul_f32 v[120:121], v[122:123], v[112:113] op_sel:[0,0] op_sel_hi:[0,1]
    v_pk_mul_f32 v[118:119], v[116:117], v[112:113] op_sel:[0,0] op_sel_hi:[0,1]
    v_pk_fma_f32 v[134:135], v[130:131], v[108:109], v[134:135] op_sel:[1,1,0] op_sel_hi:[1,0,1] neg_lo:[1,0,0]
    v_pk_fma_f32 v[120:121], v[122:123], v[112:113], v[120:121] op_sel:[1,1,0] op_sel_hi:[1,0,1] neg_lo:[1,0,0]
    v_pk_fma_f32 v[118:119], v[116:117], v[112:113], v[118:119] op_sel:[1,1,0] op_sel_hi:[1,0,1] neg_lo:[1,0,0]
    v_cvt_pk_bf16_f32 v181, v134, -v135
    v_cvt_pk_bf16_f32 v152, v120, v121
    v_cvt_pk_bf16_f32 v161, v118, v119
    v_pk_mul_f32 v[136:137], v[132:133], v[108:109] op_sel:[0,0] op_sel_hi:[0,1]
    v_pk_mul_f32 v[122:123], v[120:121], v[112:113] op_sel:[0,0] op_sel_hi:[0,1]
    v_pk_mul_f32 v[116:117], v[118:119], v[112:113] op_sel:[0,0] op_sel_hi:[0,1]
    v_pk_fma_f32 v[136:137], v[132:133], v[108:109], v[136:137] op_sel:[1,1,0] op_sel_hi:[1,0,1] neg_lo:[1,0,0]
    v_pk_fma_f32 v[122:123], v[120:121], v[112:113], v[122:123] op_sel:[1,1,0] op_sel_hi:[1,0,1] neg_lo:[1,0,0]
    v_pk_fma_f32 v[116:117], v[118:119], v[112:113], v[116:117] op_sel:[1,1,0] op_sel_hi:[1,0,1] neg_lo:[1,0,0]
    v_cvt_pk_bf16_f32 v182, v136, -v137
    v_cvt_pk_bf16_f32 v154, v122, v123
    v_cvt_pk_bf16_f32 v163, v116, v117
    v_pk_mul_f32 v[128:129], v[130:131], v[114:115] op_sel:[0,0] op_sel_hi:[0,1]
    v_pk_mul_f32 v[120:121], v[122:123], v[112:113] op_sel:[0,0] op_sel_hi:[0,1]
    v_pk_mul_f32 v[118:119], v[116:117], v[112:113] op_sel:[0,0] op_sel_hi:[0,1]
    v_pk_fma_f32 v[128:129], v[130:131], v[114:115], v[128:129] op_sel:[1,1,0] op_sel_hi:[1,0,1] neg_lo:[1,0,0]
    v_pk_fma_f32 v[120:121], v[122:123], v[112:113], v[120:121] op_sel:[1,1,0] op_sel_hi:[1,0,1] neg_lo:[1,0,0]
    v_pk_fma_f32 v[118:119], v[116:117], v[112:113], v[118:119] op_sel:[1,1,0] op_sel_hi:[1,0,1] neg_lo:[1,0,0]
    v_cvt_pk_bf16_f32 v183, v128, -v129
    v_cvt_pk_bf16_f32 v156, v120, v121
    v_cvt_pk_bf16_f32 v165, v118, v119
    v_pk_mul_f32 v[132:133], v[128:129], v[108:109] op_sel:[0,0] op_sel_hi:[0,1]
    v_pk_mul_f32 v[122:123], v[120:121], v[112:113] op_sel:[0,0] op_sel_hi:[0,1]
    v_pk_mul_f32 v[116:117], v[118:119], v[112:113] op_sel:[0,0] op_sel_hi:[0,1]
    v_pk_fma_f32 v[132:133], v[128:129], v[108:109], v[132:133] op_sel:[1,1,0] op_sel_hi:[1,0,1] neg_lo:[1,0,0]
    v_pk_fma_f32 v[122:123], v[120:121], v[112:113], v[122:123] op_sel:[1,1,0] op_sel_hi:[1,0,1] neg_lo:[1,0,0]
    v_pk_fma_f32 v[116:117], v[118:119], v[112:113], v[116:117] op_sel:[1,1,0] op_sel_hi:[1,0,1] neg_lo:[1,0,0]
    v_cvt_pk_bf16_f32 v184, v132, -v133
    v_cvt_pk_bf16_f32 v158, v122, v123
    v_cvt_pk_bf16_f32 v167, v116, v117
    v_pk_mul_f32 v[130:131], v[128:129], v[114:115] op_sel:[0,0] op_sel_hi:[0,1]
    v_pk_mul_f32 v[120:121], v[122:123], v[112:113] op_sel:[0,0] op_sel_hi:[0,1]
    v_pk_mul_f32 v[118:119], v[116:117], v[112:113] op_sel:[0,0] op_sel_hi:[0,1]
    v_pk_fma_f32 v[130:131], v[128:129], v[114:115], v[130:131] op_sel:[1,1,0] op_sel_hi:[1,0,1] neg_lo:[1,0,0]
    v_pk_fma_f32 v[120:121], v[122:123], v[112:113], v[120:121] op_sel:[1,1,0] op_sel_hi:[1,0,1] neg_lo:[1,0,0]
    v_pk_fma_f32 v[118:119], v[116:117], v[112:113], v[118:119] op_sel:[1,1,0] op_sel_hi:[1,0,1] neg_lo:[1,0,0]
    v_cvt_pk_bf16_f32 v185, v130, -v131
    v_cvt_pk_bf16_f32 v160, v120, v121
    v_cvt_pk_bf16_f32 v169, v118, v119
    v_pk_mul_f32 v[132:133], v[130:131], v[108:109] op_sel:[0,0] op_sel_hi:[0,1]
    v_pk_mul_f32 v[122:123], v[120:121], v[112:113] op_sel:[0,0] op_sel_hi:[0,1]
    v_pk_fma_f32 v[132:133], v[130:131], v[108:109], v[132:133] op_sel:[1,1,0] op_sel_hi:[1,0,1] neg_lo:[1,0,0]
    v_pk_fma_f32 v[122:123], v[120:121], v[112:113], v[122:123] op_sel:[1,1,0] op_sel_hi:[1,0,1] neg_lo:[1,0,0]
    v_cvt_pk_bf16_f32 v186, v132, -v133
    v_cvt_pk_bf16_f32 v162, v122, v123
    v_pk_mul_f32 v[128:129], v[130:131], v[114:115] op_sel:[0,0] op_sel_hi:[0,1]
    v_pk_mul_f32 v[120:121], v[122:123], v[112:113] op_sel:[0,0] op_sel_hi:[0,1]
    v_pk_fma_f32 v[128:129], v[130:131], v[114:115], v[128:129] op_sel:[1,1,0] op_sel_hi:[1,0,1] neg_lo:[1,0,0]
    v_pk_fma_f32 v[120:121], v[122:123], v[112:113], v[120:121] op_sel:[1,1,0] op_sel_hi:[1,0,1] neg_lo:[1,0,0]
    v_cvt_pk_bf16_f32 v187, v128, -v129
Lwarm2:
    s_cbranch_execz Lwarm2_1
    v_cvt_pk_bf16_f32 v164, v120, v121
    v_pk_mul_f32 v[130:131], v[128:129], v[114:115] op_sel:[0,0] op_sel_hi:[0,1]
    v_pk_mul_f32 v[122:123], v[120:121], v[112:113] op_sel:[0,0] op_sel_hi:[0,1]
    v_pk_fma_f32 v[130:131], v[128:129], v[114:115], v[130:131] op_sel:[1,1,0] op_sel_hi:[1,0,1] neg_lo:[1,0,0]
    v_pk_fma_f32 v[122:123], v[120:121], v[112:113], v[122:123] op_sel:[1,1,0] op_sel_hi:[1,0,1] neg_lo:[1,0,0]
    v_cvt_pk_bf16_f32 v188, v130, -v131
    v_cvt_pk_bf16_f32 v166, v122, v123
    v_pk_mul_f32 v[128:129], v[130:131], v[114:115] op_sel:[0,0] op_sel_hi:[0,1]
    v_pk_mul_f32 v[120:121], v[122:123], v[112:113] op_sel:[0,0] op_sel_hi:[0,1]
    v_pk_fma_f32 v[128:129], v[130:131], v[114:115], v[128:129] op_sel:[1,1,0] op_sel_hi:[1,0,1] neg_lo:[1,0,0]
    v_pk_fma_f32 v[120:121], v[122:123], v[112:113], v[120:121] op_sel:[1,1,0] op_sel_hi:[1,0,1] neg_lo:[1,0,0]
    v_cvt_pk_bf16_f32 v189, v128, -v129
    v_cvt_pk_bf16_f32 v168, v120, v121
    v_pk_mul_f32 v[130:131], v[128:129], v[114:115] op_sel:[0,0] op_sel_hi:[0,1]
    v_pk_mul_f32 v[122:123], v[120:121], v[112:113] op_sel:[0,0] op_sel_hi:[0,1]
    v_pk_fma_f32 v[130:131], v[128:129], v[114:115], v[130:131] op_sel:[1,1,0] op_sel_hi:[1,0,1] neg_lo:[1,0,0]
    v_pk_fma_f32 v[122:123], v[120:121], v[112:113], v[122:123] op_sel:[1,1,0] op_sel_hi:[1,0,1] neg_lo:[1,0,0]
    v_cvt_pk_bf16_f32 v190, v130, -v131
    v_cvt_pk_bf16_f32 v170, v122, v123
    v_pk_mul_f32 v[128:129], v[130:131], v[114:115] op_sel:[0,0] op_sel_hi:[0,1]
    v_pk_fma_f32 v[128:129], v[130:131], v[114:115], v[128:129] op_sel:[1,1,0] op_sel_hi:[1,0,1] neg_lo:[1,0,0]
    v_cvt_pk_bf16_f32 v191, v128, -v129
    s_waitcnt lgkmcnt(14)
    v_mfma_f32_32x32x16_bf16 v[84:99], v[192:195], v[196:199], v[84:99]
    s_waitcnt lgkmcnt(12)
    ds_write_addtid_b32 v171 offset:59704
    ds_write_addtid_b32 v172 offset:59976
    ds_write_addtid_b32 v173 offset:60248
    ds_write_addtid_b32 v141 offset:51544
    ds_write_addtid_b32 v174 offset:60520
    ds_write_addtid_b32 v143 offset:52088
    ds_write_addtid_b32 v175 offset:60792
    v_mfma_f32_32x32x16_bf16 v[84:99], v[200:203], v[204:207], v[84:99]
    s_waitcnt lgkmcnt(15)
    ds_write_addtid_b32 v145 offset:52632
    ds_write_addtid_b32 v176 offset:61064
    ds_write_addtid_b32 v147 offset:53176
    ds_write_addtid_b32 v177 offset:61336
    ds_write_addtid_b32 v149 offset:53720
    ds_write_addtid_b32 v178 offset:61608
    ds_write_addtid_b32 v140 offset:51272
    v_mfma_f32_32x32x16_bf16 v[84:99], v[208:211], v[212:215], v[84:99]
    ds_write_addtid_b32 v151 offset:54264
    ds_write_addtid_b32 v142 offset:51816
    ds_write_addtid_b32 v153 offset:54808
    ds_write_addtid_b32 v144 offset:52360
    ds_write_addtid_b32 v155 offset:55352
    ds_write_addtid_b32 v146 offset:52904
    ds_write_addtid_b32 v179 offset:61880
    v_mfma_f32_32x32x16_bf16 v[84:99], v[216:219], v[220:223], v[84:99]
    s_waitcnt lgkmcnt(15)
    ds_write_addtid_b32 v148 offset:53448
    ds_write_addtid_b32 v157 offset:55896
    ds_write_addtid_b32 v180 offset:62152
    ds_write_addtid_b32 v150 offset:53992
    ds_write_addtid_b32 v159 offset:56440
    ds_write_addtid_b32 v181 offset:62424
    ds_write_addtid_b32 v152 offset:54536
    v_mfma_f32_32x32x16_bf16 v[84:99], v[224:227], v[228:231], v[84:99]
    ds_write_addtid_b32 v161 offset:56984
    ds_write_addtid_b32 v182 offset:62696
    ds_write_addtid_b32 v154 offset:55080
    ds_write_addtid_b32 v163 offset:57528
    ds_write_addtid_b32 v183 offset:62968
    ds_write_addtid_b32 v156 offset:55624
    v_mfma_f32_32x32x16_bf16 v[84:99], v[232:235], v[236:239], v[84:99]
    ds_write_addtid_b32 v165 offset:58072
    ds_write_addtid_b32 v184 offset:63240
    ds_write_addtid_b32 v158 offset:56168
    ds_write_addtid_b32 v167 offset:58616
    ds_write_addtid_b32 v185 offset:63512
    ds_write_addtid_b32 v160 offset:56712
    v_mfma_f32_32x32x16_bf16 v[84:99], v[240:243], v[244:247], v[84:99]
    ds_write_addtid_b32 v169 offset:59160
    ds_write_addtid_b32 v186 offset:63784
    ds_write_addtid_b32 v162 offset:57256
    ds_write_addtid_b32 v187 offset:64056
    ds_write_addtid_b32 v164 offset:57800
    ds_write_addtid_b32 v188 offset:64328
    v_mfma_f32_32x32x16_bf16 v[84:99], v[248:251], v[252:255], v[84:99]
    ds_write_addtid_b32 v166 offset:58344
    ds_write_addtid_b32 v189 offset:64600
    ds_write_addtid_b32 v168 offset:58888
    ds_write_addtid_b32 v190 offset:64872
    ds_write_addtid_b32 v170 offset:59432
    ds_write_addtid_b32 v191 offset:65144
    ds_read_b128 v[192:195], v82 offset:8704
    ds_read_b128 v[196:199], v82 offset:0
    ds_read_b128 v[200:203], v82 offset:8736
    ds_read_b128 v[204:207], v82 offset:32
    ds_read_b128 v[208:211], v82 offset:8768
    ds_read_b128 v[212:215], v82 offset:64
    ds_read_b128 v[216:219], v82 offset:8800
    ds_read_b128 v[220:223], v82 offset:96
    ds_read_b128 v[224:227], v82 offset:8832
    ds_read_b128 v[228:231], v82 offset:128
    ds_read_b128 v[232:235], v82 offset:8864
    ds_read_b128 v[236:239], v82 offset:160
    ds_read_b128 v[240:243], v82 offset:8896
    ds_read_b128 v[244:247], v82 offset:192
    ds_read_b128 v[248:251], v82 offset:8928
    ds_read_b128 v[252:255], v82 offset:224
    s_waitcnt vmcnt(5)
    v_add_u32_sdwa v100, s63, v42 dst_sel:DWORD dst_unused:UNUSED_PAD src0_sel:DWORD src1_sel:WORD_0
    v_add_u32_sdwa v101, s63, v42 dst_sel:DWORD dst_unused:UNUSED_PAD src0_sel:DWORD src1_sel:WORD_1
    v_add_u32_sdwa v102, s63, v43 dst_sel:DWORD dst_unused:UNUSED_PAD src0_sel:DWORD src1_sel:WORD_0
    v_add_u32_sdwa v103, s63, v43 dst_sel:DWORD dst_unused:UNUSED_PAD src0_sel:DWORD src1_sel:WORD_1
    v_add_u32_sdwa v104, s63, v44 dst_sel:DWORD dst_unused:UNUSED_PAD src0_sel:DWORD src1_sel:WORD_0
    v_add_u32_sdwa v105, s63, v44 dst_sel:DWORD dst_unused:UNUSED_PAD src0_sel:DWORD src1_sel:WORD_1
    v_add_u32_sdwa v106, s63, v45 dst_sel:DWORD dst_unused:UNUSED_PAD src0_sel:DWORD src1_sel:WORD_0
    v_add_u32_sdwa v107, s63, v45 dst_sel:DWORD dst_unused:UNUSED_PAD src0_sel:DWORD src1_sel:WORD_1
    s_waitcnt vmcnt(4)
    v_add_u32_sdwa v108, s63, v46 dst_sel:DWORD dst_unused:UNUSED_PAD src0_sel:DWORD src1_sel:WORD_0
    v_add_u32_sdwa v109, s63, v46 dst_sel:DWORD dst_unused:UNUSED_PAD src0_sel:DWORD src1_sel:WORD_1
    s_waitcnt lgkmcnt(14)
    v_mfma_f32_32x32x16_bf16 v[84:99], v[192:195], v[196:199], v[84:99]
    s_waitcnt lgkmcnt(12)
    v_add_u32_sdwa v110, s63, v47 dst_sel:DWORD dst_unused:UNUSED_PAD src0_sel:DWORD src1_sel:WORD_0
    v_add_u32_sdwa v111, s63, v47 dst_sel:DWORD dst_unused:UNUSED_PAD src0_sel:DWORD src1_sel:WORD_1
    v_add_u32_sdwa v112, s63, v48 dst_sel:DWORD dst_unused:UNUSED_PAD src0_sel:DWORD src1_sel:WORD_0
    v_add_u32_sdwa v113, s63, v48 dst_sel:DWORD dst_unused:UNUSED_PAD src0_sel:DWORD src1_sel:WORD_1
    v_add_u32_sdwa v114, s63, v49 dst_sel:DWORD dst_unused:UNUSED_PAD src0_sel:DWORD src1_sel:WORD_0
    v_add_u32_sdwa v115, s63, v49 dst_sel:DWORD dst_unused:UNUSED_PAD src0_sel:DWORD src1_sel:WORD_1
    v_mfma_f32_32x32x16_bf16 v[84:99], v[200:203], v[204:207], v[84:99]
    s_waitcnt lgkmcnt(10)
    s_waitcnt vmcnt(3)
    v_add_u32_sdwa v116, s63, v50 dst_sel:DWORD dst_unused:UNUSED_PAD src0_sel:DWORD src1_sel:WORD_0
    v_add_u32_sdwa v117, s63, v50 dst_sel:DWORD dst_unused:UNUSED_PAD src0_sel:DWORD src1_sel:WORD_1
    v_add_u32_sdwa v118, s63, v51 dst_sel:DWORD dst_unused:UNUSED_PAD src0_sel:DWORD src1_sel:WORD_0
    v_add_u32_sdwa v119, s63, v51 dst_sel:DWORD dst_unused:UNUSED_PAD src0_sel:DWORD src1_sel:WORD_1
    v_add_u32_sdwa v120, s63, v52 dst_sel:DWORD dst_unused:UNUSED_PAD src0_sel:DWORD src1_sel:WORD_0
    v_add_u32_sdwa v121, s63, v52 dst_sel:DWORD dst_unused:UNUSED_PAD src0_sel:DWORD src1_sel:WORD_1
    v_mfma_f32_32x32x16_bf16 v[84:99], v[208:211], v[212:215], v[84:99]
    s_waitcnt lgkmcnt(8)
    v_add_u32_sdwa v122, s63, v53 dst_sel:DWORD dst_unused:UNUSED_PAD src0_sel:DWORD src1_sel:WORD_0
    v_add_u32_sdwa v123, s63, v53 dst_sel:DWORD dst_unused:UNUSED_PAD src0_sel:DWORD src1_sel:WORD_1
    s_waitcnt vmcnt(2)
    v_add_u32_sdwa v124, s63, v54 dst_sel:DWORD dst_unused:UNUSED_PAD src0_sel:DWORD src1_sel:WORD_0
    v_add_u32_sdwa v125, s63, v54 dst_sel:DWORD dst_unused:UNUSED_PAD src0_sel:DWORD src1_sel:WORD_1
    v_and_b32 v5, 1, v3
    v_lshl_add_u32 v10, v5, 4, v10
    v_mfma_f32_32x32x16_bf16 v[84:99], v[216:219], v[220:223], v[84:99]
    s_waitcnt lgkmcnt(6)
    v_cmp_gt_u32 vcc, 2, v3
    v_mov_b32 v6, 50432
    v_mov_b32 v7, 63744
    v_cndmask_b32 v6, v7, v6, vcc
    v_add_u32 v10, v10, v6
    v_mov_b32 v7, 0x3f80
    v_mfma_f32_32x32x16_bf16 v[84:99], v[224:227], v[228:231], v[84:99]
    s_waitcnt lgkmcnt(4)
    v_cndmask_b32 v7, v7, v75, vcc
    v_lshlrev_b32 v5, 3, v5
    v_sub_u32 v5, v2, v5
    v_and_b32 v6, 1, v5
    v_lshlrev_b32 v6, 4, v6
    v_lshlrev_b32 v6, v6, v7
    v_mfma_f32_32x32x16_bf16 v[84:99], v[232:235], v[236:239], v[84:99]
    s_waitcnt lgkmcnt(2)
    v_ashrrev_i32 v5, 1, v5
    v_cmp_eq_u32 vcc, 0, v5
    v_cmp_eq_u32 s[50:51], 1, v5
    v_cmp_eq_u32 s[52:53], 2, v5
    v_cndmask_b32 v16, 0, v6, vcc
    v_cmp_eq_u32 vcc, 3, v5
    v_mfma_f32_32x32x16_bf16 v[84:99], v[240:243], v[244:247], v[84:99]
    s_waitcnt lgkmcnt(0)
    v_cndmask_b32 v17, 0, v6, s[50:51]
    v_cndmask_b32 v18, 0, v6, s[52:53]
    v_cndmask_b32 v19, 0, v6, vcc
    v_lshrrev_b32 v5, 2, v1
    v_mul_u32_u24 v5, 163840, v5
    v_and_b32 v6, 3, v1
    v_mfma_f32_32x32x16_bf16 v[84:99], v[248:251], v[252:255], v[84:99]
    s_bfe_u32 s59, s56, 0x10002
    s_lshl_b32 s59, s59, 1
    s_lshl_b32 s60, s56, 6
    s_mul_i32 s68, s2, 2428
    s_lshr_b32 s68, s68, 16
    s_lshl_b32 s68, s68, 7
    s_add_u32 s68, s68, 262144
    s_cmp_lt_u32 s56, 640
    s_cselect_b32 s60, s60, 1073741824
    v_xor_b32 v7, s59, v6
    v_lshl_add_u32 v7, v7, 4, v5
    v_add_u32 v28, s60, v7
    s_mul_i32 s54, s45, 16640
    v_add_u32 v7, s54, v4
    v_lshl_add_u32 v5, v1, 2, s54
    v_lshlrev_b32 v6, 2, v3
    v_sub_u32 v6, v2, v6
    s_add_u32 s54, s54, 3124
    v_lshl_add_u32 v20, v6, 2, s54
    v_mov_b32 v6, 0
    ds_write_addtid_b32 v6 offset:54072
    ds_write_addtid_b32 v84 offset:51000
    ds_write_addtid_b32 v85 offset:51256
    ds_write_addtid_b32 v86 offset:51512
    ds_write_addtid_b32 v87 offset:51768
    ds_write_addtid_b32 v88 offset:52024
    ds_write_addtid_b32 v89 offset:52280
    ds_write_addtid_b32 v90 offset:52536
    ds_write_addtid_b32 v91 offset:52792
    ds_write_addtid_b32 v92 offset:53048
    ds_write_addtid_b32 v93 offset:53304
    ds_write_addtid_b32 v94 offset:53560
    ds_write_addtid_b32 v95 offset:53816
    s_mul_i32 s65, s45, 3072
    s_add_u32 s65, s65, 7168
    s_mul_i32 s64, s2, 16512
    s_add_u32 s64, s64, s65
    s_add_u32 s64, s64, 524288
    s_add_u32 s65, s65, 98304
    s_add_u32 s54, s64, 0
    buffer_load_dwordx4 v[160:163], v4, s[36:39], s54 offen offset:0 sc1
    buffer_load_dwordx4 v[164:167], v4, s[36:39], s54 offen offset:1024 sc1
    buffer_load_dwordx4 v[168:171], v4, s[36:39], s54 offen offset:2048 sc1
    s_add_u32 s54, s65, 0
    buffer_load_dwordx4 v[176:179], v4, s[36:39], s54 offen offset:0 sc1
    buffer_load_dwordx4 v[180:183], v4, s[36:39], s54 offen offset:1024 sc1
    buffer_load_dwordx4 v[184:187], v4, s[36:39], s54 offen offset:2048 sc1
    ds_write_b32 v5, v6 offset:2880
    ds_read_b32 v100, v100
    ds_read_b32 v101, v101
    ds_read_b32 v102, v102
    ds_read_b32 v103, v103
    ds_read_b32 v104, v104
    ds_read_b32 v105, v105
    ds_read_b32 v106, v106
    ds_read_b32 v107, v107
    ds_read_b32 v108, v108
    ds_read_b32 v109, v109
    ds_read_b32 v110, v110
    ds_read_b32 v111, v111
    ds_read_b32 v112, v112
    ds_read_b32 v113, v113
    ds_read_b32 v114, v114
    ds_read_b32 v115, v115
    ds_read_b32 v116, v116
    ds_read_b32 v117, v117
    ds_read_b32 v118, v118
    ds_read_b32 v119, v119
    ds_read_b32 v120, v120
    ds_read_b32 v121, v121
    ds_read_b32 v122, v122
    ds_read_b32 v123, v123
    ds_read_b32 v124, v124
    ds_read_b32 v125, v125
    s_waitcnt lgkmcnt(15)
    v_cvt_pk_bf16_f32 v128, v103, v102
    v_cvt_pk_bf16_f32 v129, v101, v100
    v_cvt_pk_bf16_f32 v130, v107, v106
    v_cvt_pk_bf16_f32 v131, v105, v104
    v_cvt_pk_bf16_f32 v132, v104, v103
    v_cvt_pk_bf16_f32 v133, v102, v101
    v_cvt_pk_bf16_f32 v134, v108, v107
    v_cvt_pk_bf16_f32 v135, v106, v105
    v_cvt_pk_bf16_f32 v136, v105, v104
    v_cvt_pk_bf16_f32 v137, v103, v102
    v_cvt_pk_bf16_f32 v138, v109, v108
    v_cvt_pk_bf16_f32 v139, v107, v106
    v_cvt_pk_bf16_f32 v140, v106, v105
    v_cvt_pk_bf16_f32 v141, v104, v103
    v_cvt_pk_bf16_f32 v142, v110, v109
    v_cvt_pk_bf16_f32 v143, v108, v107
    ds_write_b128 v7, v[128:131] offset:32
    ds_write_b128 v7, v[132:135] offset:4192
    ds_write_b128 v7, v[136:139] offset:8352
    ds_write_b128 v7, v[140:143] offset:12512
    s_waitcnt lgkmcnt(15)
    v_cvt_pk_bf16_f32 v144, v113, v113
    v_cvt_pk_bf16_f32 v145, v112, v111
    v_cvt_pk_bf16_f32 v146, v114, v114
    v_cvt_pk_bf16_f32 v147, v113, v113
    v_cvt_pk_bf16_f32 v148, v113, v113
    v_cvt_pk_bf16_f32 v149, v113, v112
    v_cvt_pk_bf16_f32 v150, v114, v114
    v_cvt_pk_bf16_f32 v151, v114, v113
    v_cvt_pk_bf16_f32 v152, v113, v113
    v_cvt_pk_bf16_f32 v153, v113, v113
Lwarm0_1:
    s_cbranch_execz Lwarm0_2
    s_waitcnt lgkmcnt(14)
    v_cvt_pk_bf16_f32 v154, v115, v114
    v_cvt_pk_bf16_f32 v155, v114, v114
    v_cvt_pk_bf16_f32 v156, v114, v113
    v_cvt_pk_bf16_f32 v157, v113, v113
    v_cvt_pk_bf16_f32 v158, v115, v115
    v_cvt_pk_bf16_f32 v159, v114, v114
    s_waitcnt lgkmcnt(4)
    v_cvt_pk_bf16_f32 v6, v124, v125
    ds_write_b128 v7, v[144:147] offset:1056
    ds_write_b128 v7, v[148:151] offset:5216
    ds_write_b128 v7, v[152:155] offset:9376
    ds_write_b128 v7, v[156:159] offset:13536
    ds_write_b32 v5, v6 offset:3136
    v_cvt_pk_bf16_f32 v216, v116, v117
    v_cvt_pk_bf16_f32 v217, v118, v119
    v_cvt_pk_bf16_f32 v218, v120, v121
    v_cvt_pk_bf16_f32 v219, v122, v123
    s_mul_i32 m0, s45, 768
    s_add_u32 m0, m0, 51712
    s_waitcnt vmcnt(5)
    v_xor_b32 v5, s44, v163
    s_waitcnt vmcnt(4)
    v_bitop3_b32 v5, v5, v167, s44 bitop3:0xf6
    s_waitcnt vmcnt(3)
    v_bitop3_b32 v5, v5, v171, s44 bitop3:0xf6
    s_waitcnt vmcnt(2)
    v_bitop3_b32 v5, v5, v179, s44 bitop3:0xf6
    s_waitcnt vmcnt(1)
    v_bitop3_b32 v5, v5, v183, s44 bitop3:0xf6
    s_waitcnt vmcnt(0)
    v_bitop3_b32 v5, v5, v187, s44 bitop3:0xf6
    v_cmp_ne_u32 vcc, 0, v5
    s_cbranch_vccnz Lslow2
Lgot3:
    v_and_b32 v179, 0xffff0000, v178
    v_and_b32 v183, 0xffff0000, v182
    v_and_b32 v187, 0xffff0000, v186
    v_lshlrev_b32 v178, 16, v178
    v_lshlrev_b32 v182, 16, v182
    v_lshlrev_b32 v186, 16, v186
    v_lshlrev_b32 v224, 16, v160
    v_lshlrev_b32 v232, 16, v164
    v_lshlrev_b32 v240, 16, v168
    v_and_b32 v225, 0xffff0000, v160
    v_and_b32 v233, 0xffff0000, v164
    v_and_b32 v241, 0xffff0000, v168
    v_lshlrev_b32 v226, 16, v161
    v_lshlrev_b32 v234, 16, v165
    v_lshlrev_b32 v242, 16, v169
    v_and_b32 v227, 0xffff0000, v161
    v_and_b32 v235, 0xffff0000, v165
    v_and_b32 v243, 0xffff0000, v169
    v_lshlrev_b32 v228, 16, v162
    v_lshlrev_b32 v236, 16, v166
    v_lshlrev_b32 v244, 16, v170
    v_and_b32 v229, 0xffff0000, v162
    v_and_b32 v237, 0xffff0000, v166
    v_and_b32 v245, 0xffff0000, v170
    v_pk_mul_f32 v[178:179], v[178:179], v[176:177]
    v_pk_mul_f32 v[182:183], v[182:183], v[180:181]
    v_pk_mul_f32 v[186:187], v[186:187], v[184:185]
    v_pk_fma_f32 v[224:225], v[224:225], v[176:177], v[178:179] neg_lo:[0,0,1] neg_hi:[0,0,1]
    v_pk_fma_f32 v[232:233], v[232:233], v[180:181], v[182:183] neg_lo:[0,0,1] neg_hi:[0,0,1]
    v_pk_fma_f32 v[240:241], v[240:241], v[184:185], v[186:187] neg_lo:[0,0,1] neg_hi:[0,0,1]
    v_pk_fma_f32 v[226:227], v[226:227], v[176:177], v[178:179] neg_lo:[0,0,1] neg_hi:[0,0,1]
    v_pk_fma_f32 v[234:235], v[234:235], v[180:181], v[182:183] neg_lo:[0,0,1] neg_hi:[0,0,1]
    v_pk_fma_f32 v[242:243], v[242:243], v[184:185], v[186:187] neg_lo:[0,0,1] neg_hi:[0,0,1]
    v_pk_fma_f32 v[228:229], v[228:229], v[176:177], v[178:179] neg_lo:[0,0,1] neg_hi:[0,0,1]
    v_pk_fma_f32 v[236:237], v[236:237], v[180:181], v[182:183] neg_lo:[0,0,1] neg_hi:[0,0,1]
    v_pk_fma_f32 v[244:245], v[244:245], v[184:185], v[186:187] neg_lo:[0,0,1] neg_hi:[0,0,1]
    v_cvt_pk_bf16_f32 v176, v224, v225
    v_cvt_pk_bf16_f32 v180, v232, v233
    v_cvt_pk_bf16_f32 v184, v240, v241
    v_cvt_pk_bf16_f32 v177, v226, v227
    v_cvt_pk_bf16_f32 v181, v234, v235
    v_cvt_pk_bf16_f32 v185, v242, v243
    v_cvt_pk_bf16_f32 v178, v228, v229
    v_cvt_pk_bf16_f32 v182, v236, v237
    v_cvt_pk_bf16_f32 v186, v244, v245
    ds_write_addtid_b32 v176 offset:512
    ds_write_addtid_b32 v160 offset:13824
    ds_write_addtid_b32 v177 offset:5120
    ds_write_addtid_b32 v161 offset:18432
    ds_write_addtid_b32 v178 offset:9728
    ds_write_addtid_b32 v162 offset:23040
    ds_write_addtid_b32 v180 offset:768
    ds_write_addtid_b32 v164 offset:14080
    ds_write_addtid_b32 v181 offset:5376
    ds_write_addtid_b32 v165 offset:18688
    ds_write_addtid_b32 v182 offset:9984
    ds_write_addtid_b32 v166 offset:23296
    ds_write_addtid_b32 v184 offset:1024
    ds_write_addtid_b32 v168 offset:14336
    ds_write_addtid_b32 v185 offset:5632
    ds_write_addtid_b32 v169 offset:18944
    ds_write_addtid_b32 v186 offset:10240
    ds_write_addtid_b32 v170 offset:23552
    s_waitcnt lgkmcnt(0)
    s_barrier
    ds_read_b128 v[72:75], v10 offset:0
    ds_read_b128 a[128:131], v9 offset:480
    ds_read_b64 a[132:133], v8 offset:8
    ds_read_b64 a[134:135], v8 offset:0
    ds_read_b128 v[76:79], v10 offset:512
    ds_read_b128 a[136:139], v9 offset:992
    ds_read_b64 a[140:141], v8 offset:520
    ds_read_b64 a[142:143], v8 offset:512
    ds_read_b128 a[144:147], v9 offset:416
    ds_read_b64 a[148:149], v8 offset:72
    ds_read_b64 a[150:151], v8 offset:64
    ds_read_b128 a[152:155], v9 offset:928
    ds_read_b64 a[156:157], v8 offset:584
    ds_read_b64 a[158:159], v8 offset:576
    s_waitcnt lgkmcnt(13)
    v_mfma_f32_16x16x32_bf16 v[32:35], v[16:19], v[72:75], 0
    s_waitcnt lgkmcnt(10)
    ds_read_b128 a[160:163], v9 offset:352
    ds_read_b64 a[164:165], v8 offset:136
    ds_read_b64 a[166:167], v8 offset:128
    v_mfma_f32_16x16x32_bf16 v[32:35], a[132:135], a[128:131], v[32:35]
    s_waitcnt lgkmcnt(12)
    ds_read_b128 a[168:171], v9 offset:864
    ds_read_b64 a[172:173], v8 offset:648
    v_mfma_f32_16x16x32_bf16 v[36:39], v[16:19], v[76:79], 0
    s_waitcnt lgkmcnt(13)
    ds_read_b64 a[174:175], v8 offset:640
    buffer_load_dwordx4 a[0:3], v4, s[36:39], s6 offen offset:0 sc1
    v_mfma_f32_16x16x32_bf16 v[36:39], a[132:135], a[136:139], v[36:39]
    s_waitcnt lgkmcnt(12)
    ds_read_b128 a[176:179], v9 offset:288
    ds_read_b64 a[180:181], v8 offset:200
    ds_read_b64 a[182:183], v8 offset:192
    v_mfma_f32_16x16x32_bf16 v[36:39], a[140:143], a[128:131], v[36:39]
    s_waitcnt lgkmcnt(12)
    ds_read_b128 a[184:187], v9 offset:800
    ds_read_b64 a[188:189], v8 offset:712
    v_mfma_f32_16x16x32_bf16 v[32:35], a[148:151], a[144:147], v[32:35]
    s_waitcnt lgkmcnt(13)
    ds_read_b64 a[190:191], v8 offset:704
    ds_read_b128 a[192:195], v9 offset:224
    v_mfma_f32_16x16x32_bf16 v[36:39], a[148:151], a[152:155], v[36:39]
    s_waitcnt lgkmcnt(13)
    ds_read_b64 a[196:197], v8 offset:264
    ds_read_b64 a[198:199], v8 offset:256
    v_mfma_f32_16x16x32_bf16 v[36:39], a[156:159], a[144:147], v[36:39]
    s_waitcnt lgkmcnt(12)
    ds_read_b128 a[200:203], v9 offset:736
    buffer_load_dwordx4 a[4:7], v4, s[36:39], s6 offen offset:1024 sc1
    v_mfma_f32_16x16x32_bf16 v[32:35], a[164:167], a[160:163], v[32:35]
    s_waitcnt lgkmcnt(12)
    ds_read_b64 a[204:205], v8 offset:776
    ds_read_b64 a[206:207], v8 offset:768
    v_mfma_f32_16x16x32_bf16 v[36:39], a[164:167], a[168:171], v[36:39]
    s_waitcnt lgkmcnt(12)
    ds_read_b128 a[208:211], v9 offset:160
    ds_read_b64 a[212:213], v8 offset:328
    ds_read_b64 a[214:215], v8 offset:320
    v_mfma_f32_16x16x32_bf16 v[36:39], a[172:175], a[160:163], v[36:39]
    s_waitcnt lgkmcnt(12)
    ds_read_b128 a[216:219], v9 offset:672
    ds_read_b64 a[220:221], v8 offset:840
    v_mfma_f32_16x16x32_bf16 v[32:35], a[180:183], a[176:179], v[32:35]
    s_waitcnt lgkmcnt(13)
    ds_read_b64 a[222:223], v8 offset:832
    ds_read_b128 a[224:227], v9 offset:96
    v_mfma_f32_16x16x32_bf16 v[36:39], a[180:183], a[184:187], v[36:39]
    s_waitcnt lgkmcnt(13)
    ds_read_b64 a[228:229], v8 offset:392
    ds_read_b64 a[230:231], v8 offset:384
    buffer_load_dwordx4 a[8:11], v4, s[36:39], s6 offen offset:2048 sc1
    v_mfma_f32_16x16x32_bf16 v[36:39], a[188:191], a[176:179], v[36:39]
    s_waitcnt lgkmcnt(12)
    ds_read_b128 a[232:235], v9 offset:608
    ds_read_b64 a[236:237], v8 offset:904
    v_mfma_f32_16x16x32_bf16 v[32:35], a[196:199], a[192:195], v[32:35]
    s_waitcnt lgkmcnt(13)
    ds_read_b64 a[238:239], v8 offset:896
    ds_read_b128 a[240:243], v9 offset:32
    v_mfma_f32_16x16x32_bf16 v[36:39], a[196:199], a[200:203], v[36:39]
    s_waitcnt lgkmcnt(13)
    ds_read_b64 a[244:245], v8 offset:456
    ds_read_b64 a[246:247], v8 offset:448
    v_mfma_f32_16x16x32_bf16 v[36:39], a[204:207], a[192:195], v[36:39]
    s_waitcnt lgkmcnt(12)
    ds_read_b128 a[248:251], v9 offset:544
    ds_read_b64 a[252:253], v8 offset:968
    v_mfma_f32_16x16x32_bf16 v[32:35], a[212:215], a[208:211], v[32:35]
    s_waitcnt lgkmcnt(13)
    ds_read_b64 a[254:255], v8 offset:960
    ds_read_b128 v[80:83], v10 offset:1024
    v_mfma_f32_16x16x32_bf16 v[36:39], a[212:215], a[216:219], v[36:39]
    s_waitcnt lgkmcnt(13)
    ds_read_b128 v[84:87], v9 offset:1504
    s_add_u32 s6, s6, 3072
    v_mfma_f32_16x16x32_bf16 v[36:39], a[220:223], a[208:211], v[36:39]
    s_waitcnt lgkmcnt(11)
    ds_read_b64 v[88:89], v8 offset:1032
    buffer_load_dwordx4 a[12:15], v4, s[36:39], s6 offen offset:0 sc1
    v_mfma_f32_16x16x32_bf16 v[32:35], a[228:231], a[224:227], v[32:35]
    s_waitcnt lgkmcnt(11)
    ds_read_b64 v[90:91], v8 offset:1024
    v_mfma_f32_16x16x32_bf16 v[36:39], a[228:231], a[232:235], v[36:39]
    s_waitcnt lgkmcnt(10)
    ds_read_b128 v[92:95], v10 offset:1536
    v_mfma_f32_16x16x32_bf16 v[36:39], a[236:239], a[224:227], v[36:39]
    s_waitcnt lgkmcnt(8)
    v_mfma_f32_16x16x32_bf16 v[32:35], a[244:247], a[240:243], v[32:35]
    s_waitcnt lgkmcnt(7)
    ds_read_b128 v[96:99], v9 offset:2016
    buffer_load_dwordx4 a[16:19], v4, s[36:39], s6 offen offset:1024 sc1
    v_mfma_f32_16x16x32_bf16 v[36:39], a[244:247], a[248:251], v[36:39]
    s_waitcnt lgkmcnt(6)
    ds_read_b64 v[100:101], v8 offset:1544
    v_mfma_f32_16x16x32_bf16 v[36:39], a[252:255], a[240:243], v[36:39]
    s_waitcnt lgkmcnt(6)
    ds_read_b64 v[102:103], v8 offset:1536
    v_mfma_f32_16x16x32_bf16 v[40:43], v[16:19], v[80:83], 0
    ds_read_b128 v[104:107], v9 offset:1440
    v_mfma_f32_16x16x32_bf16 v[40:43], a[140:143], a[136:139], v[40:43]
    s_waitcnt lgkmcnt(7)
    ds_read_b64 v[108:109], v8 offset:1096
    v_cvt_pk_bf16_f32 v248, v32, v33
    v_mfma_f32_16x16x32_bf16 v[40:43], a[132:135], v[84:87], v[40:43]
    s_waitcnt lgkmcnt(6)
    ds_read_b64 v[110:111], v8 offset:1088
    v_cvt_pk_bf16_f32 v249, v34, v35
    v_mfma_f32_16x16x32_bf16 v[40:43], v[88:91], a[128:131], v[40:43]
    s_waitcnt lgkmcnt(6)
    v_cvt_pk_bf16_f32 v250, v36, v37
    v_cvt_pk_bf16_f32 v251, v38, v39
    v_mfma_f32_16x16x32_bf16 v[44:47], v[16:19], v[92:95], 0
    s_mov_b32 s55, 7991296
    ds_read_b128 v[112:115], v9 offset:1952
    buffer_store_dwordx4 v[248:251], v28, s[36:39], s55 offen sc1
    v_mfma_f32_16x16x32_bf16 v[44:47], a[140:143], v[84:87], v[44:47]
    ds_read_b64 v[116:117], v8 offset:1608
    buffer_load_dwordx4 a[20:23], v4, s[36:39], s6 offen offset:2048 sc1
    v_mfma_f32_16x16x32_bf16 v[44:47], v[88:91], a[136:139], v[44:47]
    s_waitcnt lgkmcnt(7)
    ds_read_b64 v[118:119], v8 offset:1600
    v_mfma_f32_16x16x32_bf16 v[44:47], a[132:135], v[96:99], v[44:47]
    s_waitcnt lgkmcnt(6)
    ds_read_b128 v[120:123], v9 offset:1376
    v_mfma_f32_16x16x32_bf16 v[44:47], v[100:103], a[128:131], v[44:47]
    s_add_u32 s6, s6, 3072
    ds_read_b64 v[124:125], v8 offset:1160
    buffer_load_dwordx4 a[24:27], v4, s[36:39], s6 offen offset:0 sc1
    v_mfma_f32_16x16x32_bf16 v[40:43], a[156:159], a[152:155], v[40:43]
    s_waitcnt lgkmcnt(7)
    ds_read_b64 v[126:127], v8 offset:1152
    v_mfma_f32_16x16x32_bf16 v[40:43], a[148:151], v[104:107], v[40:43]
    s_waitcnt lgkmcnt(6)
    v_mfma_f32_16x16x32_bf16 v[40:43], v[108:111], a[144:147], v[40:43]
    ds_read_b128 v[128:131], v9 offset:1888
    v_mfma_f32_16x16x32_bf16 v[44:47], a[156:159], v[104:107], v[44:47]
    ds_read_b64 v[132:133], v8 offset:1672
    v_mfma_f32_16x16x32_bf16 v[44:47], v[108:111], a[152:155], v[44:47]
    s_waitcnt lgkmcnt(7)
    ds_read_b64 v[134:135], v8 offset:1664
    buffer_load_dwordx4 a[28:31], v4, s[36:39], s6 offen offset:1024 sc1
    v_mfma_f32_16x16x32_bf16 v[44:47], a[148:151], v[112:115], v[44:47]
    s_waitcnt lgkmcnt(6)
    ds_read_b128 v[136:139], v9 offset:1312
    v_mov_b32 v12, 0x3f803f80
    v_mfma_f32_16x16x32_bf16 v[44:47], v[116:119], a[144:147], v[44:47]
    ds_read_b64 v[140:141], v8 offset:1224
    v_mov_b32 v13, 0x3f803f80
    v_mfma_f32_16x16x32_bf16 v[40:43], a[172:175], a[168:171], v[40:43]
    s_waitcnt lgkmcnt(7)
    ds_read_b64 v[142:143], v8 offset:1216
    v_mov_b32 v14, 0x3f803f80
    v_mfma_f32_16x16x32_bf16 v[40:43], a[164:167], v[120:123], v[40:43]
    s_waitcnt lgkmcnt(6)
    v_mov_b32 v15, 0x3f803f80
    v_lshrrev_b32 v7, 2, v1
    v_mfma_f32_16x16x32_bf16 v[40:43], v[124:127], a[160:163], v[40:43]
    ds_read_b128 v[144:147], v9 offset:1824
    buffer_load_dwordx4 a[32:35], v4, s[36:39], s6 offen offset:2048 sc1
    v_mfma_f32_16x16x32_bf16 v[44:47], a[172:175], v[120:123], v[44:47]
    ds_read_b64 v[148:149], v8 offset:1736
    v_lshlrev_b32 v7, 6, v7
    v_mfma_f32_16x16x32_bf16 v[44:47], v[124:127], a[168:171], v[44:47]
    s_waitcnt lgkmcnt(7)
    ds_read_b64 v[150:151], v8 offset:1728
    v_and_b32 v6, 3, v1
    v_mfma_f32_16x16x32_bf16 v[44:47], a[164:167], v[128:131], v[44:47]
Lwarm1_1:
    s_cbranch_execz Lwarm1_2
    s_waitcnt lgkmcnt(6)
    ds_read_b128 v[152:155], v9 offset:1248
    v_lshl_add_u32 v7, v6, 3, v7
    v_mfma_f32_16x16x32_bf16 v[44:47], v[132:135], a[160:163], v[44:47]
    ds_read_b64 v[156:157], v8 offset:1288
    v_and_b32 v6, 1, v3
    v_mfma_f32_16x16x32_bf16 v[40:43], a[188:191], a[184:187], v[40:43]
    s_waitcnt lgkmcnt(7)
    ds_read_b64 v[158:159], v8 offset:1280
    v_lshl_add_u32 v7, v6, 5, v7
    v_mfma_f32_16x16x32_bf16 v[40:43], a[180:183], v[136:139], v[40:43]
    s_waitcnt lgkmcnt(6)
    s_xor_b32 s57, s4, 0
    s_mul_i32 s57, s57, 10240
    v_mfma_f32_16x16x32_bf16 v[40:43], v[140:143], a[176:179], v[40:43]
    s_add_u32 s6, s6, 3072
    ds_read_b128 v[160:163], v9 offset:1760
    buffer_load_dwordx4 a[36:39], v4, s[36:39], s6 offen offset:0 sc1
    v_mfma_f32_16x16x32_bf16 v[44:47], a[188:191], v[136:139], v[44:47]
    s_add_u32 s57, s57, 81920
    ds_read_b64 v[164:165], v8 offset:1800
    v_add_u32 v64, s57, v7
    v_mfma_f32_16x16x32_bf16 v[44:47], v[140:143], a[184:187], v[44:47]
    s_waitcnt lgkmcnt(7)
    ds_read_b64 v[166:167], v8 offset:1792
    v_xor_b32 v68, 32, v64
    v_mfma_f32_16x16x32_bf16 v[44:47], a[180:183], v[144:147], v[44:47]
    s_waitcnt lgkmcnt(6)
    ds_read_b128 v[168:171], v9 offset:1184
    s_xor_b32 s57, s4, 1
    v_mfma_f32_16x16x32_bf16 v[44:47], v[148:151], a[176:179], v[44:47]
    ds_read_b64 v[172:173], v8 offset:1352
    buffer_load_dwordx4 a[40:43], v4, s[36:39], s6 offen offset:1024 sc1
    v_mfma_f32_16x16x32_bf16 v[40:43], a[204:207], a[200:203], v[40:43]
    s_waitcnt lgkmcnt(7)
    ds_read_b64 v[174:175], v8 offset:1344
    s_mul_i32 s57, s57, 10240
    v_mfma_f32_16x16x32_bf16 v[40:43], a[196:199], v[152:155], v[40:43]
    s_waitcnt lgkmcnt(6)
    s_add_u32 s57, s57, 81920
    v_add_u32 v65, s57, v7
    v_mfma_f32_16x16x32_bf16 v[40:43], v[156:159], a[192:195], v[40:43]
    ds_read_b128 v[176:179], v9 offset:1696
    v_xor_b32 v69, 32, v65
    v_mfma_f32_16x16x32_bf16 v[44:47], a[204:207], v[152:155], v[44:47]
    s_xor_b32 s57, s4, 2
    ds_read_b64 v[180:181], v8 offset:1864
    s_mul_i32 s57, s57, 10240
    v_mfma_f32_16x16x32_bf16 v[44:47], v[156:159], a[200:203], v[44:47]
    s_waitcnt lgkmcnt(7)
    ds_read_b64 v[182:183], v8 offset:1856
    buffer_load_dwordx4 a[44:47], v4, s[36:39], s6 offen offset:2048 sc1
    v_mfma_f32_16x16x32_bf16 v[44:47], a[196:199], v[160:163], v[44:47]
    s_waitcnt lgkmcnt(6)
    ds_read_b128 v[72:75], v9 offset:1120
    s_add_u32 s57, s57, 81920
    v_mfma_f32_16x16x32_bf16 v[44:47], v[164:167], a[192:195], v[44:47]
    s_waitcnt vmcnt(7)
    ds_read_b64 v[76:77], v8 offset:1416
    ds_add_rtn_u32 v26, v21, v27 offset:0
    v_mfma_f32_16x16x32_bf16 v[40:43], a[220:223], a[216:219], v[40:43]
    s_waitcnt lgkmcnt(8)
    ds_read_b64 v[78:79], v8 offset:1408
    v_add_u32 v66, s57, v7
    v_mfma_f32_16x16x32_bf16 v[40:43], a[212:215], v[168:171], v[40:43]
    s_waitcnt lgkmcnt(7)
    v_xor_b32 v70, 32, v66
    s_xor_b32 s57, s4, 3
    v_mfma_f32_16x16x32_bf16 v[40:43], v[172:175], a[208:211], v[40:43]
    s_mul_i32 s57, s57, 10240
    ds_read_b128 v[80:83], v9 offset:1632
    s_add_u32 s57, s57, 81920
    v_mfma_f32_16x16x32_bf16 v[44:47], a[220:223], v[168:171], v[44:47]
    s_add_u32 s6, s6, 3072
    ds_read_b64 v[84:85], v8 offset:1928
    buffer_load_dwordx4 a[48:51], v4, s[36:39], s6 offen offset:0 sc1
    v_mfma_f32_16x16x32_bf16 v[44:47], v[172:175], a[216:219], v[44:47]
    s_waitcnt lgkmcnt(8)
    ds_read_b64 v[86:87], v8 offset:1920
    v_add_u32 v67, s57, v7
    v_mfma_f32_16x16x32_bf16 v[44:47], a[212:215], v[176:179], v[44:47]
    s_waitcnt lgkmcnt(7)
    ds_read_b128 v[88:91], v9 offset:1056
    s_waitcnt lgkmcnt(5)
    v_xor_b32 v26, 2, v26
    v_mfma_f32_16x16x32_bf16 v[44:47], v[180:183], a[208:211], v[44:47]
    ds_read_b64 v[92:93], v8 offset:1480
    v_lshl_add_u32 v26, v26, 29, v30
    v_mfma_f32_16x16x32_bf16 v[40:43], a[236:239], a[232:235], v[40:43]
    ds_read_b64 v[94:95], v8 offset:1472
    buffer_atomic_add v25, v26, s[36:39], s68 offen offset:0 sc1
    v_mfma_f32_16x16x32_bf16 v[40:43], a[228:231], v[72:75], v[40:43]
    s_waitcnt lgkmcnt(6)
    buffer_load_dwordx4 a[52:55], v4, s[36:39], s6 offen offset:1024 sc1
    v_xor_b32 v71, 32, v67
    v_mfma_f32_16x16x32_bf16 v[40:43], v[76:79], a[224:227], v[40:43]
    ds_read_b128 v[96:99], v9 offset:1568
    v_mfma_f32_16x16x32_bf16 v[44:47], a[236:239], v[72:75], v[44:47]
    ds_read_b64 v[100:101], v8 offset:1992
    v_mfma_f32_16x16x32_bf16 v[44:47], v[76:79], a[232:235], v[44:47]
    s_waitcnt lgkmcnt(7)
    ds_read_b64 v[102:103], v8 offset:1984
    v_mfma_f32_16x16x32_bf16 v[44:47], a[228:231], v[80:83], v[44:47]
    s_waitcnt lgkmcnt(6)
    ds_read_b128 v[104:107], v9 offset:480
    v_mfma_f32_16x16x32_bf16 v[44:47], v[84:87], a[224:227], v[44:47]
    ds_read_b128 v[108:111], v9 offset:464
    buffer_load_dwordx4 a[56:59], v4, s[36:39], s6 offen offset:2048 sc1
    v_mfma_f32_16x16x32_bf16 v[40:43], a[252:255], a[248:251], v[40:43]
    s_waitcnt lgkmcnt(7)
    ds_read_b128 v[112:115], v9 offset:992
    v_mfma_f32_16x16x32_bf16 v[40:43], a[244:247], v[88:91], v[40:43]
    s_waitcnt lgkmcnt(6)
    ds_read_b128 v[116:119], v9 offset:976
    v_mfma_f32_16x16x32_bf16 v[40:43], v[92:95], a[240:243], v[40:43]
    ds_read_b128 v[120:123], v9 offset:1504
    v_mfma_f32_16x16x32_bf16 v[44:47], a[252:255], v[88:91], v[44:47]
    ds_read_b128 v[124:127], v9 offset:1488
    v_mfma_f32_16x16x32_bf16 v[44:47], v[92:95], a[248:251], v[44:47]
    s_waitcnt lgkmcnt(8)
    ds_read_b128 v[128:131], v9 offset:2016
    v_mfma_f32_16x16x32_bf16 v[44:47], a[244:247], v[96:99], v[44:47]
    s_waitcnt lgkmcnt(7)
    ds_read_b128 v[132:135], v9 offset:2000
    buffer_load_dwordx4 a[60:63], v4, s[36:39], s7 offen offset:0 sc1
    v_mfma_f32_16x16x32_bf16 v[44:47], v[100:103], a[240:243], v[44:47]
    s_waitcnt lgkmcnt(7)
    ds_read_b128 v[136:139], v10 offset:2048
    v_mfma_f32_16x16x32_bf16 v[184:187], v[104:107], a[120:123], 0
    s_waitcnt lgkmcnt(7)
    ds_read_b64 v[140:141], v8 offset:1544
    v_mfma_f32_16x16x32_bf16 v[188:191], v[108:111], a[124:127], 0
    s_waitcnt lgkmcnt(7)
    ds_read_b64 v[142:143], v8 offset:1536
    v_cvt_pk_bf16_f32 v252, v40, v41
    v_mfma_f32_16x16x32_bf16 v[192:195], v[112:115], a[120:123], 0
    s_waitcnt lgkmcnt(7)
    ds_read_b128 v[144:147], v10 offset:2560
    v_cvt_pk_bf16_f32 v253, v42, v43
    v_mfma_f32_16x16x32_bf16 v[196:199], v[116:119], a[124:127], 0
    s_waitcnt lgkmcnt(7)
    v_cvt_pk_bf16_f32 v254, v44, v45
    v_cvt_pk_bf16_f32 v255, v46, v47
    v_mfma_f32_16x16x32_bf16 v[200:203], v[120:123], a[120:123], 0
    s_waitcnt lgkmcnt(6)
    ds_read_b64 v[148:149], v8 offset:1032
    s_mov_b32 s55, 8032256
    v_mfma_f32_16x16x32_bf16 v[204:207], v[124:127], a[124:127], 0
    s_waitcnt lgkmcnt(6)
    ds_read_b64 v[150:151], v8 offset:1024
    buffer_store_dwordx4 v[252:255], v28, s[36:39], s55 offen sc1
    v_mfma_f32_16x16x32_bf16 v[208:211], v[128:131], a[120:123], 0
    s_waitcnt lgkmcnt(6)
    ds_read_b128 v[152:155], v10 offset:3072
    buffer_load_dwordx4 a[64:67], v4, s[36:39], s7 offen offset:1024 sc1
    v_mfma_f32_16x16x32_bf16 v[212:215], v[132:135], a[124:127], 0
    s_waitcnt lgkmcnt(6)
    v_mfma_f32_16x16x32_bf16 v[48:51], v[16:19], v[136:139], 0
    ds_read_b64 v[156:157], v8 offset:520
    buffer_load_dwordx4 a[68:71], v4, s[36:39], s7 offen offset:2048 sc1
    v_mfma_f32_16x16x32_bf16 v[48:51], v[216:219], v[104:107], v[48:51]
    s_waitcnt lgkmcnt(5)
    v_mfma_f32_16x16x32_bf16 v[48:51], v[140:143], v[112:115], v[48:51]
    s_waitcnt lgkmcnt(4)
    ds_read_b64 v[158:159], v8 offset:512
    v_mfma_f32_16x16x32_bf16 v[52:55], v[16:19], v[144:147], 0
    ds_read_b128 v[160:163], v10 offset:3584
    v_mfma_f32_16x16x32_bf16 v[52:55], v[216:219], v[112:115], v[52:55]
    v_mfma_f32_16x16x32_bf16 v[52:55], v[140:143], v[120:123], v[52:55]
    s_waitcnt lgkmcnt(4)
    ds_read_b128 v[164:167], v9 offset:2528
    v_mfma_f32_16x16x32_bf16 v[48:51], v[148:151], v[120:123], v[48:51]
    s_waitcnt lgkmcnt(4)
    v_cvt_pk_bf16_f32 v184, v184, v188
    v_cvt_pk_bf16_f32 v185, v185, v189
    v_mfma_f32_16x16x32_bf16 v[56:59], v[16:19], v[152:155], 0
    s_add_u32 s7, s7, 3072
    ds_read_b64 v[168:169], v8 offset:8
    buffer_load_dwordx4 a[72:75], v4, s[36:39], s7 offen offset:0 sc1
    v_mfma_f32_16x16x32_bf16 v[56:59], v[216:219], v[120:123], v[56:59]
    ds_read_b64 v[170:171], v8 offset:0
    v_cvt_pk_bf16_f32 v186, v186, v190
    v_mfma_f32_16x16x32_bf16 v[56:59], v[140:143], v[128:131], v[56:59]
    ds_read_b128 v[172:175], v9 offset:3040
    v_cvt_pk_bf16_f32 v187, v187, v191
    v_mfma_f32_16x16x32_bf16 v[52:55], v[148:151], v[128:131], v[52:55]
    s_waitcnt lgkmcnt(5)
    v_cvt_pk_bf16_f32 v192, v192, v196
    v_cvt_pk_bf16_f32 v193, v193, v197
    v_mfma_f32_16x16x32_bf16 v[48:51], v[156:159], v[128:131], v[48:51]
    s_waitcnt lgkmcnt(4)
    ds_read_b128 v[176:179], v9 offset:3552
    buffer_load_dwordx4 a[76:79], v4, s[36:39], s7 offen offset:1024 sc1
    v_mfma_f32_16x16x32_bf16 v[60:63], v[16:19], v[160:163], 0
    ds_read_b128 v[180:183], v9 offset:4064
    v_cvt_pk_bf16_f32 v194, v194, v198
    v_mfma_f32_16x16x32_bf16 v[60:63], v[216:219], v[128:131], v[60:63]
    s_waitcnt lgkmcnt(5)
    ds_read_b128 v[72:75], v9 offset:928
    v_cvt_pk_bf16_f32 v195, v195, v199
    v_mfma_f32_16x16x32_bf16 v[60:63], v[140:143], v[164:167], v[60:63]
    ds_read_b64 v[76:77], v8 offset:1608
    v_cvt_pk_bf16_f32 v200, v200, v204
    v_mfma_f32_16x16x32_bf16 v[56:59], v[148:151], v[164:167], v[56:59]
    ds_read_b64 v[78:79], v8 offset:1600
    v_cvt_pk_bf16_f32 v201, v201, v205
    v_mfma_f32_16x16x32_bf16 v[52:55], v[156:159], v[164:167], v[52:55]
    s_waitcnt lgkmcnt(6)
    ds_read_b128 v[80:83], v9 offset:1440
    buffer_load_dwordx4 a[80:83], v4, s[36:39], s7 offen offset:2048 sc1
    v_mfma_f32_16x16x32_bf16 v[48:51], v[168:171], v[164:167], v[48:51]
    s_waitcnt lgkmcnt(6)
    ds_read_b64 v[84:85], v8 offset:1096
    v_cvt_pk_bf16_f32 v202, v202, v206
    v_mfma_f32_16x16x32_bf16 v[60:63], v[148:151], v[172:175], v[60:63]
    ds_read_b64 v[86:87], v8 offset:1088
    v_cvt_pk_bf16_f32 v203, v203, v207
    v_mfma_f32_16x16x32_bf16 v[56:59], v[156:159], v[172:175], v[56:59]
    ds_read_b128 v[88:91], v9 offset:1952
    v_cvt_pk_bf16_f32 v208, v208, v212
    v_mfma_f32_16x16x32_bf16 v[52:55], v[168:171], v[172:175], v[52:55]
    s_waitcnt lgkmcnt(8)
    ds_read_b64 v[92:93], v8 offset:584
    v_cvt_pk_bf16_f32 v209, v209, v213
    v_mfma_f32_16x16x32_bf16 v[60:63], v[156:159], v[176:179], v[60:63]
    ds_read_b64 v[94:95], v8 offset:576
    v_cvt_pk_bf16_f32 v210, v210, v214
    v_mfma_f32_16x16x32_bf16 v[56:59], v[168:171], v[176:179], v[56:59]
    s_waitcnt lgkmcnt(9)
    ds_read_b128 v[96:99], v9 offset:2464
    v_cvt_pk_bf16_f32 v211, v211, v215
    v_mfma_f32_16x16x32_bf16 v[60:63], v[168:171], v[180:183], v[60:63]
    s_waitcnt lgkmcnt(7)
    ds_read_b64 v[100:101], v8 offset:72
    s_add_u32 s7, s7, 3072
    v_mfma_f32_16x16x32_bf16 v[48:51], v[76:79], v[72:75], v[48:51]
    s_waitcnt lgkmcnt(7)
    ds_read_b64 v[102:103], v8 offset:64
    buffer_load_dwordx4 a[84:87], v4, s[36:39], s7 offen offset:0 sc1
    v_mfma_f32_16x16x32_bf16 v[52:55], v[76:79], v[80:83], v[52:55]
    s_waitcnt lgkmcnt(6)
    ds_read_b128 v[104:107], v9 offset:2976
    v_mfma_f32_16x16x32_bf16 v[48:51], v[84:87], v[80:83], v[48:51]
    s_waitcnt lgkmcnt(6)
    v_mfma_f32_16x16x32_bf16 v[56:59], v[76:79], v[88:91], v[56:59]
    ds_read_b128 v[108:111], v9 offset:3488
    buffer_load_dwordx4 a[88:91], v4, s[36:39], s7 offen offset:1024 sc1
    v_mfma_f32_16x16x32_bf16 v[52:55], v[84:87], v[88:91], v[52:55]
    s_waitcnt lgkmcnt(5)
    v_mfma_f32_16x16x32_bf16 v[48:51], v[92:95], v[88:91], v[48:51]
    s_waitcnt lgkmcnt(4)
    ds_read_b128 v[112:115], v9 offset:4000
    v_mfma_f32_16x16x32_bf16 v[60:63], v[76:79], v[96:99], v[60:63]
    ds_read2_b32 v[116:117], v20 offset0:3 offset1:2
    v_mfma_f32_16x16x32_bf16 v[56:59], v[84:87], v[96:99], v[56:59]
    ds_read2_b32 v[118:119], v20 offset0:1 offset1:0
    v_mfma_f32_16x16x32_bf16 v[52:55], v[92:95], v[96:99], v[52:55]
    s_waitcnt lgkmcnt(5)
    ds_read2_b32 v[120:121], v20 offset0:19 offset1:18
    buffer_load_dwordx4 a[92:95], v4, s[36:39], s7 offen offset:2048 sc1
    v_mfma_f32_16x16x32_bf16 v[48:51], v[100:103], v[96:99], v[48:51]
    s_waitcnt lgkmcnt(5)
    v_mfma_f32_16x16x32_bf16 v[60:63], v[84:87], v[104:107], v[60:63]
    ds_read2_b32 v[122:123], v20 offset0:17 offset1:16
    v_mfma_f32_16x16x32_bf16 v[56:59], v[92:95], v[104:107], v[56:59]
    ds_read2_b32 v[124:125], v20 offset0:35 offset1:34
    v_mfma_f32_16x16x32_bf16 v[52:55], v[100:103], v[104:107], v[52:55]
    s_waitcnt lgkmcnt(6)
    ds_read2_b32 v[126:127], v20 offset0:33 offset1:32
    v_mfma_f32_16x16x32_bf16 v[60:63], v[92:95], v[108:111], v[60:63]
    ds_read2_b32 v[128:129], v20 offset0:51 offset1:50
    v_mfma_f32_16x16x32_bf16 v[56:59], v[100:103], v[108:111], v[56:59]
    s_waitcnt lgkmcnt(7)
    ds_read2_b32 v[130:131], v20 offset0:49 offset1:48
    s_add_u32 s7, s7, 3072
    v_mfma_f32_16x16x32_bf16 v[60:63], v[100:103], v[112:115], v[60:63]
    s_waitcnt lgkmcnt(6)
    ds_read_b128 v[132:135], v9 offset:864
    buffer_load_dwordx4 a[96:99], v4, s[36:39], s7 offen offset:0 sc1
    v_mfma_f32_16x16x32_bf16 v[48:51], v[184:187], v[116:119], v[48:51]
    s_waitcnt vmcnt(9)
    ds_read_b64 v[136:137], v8 offset:1672
    ds_add_rtn_u32 v26, v21, v27 offset:256
    v_mfma_f32_16x16x32_bf16 v[52:55], v[192:195], v[116:119], v[52:55]
    ds_read_b64 v[138:139], v8 offset:1664
    ds_read_b128 v[140:143], v9 offset:1376
    v_mfma_f32_16x16x32_bf16 v[56:59], v[200:203], v[116:119], v[56:59]
    ds_read_b64 v[144:145], v8 offset:1160
    v_mfma_f32_16x16x32_bf16 v[60:63], v[208:211], v[116:119], v[60:63]
Lwarm2_1:
    s_cbranch_execz Lwarm2_2
    s_waitcnt lgkmcnt(10)
    ds_read_b64 v[146:147], v8 offset:1152
    buffer_load_dwordx4 a[100:103], v4, s[36:39], s7 offen offset:1024 sc1
    v_mfma_f32_16x16x32_bf16 v[52:55], v[184:187], v[120:123], v[52:55]
    ds_read_b128 v[148:151], v9 offset:1888
    v_mfma_f32_16x16x32_bf16 v[56:59], v[192:195], v[120:123], v[56:59]
    ds_read_b64 v[152:153], v8 offset:648
    v_mfma_f32_16x16x32_bf16 v[60:63], v[200:203], v[120:123], v[60:63]
    s_waitcnt lgkmcnt(11)
    ds_read_b64 v[154:155], v8 offset:640
    s_waitcnt lgkmcnt(7)
    v_xor_b32 v26, 2, v26
    v_mfma_f32_16x16x32_bf16 v[56:59], v[184:187], v[124:127], v[56:59]
    ds_read_b128 v[156:159], v9 offset:2400
    v_lshl_add_u32 v26, v26, 29, v30
    v_mfma_f32_16x16x32_bf16 v[60:63], v[192:195], v[124:127], v[60:63]
    buffer_atomic_add v25, v26, s[36:39], s68 offen offset:4 sc1
    v_mfma_f32_16x16x32_bf16 v[60:63], v[184:187], v[128:131], v[60:63]
    s_waitcnt lgkmcnt(7)
    ds_read_b64 v[160:161], v8 offset:136
    buffer_load_dwordx4 a[104:107], v4, s[36:39], s7 offen offset:2048 sc1
    v_mfma_f32_16x16x32_bf16 v[48:51], v[136:139], v[132:135], v[48:51]
    s_waitcnt lgkmcnt(7)
    ds_read_b64 v[162:163], v8 offset:128
    v_mfma_f32_16x16x32_bf16 v[52:55], v[136:139], v[140:143], v[52:55]
    s_waitcnt lgkmcnt(6)
    ds_read_b128 v[164:167], v9 offset:2912
    v_mfma_f32_16x16x32_bf16 v[48:51], v[144:147], v[140:143], v[48:51]
    s_waitcnt lgkmcnt(6)
    v_mfma_f32_16x16x32_bf16 v[56:59], v[136:139], v[148:151], v[56:59]
    ds_read_b128 v[168:171], v9 offset:3424
    v_mfma_f32_16x16x32_bf16 v[52:55], v[144:147], v[148:151], v[52:55]
    s_waitcnt lgkmcnt(5)
    ds_read_b128 v[172:175], v9 offset:3936
    s_add_u32 s7, s7, 3072
    v_mfma_f32_16x16x32_bf16 v[48:51], v[152:155], v[148:151], v[48:51]
    s_waitcnt lgkmcnt(5)
    ds_read_b128 v[176:179], v9 offset:800
    buffer_load_dwordx4 a[108:111], v4, s[36:39], s7 offen offset:0 sc1
    v_mfma_f32_16x16x32_bf16 v[60:63], v[136:139], v[156:159], v[60:63]
    ds_read_b64 v[180:181], v8 offset:1736
    ds_read_b64 v[182:183], v8 offset:1728
    v_mfma_f32_16x16x32_bf16 v[56:59], v[144:147], v[156:159], v[56:59]
    ds_read_b128 v[72:75], v9 offset:1312
    v_mfma_f32_16x16x32_bf16 v[52:55], v[152:155], v[156:159], v[52:55]
    s_waitcnt lgkmcnt(7)
    ds_read_b64 v[76:77], v8 offset:1224
    v_mfma_f32_16x16x32_bf16 v[48:51], v[160:163], v[156:159], v[48:51]
    s_waitcnt lgkmcnt(7)
    ds_read_b64 v[78:79], v8 offset:1216
    buffer_load_dwordx4 a[112:115], v4, s[36:39], s7 offen offset:1024 sc1
    v_mfma_f32_16x16x32_bf16 v[60:63], v[144:147], v[164:167], v[60:63]
    ds_read_b128 v[80:83], v9 offset:1824
    v_mfma_f32_16x16x32_bf16 v[56:59], v[152:155], v[164:167], v[56:59]
    ds_read_b64 v[84:85], v8 offset:712
    v_mfma_f32_16x16x32_bf16 v[52:55], v[160:163], v[164:167], v[52:55]
    s_waitcnt lgkmcnt(9)
    ds_read_b64 v[86:87], v8 offset:704
    v_mfma_f32_16x16x32_bf16 v[60:63], v[152:155], v[168:171], v[60:63]
    ds_read_b128 v[88:91], v9 offset:2336
    v_mfma_f32_16x16x32_bf16 v[56:59], v[160:163], v[168:171], v[56:59]
    s_waitcnt lgkmcnt(10)
    ds_read_b64 v[92:93], v8 offset:200
    buffer_load_dwordx4 a[116:119], v4, s[36:39], s7 offen offset:2048 sc1
    v_mfma_f32_16x16x32_bf16 v[60:63], v[160:163], v[172:175], v[60:63]
    s_waitcnt lgkmcnt(8)
    v_mfma_f32_16x16x32_bf16 v[48:51], v[180:183], v[176:179], v[48:51]
    s_waitcnt lgkmcnt(7)
    ds_read_b64 v[94:95], v8 offset:192
    v_mfma_f32_16x16x32_bf16 v[52:55], v[180:183], v[72:75], v[52:55]
    s_waitcnt lgkmcnt(6)
    ds_read_b128 v[96:99], v9 offset:2848
    v_mfma_f32_16x16x32_bf16 v[48:51], v[76:79], v[72:75], v[48:51]
    s_waitcnt lgkmcnt(6)
    v_mfma_f32_16x16x32_bf16 v[56:59], v[180:183], v[80:83], v[56:59]
    ds_read_b128 v[100:103], v9 offset:3360
    v_mfma_f32_16x16x32_bf16 v[52:55], v[76:79], v[80:83], v[52:55]
    s_waitcnt lgkmcnt(5)
    ds_read_b128 v[104:107], v9 offset:3872
    ds_read_b128 v[108:111], v9 offset:736
    v_mfma_f32_16x16x32_bf16 v[48:51], v[84:87], v[80:83], v[48:51]
    s_waitcnt lgkmcnt(6)
    ds_read_b64 v[112:113], v8 offset:1800
    v_mfma_f32_16x16x32_bf16 v[60:63], v[180:183], v[88:91], v[60:63]
    s_barrier
    ds_read_b64 v[114:115], v8 offset:1792
    ds_read_b128 v[232:235], v29 offset:0
    v_mfma_f32_16x16x32_bf16 v[56:59], v[76:79], v[88:91], v[56:59]
    ds_read_b128 v[116:119], v9 offset:1248
    ds_read_b128 v[236:239], v29 offset:1024
    v_mfma_f32_16x16x32_bf16 v[52:55], v[84:87], v[88:91], v[52:55]
    s_waitcnt lgkmcnt(9)
    ds_read_b64 v[120:121], v8 offset:1288
    ds_read_b128 v[240:243], v29 offset:2048
    v_mfma_f32_16x16x32_bf16 v[48:51], v[92:95], v[88:91], v[48:51]
    s_waitcnt lgkmcnt(10)
    ds_read_b64 v[122:123], v8 offset:1280
    ds_read_b128 v[244:247], v29 offset:3072
    v_mfma_f32_16x16x32_bf16 v[60:63], v[76:79], v[96:99], v[60:63]
    s_add_u32 m0, s12, 81920
    ds_read_b128 v[124:127], v9 offset:1760
    s_add_u32 s54, s11, 0
    v_mfma_f32_16x16x32_bf16 v[56:59], v[84:87], v[96:99], v[56:59]
    ds_read_b64 v[128:129], v8 offset:776
    buffer_load_dwordx4 v4, s[36:39], s54 offen offset:0 sc1 lds
    v_mfma_f32_16x16x32_bf16 v[52:55], v[92:95], v[96:99], v[52:55]
    s_waitcnt lgkmcnt(13)
    ds_read_b64 v[130:131], v8 offset:768
    buffer_load_dwordx4 v4, s[36:39], s54 offen offset:1024 sc1 lds
    v_mfma_f32_16x16x32_bf16 v[60:63], v[84:87], v[100:103], v[60:63]
    ds_read_b128 v[132:135], v9 offset:2272
    buffer_load_dwordx4 v4, s[36:39], s54 offen offset:2048 sc1 lds
    v_mfma_f32_16x16x32_bf16 v[56:59], v[92:95], v[100:103], v[56:59]
    s_waitcnt lgkmcnt(14)
    ds_read_b64 v[136:137], v8 offset:264
    buffer_load_dwordx4 v4, s[36:39], s54 offen offset:3072 sc1 lds
    v_mfma_f32_16x16x32_bf16 v[60:63], v[92:95], v[104:107], v[60:63]
    s_waitcnt lgkmcnt(12)
    v_mfma_f32_16x16x32_bf16 v[48:51], v[112:115], v[108:111], v[48:51]
    s_waitcnt lgkmcnt(10)
    ds_read_b64 v[138:139], v8 offset:256
    s_add_u32 m0, s12, 86016
    v_mfma_f32_16x16x32_bf16 v[52:55], v[112:115], v[116:119], v[52:55]
    s_waitcnt lgkmcnt(7)
    ds_read_b128 v[140:143], v9 offset:2784
    s_add_u32 s54, s11, 4096
    v_mfma_f32_16x16x32_bf16 v[48:51], v[120:123], v[116:119], v[48:51]
    s_waitcnt lgkmcnt(6)
    buffer_load_dwordx4 v4, s[36:39], s54 offen offset:0 sc1 lds
    buffer_load_dwordx4 v4, s[36:39], s54 offen offset:1024 sc1 lds
    v_mfma_f32_16x16x32_bf16 v[56:59], v[112:115], v[124:127], v[56:59]
    v_mfma_f32_16x16x32_bf16 v[52:55], v[120:123], v[124:127], v[52:55]
    s_waitcnt lgkmcnt(4)
    ds_read_b128 v[144:147], v9 offset:3296
    buffer_load_dwordx4 v4, s[36:39], s54 offen offset:2048 sc1 lds
    v_mfma_f32_16x16x32_bf16 v[48:51], v[128:131], v[124:127], v[48:51]
    s_waitcnt lgkmcnt(4)
    v_mfma_f32_16x16x32_bf16 v[60:63], v[112:115], v[132:135], v[60:63]
    ds_read_b128 v[148:151], v9 offset:3808
    buffer_load_dwordx4 v4, s[36:39], s54 offen offset:3072 sc1 lds
    v_mfma_f32_16x16x32_bf16 v[56:59], v[120:123], v[132:135], v[56:59]
    v_mfma_f32_16x16x32_bf16 v[52:55], v[128:131], v[132:135], v[52:55]
    s_waitcnt lgkmcnt(3)
    s_add_u32 m0, s12, 90112
    s_add_u32 s54, s11, 8192
    v_mfma_f32_16x16x32_bf16 v[48:51], v[136:139], v[132:135], v[48:51]
    s_waitcnt lgkmcnt(2)
    buffer_load_dwordx4 v4, s[36:39], s54 offen offset:0 sc1 lds
    v_mfma_f32_16x16x32_bf16 v[60:63], v[120:123], v[140:143], v[60:63]
    buffer_load_dwordx4 v4, s[36:39], s54 offen offset:1024 sc1 lds
    v_mfma_f32_16x16x32_bf16 v[56:59], v[128:131], v[140:143], v[56:59]
    v_mfma_f32_16x16x32_bf16 v[52:55], v[136:139], v[140:143], v[52:55]
    s_waitcnt lgkmcnt(1)
    v_mfma_f32_16x16x32_bf16 v[60:63], v[128:131], v[144:147], v[60:63]
    v_mfma_f32_16x16x32_bf16 v[56:59], v[136:139], v[144:147], v[56:59]
    s_waitcnt lgkmcnt(0)
    v_mfma_f32_16x16x32_bf16 v[60:63], v[136:139], v[148:151], v[60:63]
    v_pk_add_f32 v[48:49], v[48:49], v[232:233]
    v_pk_add_f32 v[50:51], v[50:51], v[234:235]
    s_nop 0
    v_pk_add_f32 v[52:53], v[52:53], v[236:237]
    v_pk_add_f32 v[54:55], v[54:55], v[238:239]
    v_cvt_pk_bf16_f32 v248, v48, v49
    v_cvt_pk_bf16_f32 v249, v50, v51
    v_cvt_pk_bf16_f32 v250, v52, v53
    v_cvt_pk_bf16_f32 v251, v54, v55
    s_mov_b32 s55, 8073216
    buffer_store_dwordx4 v[248:251], v28, s[36:39], s55 offen sc1
    v_pk_add_f32 v[56:57], v[56:57], v[240:241]
    v_pk_add_f32 v[58:59], v[58:59], v[242:243]
    v_pk_add_f32 v[60:61], v[60:61], v[244:245]
    v_pk_add_f32 v[62:63], v[62:63], v[246:247]
    v_cvt_pk_bf16_f32 v252, v56, v57
    v_cvt_pk_bf16_f32 v253, v58, v59
    v_cvt_pk_bf16_f32 v254, v60, v61
    v_cvt_pk_bf16_f32 v255, v62, v63
    s_mov_b32 s55, 8114176
    buffer_store_dwordx4 v[252:255], v28, s[36:39], s55 offen sc1
    buffer_load_dwordx4 a[120:123], v4, s[36:39], s8 offen offset:0 sc1
    buffer_load_dwordx4 a[124:127], v4, s[36:39], s8 offen offset:1024 sc1
    buffer_load_dwordx4 a[128:131], v4, s[36:39], s8 offen offset:2048 sc1
    s_add_u32 s8, s8, 3072
    buffer_load_dwordx4 a[132:135], v4, s[36:39], s8 offen offset:0 sc1
    buffer_load_dwordx4 a[136:139], v4, s[36:39], s8 offen offset:1024 sc1
    buffer_load_dwordx4 a[140:143], v4, s[36:39], s8 offen offset:2048 sc1
    v_mov_b32 v24, 0
    buffer_atomic_add v24, v23, s[36:39], s16 offen offset:4 sc0 sc1
    v_mfma_f32_16x16x32_bf16 v[180:183], a[0:3], v[12:15], 0
    v_mfma_f32_16x16x32_bf16 v[184:187], a[4:7], v[12:15], 0
    v_mfma_f32_16x16x32_bf16 v[188:191], a[8:11], v[12:15], 0
    v_mfma_f32_16x16x32_bf16 v[180:183], a[12:15], v[12:15], v[180:183]
    v_mfma_f32_16x16x32_bf16 v[184:187], a[16:19], v[12:15], v[184:187]
    v_mfma_f32_16x16x32_bf16 v[188:191], a[20:23], v[12:15], v[188:191]
    v_mfma_f32_16x16x32_bf16 v[180:183], a[24:27], v[12:15], v[180:183]
    v_mfma_f32_16x16x32_bf16 v[184:187], a[28:31], v[12:15], v[184:187]
    v_mfma_f32_16x16x32_bf16 v[188:191], a[32:35], v[12:15], v[188:191]
    v_mfma_f32_16x16x32_bf16 v[180:183], a[36:39], v[12:15], v[180:183]
    v_mfma_f32_16x16x32_bf16 v[184:187], a[40:43], v[12:15], v[184:187]
    v_mfma_f32_16x16x32_bf16 v[188:191], a[44:47], v[12:15], v[188:191]
    v_mfma_f32_16x16x32_bf16 v[180:183], a[48:51], v[12:15], v[180:183]
    v_mfma_f32_16x16x32_bf16 v[184:187], a[52:55], v[12:15], v[184:187]
    v_mfma_f32_16x16x32_bf16 v[188:191], a[56:59], v[12:15], v[188:191]
    v_mfma_f32_16x16x32_bf16 v[180:183], a[60:63], v[12:15], v[180:183]
    s_waitcnt vmcnt(33)
    v_mfma_f32_16x16x32_bf16 v[184:187], a[64:67], v[12:15], v[184:187]
    s_waitcnt vmcnt(32)
    v_mfma_f32_16x16x32_bf16 v[188:191], a[68:71], v[12:15], v[188:191]
    s_branch Lconvd
Lother:
    v_lshrrev_b32 v3, 4, v1
    s_mov_b32 s68, 1073741824
    s_mov_b32 s36, s34
    s_mov_b32 s37, s35
    s_mov_b32 s38, 268435456
    s_mov_b32 s39, 0x20000
    s_cmp_eq_u32 s45, 2
    s_cselect_b32 s62, s2, 0
    s_cmp_lt_u32 s62, 240
    s_cbranch_scc1 Lnoinit
    s_sub_u32 s62, s2, 240
    s_lshl_b32 s63, s62, 2
    s_add_u32 s63, s63, 288768
    v_min_u32 v62, 1, v1
    v_lshlrev_b32 v62, 30, v62
    v_mov_b32 v5, 0
    buffer_atomic_add v5, v62, s[36:39], s63 offen sc1
    v_lshrrev_b32 v63, 5, v1
    v_lshl_add_u32 v63, v63, 30, v4
    s_mul_i32 s59, s62, 1152
    s_add_u32 s59, s59, 262144
    s_lshl_b32 s62, s62, 9
    s_add_u32 s62, s62, 280576
    s_waitcnt lgkmcnt(0)
    s_add_u32 s60, s44, 0x9E3779B1
    v_mov_b32 v64, s60
    v_mov_b32 v65, s60
    v_mov_b32 v66, s60
    v_mov_b32 v67, s60
    buffer_store_dwordx4 v[64:67], v4, s[36:39], s59 offen sc1
    buffer_store_dwordx4 v[64:67], v63, s[36:39], s62 offen sc1
    s_mov_b32 s62, 240
Lnoinit:
    s_cmp_eq_u32 s45, 3
    s_cbranch_scc1 Lw3
    s_waitcnt vmcnt(0)
    s_cmp_lt_u32 s62, 240
    s_cbranch_scc1 Lnordy
    buffer_store_dword v64, v62, s[36:39], s63 offen sc1
Lnordy:
    s_waitcnt lgkmcnt(0)
    s_add_u32 s44, s44, 0x9E3779B1
    v_mov_b32 v11, s44
    s_barrier
    s_branch Lnostat
Lw3:
    v_and_b32 v32, 3, v1
    v_lshrrev_b32 v33, 2, v1
    v_mul_u32_u24 v5, 6, v33
    v_and_b32 v5, -4, v5
    v_mul_u32_u24 v34, 2592, v32
    v_add_u32 v34, 148224, v34
    v_min_u32 v38, 24, v5
    v_add_u32 v38, 1248, v38
    v_add_u32 v38, v38, v34
    v_add_u32 v34, v34, v5
    v_add_u32 v35, 1280, v34
    v_add_u32 v36, 960, v34
    v_add_u32 v37, 2240, v34
    v_add_u32 v39, 1280, v38
    v_and_b32 v5, 1, v33
    v_mul_u32_u24 v5, 0x0202, v5
    v_lshlrev_b32 v5, 16, v5
    v_add_u32 v40, 0x01000c0c, v5
    v_add_u32 v41, 0x03020c0c, v5
    v_add_u32 v42, 0x05040c0c, v5
    v_mov_b32 v5, 0x0c0c0c0c
    v_cmp_gt_u32 vcc, 5, v33
    v_mul_u32_u24 v46, 16512, v33
    v_lshl_add_u32 v46, v32, 4, v46
    v_cndmask_b32 v43, v5, v40, vcc
    v_cndmask_b32 v44, v5, v41, vcc
    v_cndmask_b32 v45, v5, v42, vcc
    v_cmp_eq_u32 vcc, 5, v33
    v_mov_b32 v5, 0x07060c0c
    v_lshrrev_b32 v48, 1, v3
    v_cndmask_b32 v43, v43, v5, vcc
    v_cmp_gt_u32 vcc, 6, v33
    v_and_b32 v5, 1, v3
    v_mov_b32 v6, 1073741824
    v_cndmask_b32 v47, v6, v46, vcc
    v_lshl_add_u32 v48, v5, 1, v48
    v_lshlrev_b32 v49, 4, v32
    v_add_u32 v49, 158592, v49
    v_lshl_add_u32 v48, v48, 2, v49
    s_lshl_b32 s54, s2, 6
    s_add_u32 s59, s54, 524288
    s_waitcnt lgkmcnt(0)
    s_add_u32 s60, s44, 0x9E3779B1
    v_mov_b32 v143, s60
    v_mov_b32 v147, s60
    v_mov_b32 v151, s60
    v_mov_b32 v155, s60
    v_mov_b32 v159, s60
    v_mov_b32 v163, s60
    v_mov_b32 v167, s60
    v_mov_b32 v171, s60
    v_mov_b32 v175, s60
    v_mov_b32 v179, s60
    v_mov_b32 v183, s60
    v_mov_b32 v187, s60
    v_mov_b32 v191, s60
    v_mov_b32 v195, s60
    s_cmp_lt_u32 s2, 214
    s_cbranch_scc1 Lhasdma
    s_waitcnt vmcnt(0)
Lhasdma:
    s_cmp_ge_u32 s2, 214
    s_cbranch_scc1 Lnodma
    v_add_u32 v5, 0, v1
    v_mul_u32_u24 v6, 2731, v5
    v_lshrrev_b32 v7, 18, v6
    v_lshrrev_b32 v6, 16, v6
    v_mul_u32_u24 v6, 2688, v6
    v_mul_u32_u24 v7, 36864, v7
    v_lshlrev_b32 v5, 4, v5
    v_add3_u32 v196, v5, v6, v7
    v_add_u32 v5, 64, v1
    v_mul_u32_u24 v6, 2731, v5
    v_lshrrev_b32 v7, 18, v6
    v_lshrrev_b32 v6, 16, v6
    v_mul_u32_u24 v6, 2688, v6
    v_mul_u32_u24 v7, 36864, v7
    v_lshlrev_b32 v5, 4, v5
    v_add3_u32 v197, v5, v6, v7
    v_add_u32 v5, 128, v1
    v_mul_u32_u24 v6, 2731, v5
    v_lshrrev_b32 v7, 18, v6
    v_lshrrev_b32 v6, 16, v6
    v_mul_u32_u24 v6, 2688, v6
    v_mul_u32_u24 v7, 36864, v7
    v_lshlrev_b32 v5, 4, v5
    v_add3_u32 v198, v5, v6, v7
    s_add_u32 s61, s56, 0
    s_min_u32 s53, s61, 639
    s_lshr_b32 s50, s53, 5
    s_bfe_u32 s51, s53, 0x20003
    s_and_b32 s52, s53, 7
    s_lshl3_add_u32 s53, s50, s51
    s_lshl_b32 s53, s53, 5
    s_add_u32 s53, s53, s52
    s_mul_i32 s53, s53, 384
    v_add_u32 v5, s53, v196
    v_add_u32 v6, s53, v197
    v_add_u32 v7, s53, v198
    s_mov_b32 m0, 129792
    s_mul_i32 s66, s50, 12
    global_load_lds_dwordx4 v5, s[24:25]
    s_mov_b32 m0, 130816
    s_add_u32 s66, s66, s51
    global_load_lds_dwordx4 v6, s[24:25]
    s_mov_b32 m0, 131840
    s_lshl_b32 s66, s66, 8
    global_load_lds_dwordx4 v7, s[24:25]
    s_mov_b32 m0, 132864
    s_mul_i32 s50, s52, 491520
    global_load_lds_dwordx4 v5, s[26:27]
    s_mov_b32 m0, 133888
    s_add_u32 s66, s66, s50
    global_load_lds_dwordx4 v6, s[26:27]
    s_mov_b32 m0, 134912
    s_add_u32 s66, s66, 4059136
    global_load_lds_dwordx4 v7, s[26:27]
    s_mul_i32 s51, s51, 4608
    s_lshl_b32 s22, s52, 7
    s_add_u32 s22, s22, s51
    s_add_u32 s22, s22, 262160
    s_cmp_lt_u32 s61, 640
    s_cselect_b32 s22, s22, 1073741824
    s_add_u32 s61, s56, 1
    s_min_u32 s53, s61, 639
    s_lshr_b32 s50, s53, 5
    s_bfe_u32 s51, s53, 0x20003
    s_and_b32 s52, s53, 7
    s_lshl3_add_u32 s53, s50, s51
    s_lshl_b32 s53, s53, 5
    s_add_u32 s53, s53, s52
    s_mul_i32 s53, s53, 384
    v_add_u32 v5, s53, v196
    v_add_u32 v6, s53, v197
    v_add_u32 v7, s53, v198
    s_mov_b32 m0, 135936
    s_mul_i32 s67, s50, 12
    global_load_lds_dwordx4 v5, s[24:25]
    s_mov_b32 m0, 136960
    s_add_u32 s67, s67, s51
    global_load_lds_dwordx4 v6, s[24:25]
    s_mov_b32 m0, 137984
    s_lshl_b32 s67, s67, 8
    global_load_lds_dwordx4 v7, s[24:25]
    s_mov_b32 m0, 139008
    s_mul_i32 s50, s52, 491520
    global_load_lds_dwordx4 v5, s[26:27]
    s_mov_b32 m0, 140032
    s_add_u32 s67, s67, s50
    global_load_lds_dwordx4 v6, s[26:27]
    s_mov_b32 m0, 141056
    s_add_u32 s67, s67, 4059136
    global_load_lds_dwordx4 v7, s[26:27]
    s_mul_i32 s51, s51, 4608
    s_lshl_b32 s23, s52, 7
    s_add_u32 s23, s23, s51
    s_add_u32 s23, s23, 262160
    s_cmp_lt_u32 s61, 640
    s_cselect_b32 s23, s23, 1073741824
    s_add_u32 s61, s56, 2
    s_min_u32 s53, s61, 639
    s_lshr_b32 s50, s53, 5
    s_bfe_u32 s51, s53, 0x20003
    s_and_b32 s52, s53, 7
    s_lshl3_add_u32 s53, s50, s51
    s_lshl_b32 s53, s53, 5
    s_add_u32 s53, s53, s52
    s_mul_i32 s53, s53, 384
    v_add_u32 v5, s53, v196
    v_add_u32 v6, s53, v197
    v_add_u32 v7, s53, v198
    s_mov_b32 m0, 142080
    s_mul_i32 s3, s50, 12
    global_load_lds_dwordx4 v5, s[24:25]
    s_mov_b32 m0, 143104
    s_add_u32 s3, s3, s51
    global_load_lds_dwordx4 v6, s[24:25]
    s_mov_b32 m0, 144128
    s_lshl_b32 s3, s3, 8
    global_load_lds_dwordx4 v7, s[24:25]
    s_mov_b32 m0, 145152
    s_mul_i32 s50, s52, 491520
    global_load_lds_dwordx4 v5, s[26:27]
    s_mov_b32 m0, 146176
    s_add_u32 s3, s3, s50
    global_load_lds_dwordx4 v6, s[26:27]
    s_mov_b32 m0, 147200
    s_add_u32 s3, s3, 4059136
    global_load_lds_dwordx4 v7, s[26:27]
    s_mul_i32 s51, s51, 4608
    s_lshl_b32 s64, s52, 7
    s_add_u32 s64, s64, s51
    s_add_u32 s64, s64, 262160
    s_cmp_lt_u32 s61, 640
    s_cselect_b32 s64, s64, 1073741824
    s_waitcnt vmcnt(18)
Lnodma:
    s_add_u32 s44, s44, 0x9E3779B1
    v_mov_b32 v11, s44
    s_barrier
    ds_read2_b32 v[84:85], v34 offset0:0 offset1:1
    ds_read2_b32 v[86:87], v35 offset0:0 offset1:1
    ds_read2_b32 v[88:89], v34 offset0:24 offset1:25
    ds_read2_b32 v[90:91], v35 offset0:24 offset1:25
    ds_read2_b32 v[92:93], v34 offset0:48 offset1:49
    ds_read2_b32 v[94:95], v35 offset0:48 offset1:49
    ds_read2_b32 v[96:97], v34 offset0:72 offset1:73
    ds_read2_b32 v[98:99], v35 offset0:72 offset1:73
    ds_read2_b32 v[100:101], v34 offset0:96 offset1:97
    ds_read2_b32 v[102:103], v35 offset0:96 offset1:97
    ds_read2_b32 v[104:105], v34 offset0:120 offset1:121
    ds_read2_b32 v[106:107], v35 offset0:120 offset1:121
    ds_read2_b32 v[108:109], v34 offset0:144 offset1:145
    ds_read2_b32 v[110:111], v35 offset0:144 offset1:145
    ds_read2_b32 v[112:113], v34 offset0:168 offset1:169
    ds_read2_b32 v[114:115], v35 offset0:168 offset1:169
    ds_read2_b32 v[116:117], v34 offset0:192 offset1:193
    ds_read2_b32 v[118:119], v35 offset0:192 offset1:193
    ds_read2_b32 v[120:121], v34 offset0:216 offset1:217
    ds_read2_b32 v[122:123], v35 offset0:216 offset1:217
    ds_read2_b32 v[124:125], v36 offset0:0 offset1:1
    ds_read2_b32 v[126:127], v37 offset0:0 offset1:1
    ds_read2_b32 v[128:129], v36 offset0:24 offset1:25
    ds_read2_b32 v[130:131], v37 offset0:24 offset1:25
    ds_read2_b32 v[132:133], v36 offset0:48 offset1:49
    ds_read2_b32 v[134:135], v37 offset0:48 offset1:49
    ds_read2_b32 v[136:137], v38 offset0:0 offset1:1
    ds_read2_b32 v[138:139], v39 offset0:0 offset1:1
    s_waitcnt lgkmcnt(15)
    v_perm_b32 v56, v85, v84, v40
    v_perm_b32 v57, v87, v86, v40
    v_perm_b32 v58, v85, v84, v41
    v_perm_b32 v59, v87, v86, v41
    v_perm_b32 v60, v85, v84, v42
    v_perm_b32 v61, v87, v86, v42
    v_pk_mul_f32 v[52:53], v[56:57], v[56:57]
    v_cvt_pk_bf16_f32 v140, v56, v57
    v_pk_fma_f32 v[52:53], v[58:59], v[58:59], v[52:53]
    v_pk_add_f32 v[50:51], v[56:57], v[58:59]
    v_cvt_pk_bf16_f32 v141, v58, v59
    v_pk_fma_f32 v[52:53], v[60:61], v[60:61], v[52:53]
    v_pk_add_f32 v[50:51], v[50:51], v[60:61]
    v_cvt_pk_bf16_f32 v142, v60, v61
    v_perm_b32 v62, v89, v88, v40
    v_perm_b32 v63, v91, v90, v40
    v_perm_b32 v64, v89, v88, v41
    v_perm_b32 v65, v91, v90, v41
    v_perm_b32 v66, v89, v88, v42
    v_perm_b32 v67, v91, v90, v42
    v_pk_fma_f32 v[52:53], v[62:63], v[62:63], v[52:53]
    v_pk_add_f32 v[50:51], v[50:51], v[62:63]
    v_cvt_pk_bf16_f32 v144, v62, v63
    v_pk_fma_f32 v[52:53], v[64:65], v[64:65], v[52:53]
    v_pk_add_f32 v[50:51], v[50:51], v[64:65]
    v_cvt_pk_bf16_f32 v145, v64, v65
    v_pk_fma_f32 v[52:53], v[66:67], v[66:67], v[52:53]
    v_pk_add_f32 v[50:51], v[50:51], v[66:67]
    v_cvt_pk_bf16_f32 v146, v66, v67
    v_perm_b32 v56, v93, v92, v40
    v_perm_b32 v57, v95, v94, v40
    v_perm_b32 v58, v93, v92, v41
    v_perm_b32 v59, v95, v94, v41
    v_perm_b32 v60, v93, v92, v42
    v_perm_b32 v61, v95, v94, v42
    v_pk_fma_f32 v[52:53], v[56:57], v[56:57], v[52:53]
    v_pk_add_f32 v[50:51], v[50:51], v[56:57]
    v_cvt_pk_bf16_f32 v148, v56, v57
    v_pk_fma_f32 v[52:53], v[58:59], v[58:59], v[52:53]
    v_pk_add_f32 v[50:51], v[50:51], v[58:59]
    v_cvt_pk_bf16_f32 v149, v58, v59
    v_pk_fma_f32 v[52:53], v[60:61], v[60:61], v[52:53]
    v_pk_add_f32 v[50:51], v[50:51], v[60:61]
    v_cvt_pk_bf16_f32 v150, v60, v61
    v_perm_b32 v62, v97, v96, v40
    v_perm_b32 v63, v99, v98, v40
    v_perm_b32 v64, v97, v96, v41
    v_perm_b32 v65, v99, v98, v41
    v_perm_b32 v66, v97, v96, v42
    v_perm_b32 v67, v99, v98, v42
    v_pk_fma_f32 v[52:53], v[62:63], v[62:63], v[52:53]
    v_pk_add_f32 v[50:51], v[50:51], v[62:63]
    v_cvt_pk_bf16_f32 v152, v62, v63
    v_pk_fma_f32 v[52:53], v[64:65], v[64:65], v[52:53]
    v_pk_add_f32 v[50:51], v[50:51], v[64:65]
    v_cvt_pk_bf16_f32 v153, v64, v65
    v_pk_fma_f32 v[52:53], v[66:67], v[66:67], v[52:53]
    v_pk_add_f32 v[50:51], v[50:51], v[66:67]
    v_cvt_pk_bf16_f32 v154, v66, v67
    v_perm_b32 v56, v101, v100, v40
    v_perm_b32 v57, v103, v102, v40
    v_perm_b32 v58, v101, v100, v41
    v_perm_b32 v59, v103, v102, v41
    v_perm_b32 v60, v101, v100, v42
    v_perm_b32 v61, v103, v102, v42
    v_pk_fma_f32 v[52:53], v[56:57], v[56:57], v[52:53]
    v_pk_add_f32 v[50:51], v[50:51], v[56:57]
    v_cvt_pk_bf16_f32 v156, v56, v57
    v_pk_fma_f32 v[52:53], v[58:59], v[58:59], v[52:53]
    v_pk_add_f32 v[50:51], v[50:51], v[58:59]
    v_cvt_pk_bf16_f32 v157, v58, v59
    v_pk_fma_f32 v[52:53], v[60:61], v[60:61], v[52:53]
    v_pk_add_f32 v[50:51], v[50:51], v[60:61]
    v_cvt_pk_bf16_f32 v158, v60, v61
    v_perm_b32 v62, v105, v104, v40
    v_perm_b32 v63, v107, v106, v40
    v_perm_b32 v64, v105, v104, v41
    v_perm_b32 v65, v107, v106, v41
    v_perm_b32 v66, v105, v104, v42
    v_perm_b32 v67, v107, v106, v42
    v_pk_fma_f32 v[52:53], v[62:63], v[62:63], v[52:53]
    v_pk_add_f32 v[50:51], v[50:51], v[62:63]
    v_cvt_pk_bf16_f32 v160, v62, v63
    v_pk_fma_f32 v[52:53], v[64:65], v[64:65], v[52:53]
    v_pk_add_f32 v[50:51], v[50:51], v[64:65]
    v_cvt_pk_bf16_f32 v161, v64, v65
    v_pk_fma_f32 v[52:53], v[66:67], v[66:67], v[52:53]
    v_pk_add_f32 v[50:51], v[50:51], v[66:67]
    v_cvt_pk_bf16_f32 v162, v66, v67
    v_perm_b32 v56, v109, v108, v40
    s_waitcnt lgkmcnt(14)
    v_perm_b32 v57, v111, v110, v40
    v_perm_b32 v58, v109, v108, v41
    v_perm_b32 v59, v111, v110, v41
    v_perm_b32 v60, v109, v108, v42
    v_perm_b32 v61, v111, v110, v42
    v_pk_fma_f32 v[52:53], v[56:57], v[56:57], v[52:53]
    v_pk_add_f32 v[50:51], v[50:51], v[56:57]
    v_cvt_pk_bf16_f32 v164, v56, v57
    v_pk_fma_f32 v[52:53], v[58:59], v[58:59], v[52:53]
    v_pk_add_f32 v[50:51], v[50:51], v[58:59]
    v_cvt_pk_bf16_f32 v165, v58, v59
    v_pk_fma_f32 v[52:53], v[60:61], v[60:61], v[52:53]
    v_pk_add_f32 v[50:51], v[50:51], v[60:61]
    v_cvt_pk_bf16_f32 v166, v60, v61
    s_waitcnt lgkmcnt(13)
    v_perm_b32 v62, v113, v112, v40
    s_waitcnt lgkmcnt(12)
    v_perm_b32 v63, v115, v114, v40
    v_perm_b32 v64, v113, v112, v41
    v_perm_b32 v65, v115, v114, v41
    v_perm_b32 v66, v113, v112, v42
    v_perm_b32 v67, v115, v114, v42
    v_pk_fma_f32 v[52:53], v[62:63], v[62:63], v[52:53]
    v_pk_add_f32 v[50:51], v[50:51], v[62:63]
    v_cvt_pk_bf16_f32 v168, v62, v63
    v_pk_fma_f32 v[52:53], v[64:65], v[64:65], v[52:53]
    v_pk_add_f32 v[50:51], v[50:51], v[64:65]
    v_cvt_pk_bf16_f32 v169, v64, v65
    v_pk_fma_f32 v[52:53], v[66:67], v[66:67], v[52:53]
    v_pk_add_f32 v[50:51], v[50:51], v[66:67]
    v_cvt_pk_bf16_f32 v170, v66, v67
    s_waitcnt lgkmcnt(11)
    v_perm_b32 v56, v117, v116, v40
    s_waitcnt lgkmcnt(10)
    v_perm_b32 v57, v119, v118, v40
    v_perm_b32 v58, v117, v116, v41
    v_perm_b32 v59, v119, v118, v41
    v_perm_b32 v60, v117, v116, v42
    v_perm_b32 v61, v119, v118, v42
    v_pk_fma_f32 v[52:53], v[56:57], v[56:57], v[52:53]
    v_pk_add_f32 v[50:51], v[50:51], v[56:57]
    v_cvt_pk_bf16_f32 v172, v56, v57
    v_pk_fma_f32 v[52:53], v[58:59], v[58:59], v[52:53]
    v_pk_add_f32 v[50:51], v[50:51], v[58:59]
    v_cvt_pk_bf16_f32 v173, v58, v59
    v_pk_fma_f32 v[52:53], v[60:61], v[60:61], v[52:53]
    v_pk_add_f32 v[50:51], v[50:51], v[60:61]
    v_cvt_pk_bf16_f32 v174, v60, v61
    s_waitcnt lgkmcnt(9)
    v_perm_b32 v62, v121, v120, v40
    s_waitcnt lgkmcnt(8)
    v_perm_b32 v63, v123, v122, v40
    v_perm_b32 v64, v121, v120, v41
    v_perm_b32 v65, v123, v122, v41
    v_perm_b32 v66, v121, v120, v42
    v_perm_b32 v67, v123, v122, v42
    v_pk_fma_f32 v[52:53], v[62:63], v[62:63], v[52:53]
    v_pk_add_f32 v[50:51], v[50:51], v[62:63]
    v_cvt_pk_bf16_f32 v176, v62, v63
    v_pk_fma_f32 v[52:53], v[64:65], v[64:65], v[52:53]
    v_pk_add_f32 v[50:51], v[50:51], v[64:65]
    v_cvt_pk_bf16_f32 v177, v64, v65
    v_pk_fma_f32 v[52:53], v[66:67], v[66:67], v[52:53]
    v_pk_add_f32 v[50:51], v[50:51], v[66:67]
    v_cvt_pk_bf16_f32 v178, v66, v67
    s_waitcnt lgkmcnt(7)
    v_perm_b32 v56, v125, v124, v40
    s_waitcnt lgkmcnt(6)
    v_perm_b32 v57, v127, v126, v40
    v_perm_b32 v58, v125, v124, v41
    v_perm_b32 v59, v127, v126, v41
    v_perm_b32 v60, v125, v124, v42
    v_perm_b32 v61, v127, v126, v42
    v_pk_fma_f32 v[52:53], v[56:57], v[56:57], v[52:53]
    v_pk_add_f32 v[50:51], v[50:51], v[56:57]
    v_cvt_pk_bf16_f32 v180, v56, v57
    v_pk_fma_f32 v[52:53], v[58:59], v[58:59], v[52:53]
    v_pk_add_f32 v[50:51], v[50:51], v[58:59]
    v_cvt_pk_bf16_f32 v181, v58, v59
    v_pk_fma_f32 v[52:53], v[60:61], v[60:61], v[52:53]
    v_pk_add_f32 v[50:51], v[50:51], v[60:61]
    v_cvt_pk_bf16_f32 v182, v60, v61
    s_waitcnt lgkmcnt(5)
    v_perm_b32 v62, v129, v128, v40
    s_waitcnt lgkmcnt(4)
    v_perm_b32 v63, v131, v130, v40
    v_perm_b32 v64, v129, v128, v41
    v_perm_b32 v65, v131, v130, v41
    v_perm_b32 v66, v129, v128, v42
    v_perm_b32 v67, v131, v130, v42
    v_pk_fma_f32 v[52:53], v[62:63], v[62:63], v[52:53]
    v_pk_add_f32 v[50:51], v[50:51], v[62:63]
    v_cvt_pk_bf16_f32 v184, v62, v63
    v_pk_fma_f32 v[52:53], v[64:65], v[64:65], v[52:53]
    v_pk_add_f32 v[50:51], v[50:51], v[64:65]
    v_cvt_pk_bf16_f32 v185, v64, v65
    v_pk_fma_f32 v[52:53], v[66:67], v[66:67], v[52:53]
    v_pk_add_f32 v[50:51], v[50:51], v[66:67]
    v_cvt_pk_bf16_f32 v186, v66, v67
    s_waitcnt lgkmcnt(3)
    v_perm_b32 v56, v133, v132, v40
    s_waitcnt lgkmcnt(2)
    v_perm_b32 v57, v135, v134, v40
    v_perm_b32 v58, v133, v132, v41
    v_perm_b32 v59, v135, v134, v41
    v_perm_b32 v60, v133, v132, v42
    v_perm_b32 v61, v135, v134, v42
    v_pk_fma_f32 v[52:53], v[56:57], v[56:57], v[52:53]
    v_pk_add_f32 v[50:51], v[50:51], v[56:57]
    v_cvt_pk_bf16_f32 v188, v56, v57
    v_pk_fma_f32 v[52:53], v[58:59], v[58:59], v[52:53]
    v_pk_add_f32 v[50:51], v[50:51], v[58:59]
    v_cvt_pk_bf16_f32 v189, v58, v59
    v_pk_fma_f32 v[52:53], v[60:61], v[60:61], v[52:53]
    v_pk_add_f32 v[50:51], v[50:51], v[60:61]
    v_cvt_pk_bf16_f32 v190, v60, v61
    s_waitcnt lgkmcnt(1)
    v_perm_b32 v62, v137, v136, v43
    s_waitcnt lgkmcnt(0)
    v_perm_b32 v63, v139, v138, v43
    v_perm_b32 v64, v137, v136, v44
    v_perm_b32 v65, v139, v138, v44
    v_perm_b32 v66, v137, v136, v45
    v_perm_b32 v67, v139, v138, v45
    v_pk_fma_f32 v[52:53], v[62:63], v[62:63], v[52:53]
    v_pk_add_f32 v[50:51], v[50:51], v[62:63]
    v_cvt_pk_bf16_f32 v192, v62, v63
    v_pk_fma_f32 v[52:53], v[64:65], v[64:65], v[52:53]
    v_pk_add_f32 v[50:51], v[50:51], v[64:65]
    v_cvt_pk_bf16_f32 v193, v64, v65
    v_pk_fma_f32 v[52:53], v[66:67], v[66:67], v[52:53]
    v_pk_add_f32 v[50:51], v[50:51], v[66:67]
    v_cvt_pk_bf16_f32 v194, v66, v67
    v_permlane32_swap_b32 v52, v53
    v_permlane32_swap_b32 v50, v51
    v_add_f32 v52, v52, v53
    v_add_f32 v50, v50, v51
    s_nop 1
    v_permlane16_swap_b32 v50, v52
    v_add_f32 v50, v50, v52
    s_nop 1
    v_add_f32_dpp v50, v50, v50 row_ror:8 row_mask:0xf bank_mask:0xf
    s_nop 1
    v_add_f32_dpp v50, v50, v50 row_ror:4 row_mask:0xf bank_mask:0xf
    ds_write_b32 v48, v50
    ds_read_b128 v[68:71], v49
    buffer_store_dwordx4 v[140:143], v46, s[36:39], s59 offen sc1
    s_add_u32 s59, s59, 264192
    buffer_store_dwordx4 v[144:147], v46, s[36:39], s59 offen sc1
    s_add_u32 s59, s59, 264192
    buffer_store_dwordx4 v[148:151], v46, s[36:39], s59 offen sc1
    s_add_u32 s59, s59, 264192
    buffer_store_dwordx4 v[152:155], v46, s[36:39], s59 offen sc1
    s_add_u32 s59, s59, 264192
    v_mov_b32 v78, 986500301
    v_cmp_gt_u32 vcc, 4, v1
    v_mov_b32 v6, 1073741824
    s_add_u32 s54, s54, 98304
    v_cndmask_b32 v6, v6, v4, vcc
    v_mov_b32 v77, s44
    s_waitcnt lgkmcnt(0)
    v_pk_mul_f32 v[68:69], v[68:69], v[78:79] op_sel_hi:[1,0]
    v_pk_mul_f32 v[70:71], v[70:71], v[78:79] op_sel_hi:[1,0]
    v_pk_fma_f32 v[70:71], v[68:69], v[68:69], v[70:71] neg_lo:[1,0,0] neg_hi:[1,0,0]
    v_cvt_pk_bf16_f32 v76, v68, v69
    v_max_f32 v70, 0, v70
    v_max_f32 v71, 0, v71
    v_cvt_pk_bf16_f32 v70, 0, v70
    v_cvt_pk_bf16_f32 v71, 0, v71
    v_add_f32 v70, 0x3727c5ac, v70
    v_add_f32 v71, 0x3727c5ac, v71
    v_cvt_pk_bf16_f32 v70, 0, v70
    v_cvt_pk_bf16_f32 v71, 0, v71
    v_sqrt_f32 v70, v70
    v_sqrt_f32 v71, v71
    v_cvt_pk_bf16_f32 v70, 0, v70
    v_cvt_pk_bf16_f32 v71, 0, v71
    v_rcp_f32 v74, v70
    v_rcp_f32 v75, v71
    s_nop 0
    buffer_store_dwordx4 v[74:77], v6, s[36:39], s54 offen sc1
    buffer_store_dwordx4 v[156:159], v46, s[36:39], s59 offen sc1
    s_add_u32 s59, s59, 264192
    buffer_store_dwordx4 v[160:163], v46, s[36:39], s59 offen sc1
    s_add_u32 s59, s59, 264192
    buffer_store_dwordx4 v[164:167], v46, s[36:39], s59 offen sc1
    s_add_u32 s59, s59, 264192
    buffer_store_dwordx4 v[168:171], v46, s[36:39], s59 offen sc1
    s_add_u32 s59, s59, 264192
    buffer_store_dwordx4 v[172:175], v46, s[36:39], s59 offen sc1
    s_add_u32 s59, s59, 264192
    buffer_store_dwordx4 v[176:179], v46, s[36:39], s59 offen sc1
    s_add_u32 s59, s59, 264192
    buffer_store_dwordx4 v[180:183], v46, s[36:39], s59 offen sc1
    s_add_u32 s59, s59, 264192
    buffer_store_dwordx4 v[184:187], v46, s[36:39], s59 offen sc1
    s_add_u32 s59, s59, 264192
    buffer_store_dwordx4 v[188:191], v46, s[36:39], s59 offen sc1
    s_add_u32 s59, s59, 264192
    buffer_store_dwordx4 v[192:195], v47, s[36:39], s59 offen sc1
Lnostat:
    s_mov_b32 s40, s30
    s_mov_b32 s41, s31
    s_mov_b32 s42, 2621440
    s_mov_b32 s43, 0x20000
    v_mov_b32 v6, 1073741824
    v_mov_b32 v27, 1
    s_and_b32 s54, s2, 7
    s_lshr_b32 s46, s54, 2
    s_lshr_b32 s60, s55, 2
    s_lshl3_add_u32 s46, s46, s60
    s_and_b32 s47, s54, 3
    s_and_b32 s60, s55, 3
    s_lshl2_add_u32 s47, s47, s60
    s_and_b32 s4, s46, 0
    s_xor_b32 s4, s4, s45
    s_lshr_b32 s48, s47, 3
    s_and_b32 s49, s47, 7
    s_and_b32 s16, s55, 15
    s_mul_i32 s16, s16, 1152
    s_add_u32 s16, s16, 262144
    v_cmp_ne_u32 vcc, 0, v1
    s_nop 1
    v_cndmask_b32 v31, 0, v6, vcc
    v_cmp_gt_u32 vcc, 16, v1
    v_mul_u32_u24 v30, 1152, v1
    s_nop 0
    v_cndmask_b32 v30, v6, v30, vcc
    s_lshr_b32 s59, s47, 1
    s_lshl_b32 s59, s59, 7
    s_and_b32 s60, s46, 3
    s_mul_i32 s60, s60, 1152
    s_add_u32 s59, s59, s60
    s_add_u32 s59, s59, 262144
    s_lshl_b32 s60, s45, 8
    s_max_u32 s60, s60, 128
    s_sub_u32 s60, s60, 128
    v_cmp_gt_u32 vcc, 4, v1
    v_lshl_add_u32 v22, v30, 2, s59
    v_lshl_add_u32 v23, v1, 7, s60
    v_cndmask_b32 v22, v6, v22, vcc
    v_cndmask_b32 v39, v6, v30, vcc
    v_cmp_gt_u32 vcc, 3, v1
    s_cmp_eq_u32 s2, 213
    s_cselect_b32 s60, 3, 1
    v_cndmask_b32 v23, v6, v23, vcc
    v_mov_b32 v25, s60
    v_lshlrev_b32 v21, 2, v1
    v_add_u32 v21, 11392, v21
    s_lshl2_add_u32 s59, s47, s45
    s_mul_i32 s59, s59, 61440
    s_add_u32 s59, s59, 4059136
    s_xor_b32 s6, s4, 0
    s_mul_i32 s6, s6, 15360
    s_add_u32 s6, s6, s59
    s_xor_b32 s7, s4, 1
    s_mul_i32 s7, s7, 15360
    s_add_u32 s7, s7, s59
    s_xor_b32 s8, s4, 2
    s_mul_i32 s8, s8, 15360
    s_add_u32 s8, s8, s59
    s_xor_b32 s9, s4, 3
    s_mul_i32 s9, s9, 15360
    s_add_u32 s9, s9, s59
    s_mul_i32 s12, s45, 10240
    s_mul_i32 s11, s46, 163840
    s_add_u32 s11, s11, s12
    s_add_u32 s11, s11, 7991296
    s_mul_i32 s59, s57, 16640
    s_mul_i32 s60, s57, 4608
    v_and_b32 v5, 3, v2
    v_mul_u32_u24 v8, 4160, v5
    v_lshrrev_b32 v5, 2, v2
    v_lshlrev_b32 v6, 1, v3
    v_sub_u32 v5, v5, v6
    v_add_u32 v5, 7, v5
    v_lshl_add_u32 v8, v5, 3, v8
    v_add_u32 v8, s59, v8
    v_lshl_add_u32 v10, v2, 5, s60
    v_lshl_add_u32 v9, v3, 4, v10
    v_add_u32 v9, 49920, v9
    s_lshl_b32 s59, s57, 12
    s_add_u32 s59, s59, 122880
    v_add_u32 v29, s59, v4
    s_cmp_ge_u32 s2, 214
    s_cbranch_scc1 Lhelp
    v_mov_b32 v6, 0
    v_mov_b32 v7, 0
    v_lshlrev_b32 v60, 3, v1
    v_lshrrev_b32 v80, 2, v1
    v_min_u32 v80, 11, v80
    v_mul_u32_u24 v80, 4160, v80
    v_and_b32 v81, 3, v1
    v_lshl_add_u32 v80, v81, 3, v80
    s_mul_i32 s55, s2, 16512
    s_add_u32 s55, s55, 524288
    s_mov_b32 m0, 49920
    ds_write_b64 v60, v[6:7] offset:49920
    ds_write_b64 v60, v[6:7] offset:54528
    ds_write_b64 v60, v[6:7] offset:59136
    ds_write_b64 v80, v[6:7] offset:0
    ds_write_b64 v60, v[6:7] offset:10624
    ds_write_b64 v60, v[6:7] offset:11136
    v_bfe_u32 v5, v1, 1, 1
    v_mul_u32_u24 v200, 3072, v5
    v_bfe_u32 v5, v1, 2, 2
    v_mul_u32_u24 v5, 384, v5
    v_add_u32 v5, 129792, v5
    v_add_u32 v200, v200, v5
    v_mad_u32_u24 v200, v3, 48, v200
    v_and_b32 v5, 1, v1
    v_lshl_add_u32 v201, v5, 3, v200
    v_lshl_add_u32 v200, v5, 4, v200
    v_mul_u32_u24 v5, 61440, v3
    v_lshl_add_u32 v202, v2, 4, v5
    s_waitcnt vmcnt(15)
    ds_read_b64_tr_b16 a[0:1], v200 offset:0
    ds_read_b64_tr_b16 a[2:3], v200 offset:1536
    ds_read_b64_tr_b16 a[4:5], v200 offset:8
    ds_read_b64_tr_b16 a[6:7], v200 offset:1544
    ds_read_b64_tr_b16 a[8:9], v201 offset:32
    ds_read_b64_tr_b16 a[10:11], v201 offset:1568
    ds_read_b64_tr_b16 a[12:13], v200 offset:192
    ds_read_b64_tr_b16 a[14:15], v200 offset:1728
    ds_read_b64_tr_b16 a[16:17], v200 offset:200
    ds_read_b64_tr_b16 a[18:19], v200 offset:1736
    ds_read_b64_tr_b16 a[20:21], v201 offset:224
    ds_read_b64_tr_b16 a[22:23], v201 offset:1760
    ds_read_b64_tr_b16 a[24:25], v200 offset:6144
    ds_read_b64_tr_b16 a[26:27], v200 offset:7680
    ds_read_b64_tr_b16 a[28:29], v200 offset:6152
    ds_read_b64_tr_b16 a[30:31], v200 offset:7688
    ds_read_b64_tr_b16 a[32:33], v201 offset:6176
    ds_read_b64_tr_b16 a[34:35], v201 offset:7712
    ds_read_b64_tr_b16 a[36:37], v200 offset:6336
    ds_read_b64_tr_b16 a[38:39], v200 offset:7872
    ds_read_b64_tr_b16 a[40:41], v200 offset:6344
    ds_read_b64_tr_b16 a[42:43], v200 offset:7880
Lwarm0_2:
    s_cbranch_execz Lwarm0_3
    ds_read_b64_tr_b16 a[44:45], v201 offset:6368
    ds_read_b64_tr_b16 a[46:47], v201 offset:7904
    ds_read_b64_tr_b16 a[48:49], v200 offset:12288
    ds_read_b64_tr_b16 a[50:51], v200 offset:13824
    ds_read_b64_tr_b16 a[52:53], v200 offset:12296
    ds_read_b64_tr_b16 a[54:55], v200 offset:13832
    ds_read_b64_tr_b16 a[56:57], v201 offset:12320
    ds_read_b64_tr_b16 a[58:59], v201 offset:13856
    ds_read_b64_tr_b16 a[60:61], v200 offset:12480
    ds_read_b64_tr_b16 a[62:63], v200 offset:14016
    ds_read_b64_tr_b16 a[64:65], v200 offset:12488
    ds_read_b64_tr_b16 a[66:67], v200 offset:14024
    ds_read_b64_tr_b16 a[68:69], v201 offset:12512
    ds_read_b64_tr_b16 a[70:71], v201 offset:14048
    s_waitcnt lgkmcnt(15)
    buffer_store_dwordx4 a[0:3], v202, s[36:39], s66 offen offset:0 sc1
    buffer_store_dwordx4 a[4:7], v202, s[36:39], s66 offen offset:1024 sc1
    buffer_store_dwordx4 a[8:11], v202, s[36:39], s66 offen offset:2048 sc1
    s_add_u32 s66, s66, 245760
    buffer_store_dwordx4 a[12:15], v202, s[36:39], s66 offen offset:0 sc1
    buffer_store_dwordx4 a[16:19], v202, s[36:39], s66 offen offset:1024 sc1
    buffer_store_dwordx4 a[20:23], v202, s[36:39], s66 offen offset:2048 sc1
    buffer_store_dwordx4 a[24:27], v202, s[36:39], s67 offen offset:0 sc1
    buffer_store_dwordx4 a[28:31], v202, s[36:39], s67 offen offset:1024 sc1
    buffer_store_dwordx4 a[32:35], v202, s[36:39], s67 offen offset:2048 sc1
    s_add_u32 s67, s67, 245760
    buffer_store_dwordx4 a[36:39], v202, s[36:39], s67 offen offset:0 sc1
    s_waitcnt lgkmcnt(14)
    buffer_store_dwordx4 a[40:43], v202, s[36:39], s67 offen offset:1024 sc1
    s_waitcnt lgkmcnt(12)
    buffer_store_dwordx4 a[44:47], v202, s[36:39], s67 offen offset:2048 sc1
    s_waitcnt lgkmcnt(10)
    buffer_store_dwordx4 a[48:51], v202, s[36:39], s3 offen offset:0 sc1
    s_waitcnt lgkmcnt(8)
    buffer_store_dwordx4 a[52:55], v202, s[36:39], s3 offen offset:1024 sc1
    s_waitcnt lgkmcnt(6)
    buffer_store_dwordx4 a[56:59], v202, s[36:39], s3 offen offset:2048 sc1
    s_add_u32 s3, s3, 245760
    s_waitcnt lgkmcnt(4)
    buffer_store_dwordx4 a[60:63], v202, s[36:39], s3 offen offset:0 sc1
    s_waitcnt lgkmcnt(2)
    buffer_store_dwordx4 a[64:67], v202, s[36:39], s3 offen offset:1024 sc1
    s_waitcnt lgkmcnt(0)
    buffer_store_dwordx4 a[68:71], v202, s[36:39], s3 offen offset:2048 sc1
    s_mov_b32 s51, 288768
    v_lshlrev_b32 v40, 2, v2
    buffer_load_dword v40, v40, s[36:39], s51 offen sc1
    s_mov_b64 exec, 0
    s_branch Lwarm3
Lwarm_ret3:
    s_mov_b64 exec, -1
    s_cmp_ge_u32 s2, 214
    s_cbranch_scc1 Lwarm_reth3
    s_waitcnt vmcnt(0)
    v_cmp_ne_u32 vcc, s44, v40
    s_cbranch_vccnz Lslow5
Lgot6:
    buffer_atomic_add v27, v39, s[36:39], s22 offen sc1
    buffer_atomic_add v27, v39, s[36:39], s23 offen sc1
    buffer_atomic_add v27, v39, s[36:39], s64 offen sc1
    s_mov_b32 s59, 98304
    s_add_u32 s54, s55, 0
    buffer_load_dwordx4 v[84:87], v4, s[36:39], s54 offen offset:0 sc1
    buffer_load_dwordx4 v[88:91], v4, s[36:39], s54 offen offset:1024 sc1
    buffer_load_dwordx4 v[92:95], v4, s[36:39], s54 offen offset:2048 sc1
    buffer_load_dwordx4 v[96:99], v4, s[36:39], s54 offen offset:3072 sc1
    s_add_u32 s54, s59, 0
    buffer_load_dwordx4 v[148:151], v4, s[36:39], s54 offen offset:0 sc1
    buffer_load_dwordx4 v[152:155], v4, s[36:39], s54 offen offset:1024 sc1
    buffer_load_dwordx4 v[156:159], v4, s[36:39], s54 offen offset:2048 sc1
    buffer_load_dwordx4 v[160:163], v4, s[36:39], s54 offen offset:3072 sc1
    s_add_u32 s54, s55, 4096
    buffer_load_dwordx4 v[100:103], v4, s[36:39], s54 offen offset:0 sc1
    buffer_load_dwordx4 v[104:107], v4, s[36:39], s54 offen offset:1024 sc1
    buffer_load_dwordx4 v[108:111], v4, s[36:39], s54 offen offset:2048 sc1
    s_add_u32 s54, s59, 4096
    buffer_load_dwordx4 v[164:167], v4, s[36:39], s54 offen offset:0 sc1
    buffer_load_dwordx4 v[168:171], v4, s[36:39], s54 offen offset:1024 sc1
    buffer_load_dwordx4 v[172:175], v4, s[36:39], s54 offen offset:2048 sc1
    s_waitcnt vmcnt(13)
    v_xor_b32 v5, s44, v87
    s_waitcnt vmcnt(12)
    v_bitop3_b32 v5, v5, v91, s44 bitop3:0xf6
    s_waitcnt vmcnt(11)
    v_bitop3_b32 v5, v5, v95, s44 bitop3:0xf6
    s_waitcnt vmcnt(10)
    v_bitop3_b32 v5, v5, v99, s44 bitop3:0xf6
    s_waitcnt vmcnt(9)
    v_bitop3_b32 v5, v5, v151, s44 bitop3:0xf6
    s_waitcnt vmcnt(8)
    v_bitop3_b32 v5, v5, v155, s44 bitop3:0xf6
    s_waitcnt vmcnt(7)
    v_bitop3_b32 v5, v5, v159, s44 bitop3:0xf6
    s_waitcnt vmcnt(6)
    v_bitop3_b32 v5, v5, v163, s44 bitop3:0xf6
    v_cmp_ne_u32 vcc, 0, v5
    s_cbranch_vccnz Lslow8
Lgot9:
    v_and_b32 v151, 0xffff0000, v150
    v_and_b32 v155, 0xffff0000, v154
    v_and_b32 v159, 0xffff0000, v158
    v_and_b32 v163, 0xffff0000, v162
    v_lshlrev_b32 v150, 16, v150
    v_lshlrev_b32 v154, 16, v154
    v_lshlrev_b32 v158, 16, v158
    v_lshlrev_b32 v162, 16, v162
    v_lshlrev_b32 v212, 16, v84
    v_lshlrev_b32 v220, 16, v88
    v_lshlrev_b32 v228, 16, v92
    v_lshlrev_b32 v236, 16, v96
    v_and_b32 v213, 0xffff0000, v84
    v_and_b32 v221, 0xffff0000, v88
    v_and_b32 v229, 0xffff0000, v92
    v_and_b32 v237, 0xffff0000, v96
    v_lshlrev_b32 v214, 16, v85
    v_lshlrev_b32 v222, 16, v89
    v_lshlrev_b32 v230, 16, v93
    v_lshlrev_b32 v238, 16, v97
    v_and_b32 v215, 0xffff0000, v85
    v_and_b32 v223, 0xffff0000, v89
    v_and_b32 v231, 0xffff0000, v93
    v_and_b32 v239, 0xffff0000, v97
    v_lshlrev_b32 v216, 16, v86
    v_lshlrev_b32 v224, 16, v90
    v_lshlrev_b32 v232, 16, v94
    v_lshlrev_b32 v240, 16, v98
    v_and_b32 v217, 0xffff0000, v86
    v_and_b32 v225, 0xffff0000, v90
    v_and_b32 v233, 0xffff0000, v94
    v_and_b32 v241, 0xffff0000, v98
    v_pk_mul_f32 v[150:151], v[150:151], v[148:149]
    v_pk_mul_f32 v[154:155], v[154:155], v[152:153]
    v_pk_mul_f32 v[158:159], v[158:159], v[156:157]
    v_pk_mul_f32 v[162:163], v[162:163], v[160:161]
    v_pk_fma_f32 v[212:213], v[212:213], v[148:149], v[150:151] neg_lo:[0,0,1] neg_hi:[0,0,1]
    v_pk_fma_f32 v[220:221], v[220:221], v[152:153], v[154:155] neg_lo:[0,0,1] neg_hi:[0,0,1]
    v_pk_fma_f32 v[228:229], v[228:229], v[156:157], v[158:159] neg_lo:[0,0,1] neg_hi:[0,0,1]
    v_pk_fma_f32 v[236:237], v[236:237], v[160:161], v[162:163] neg_lo:[0,0,1] neg_hi:[0,0,1]
    v_pk_fma_f32 v[214:215], v[214:215], v[148:149], v[150:151] neg_lo:[0,0,1] neg_hi:[0,0,1]
    v_pk_fma_f32 v[222:223], v[222:223], v[152:153], v[154:155] neg_lo:[0,0,1] neg_hi:[0,0,1]
    v_pk_fma_f32 v[230:231], v[230:231], v[156:157], v[158:159] neg_lo:[0,0,1] neg_hi:[0,0,1]
    v_pk_fma_f32 v[238:239], v[238:239], v[160:161], v[162:163] neg_lo:[0,0,1] neg_hi:[0,0,1]
    v_pk_fma_f32 v[216:217], v[216:217], v[148:149], v[150:151] neg_lo:[0,0,1] neg_hi:[0,0,1]
    v_pk_fma_f32 v[224:225], v[224:225], v[152:153], v[154:155] neg_lo:[0,0,1] neg_hi:[0,0,1]
    v_pk_fma_f32 v[232:233], v[232:233], v[156:157], v[158:159] neg_lo:[0,0,1] neg_hi:[0,0,1]
    v_pk_fma_f32 v[240:241], v[240:241], v[160:161], v[162:163] neg_lo:[0,0,1] neg_hi:[0,0,1]
    v_cvt_pk_bf16_f32 v148, v212, v213
    v_cvt_pk_bf16_f32 v152, v220, v221
    v_cvt_pk_bf16_f32 v156, v228, v229
    v_cvt_pk_bf16_f32 v160, v236, v237
    v_cvt_pk_bf16_f32 v149, v214, v215
    v_cvt_pk_bf16_f32 v153, v222, v223
    v_cvt_pk_bf16_f32 v157, v230, v231
    v_cvt_pk_bf16_f32 v161, v238, v239
    v_cvt_pk_bf16_f32 v150, v216, v217
    v_cvt_pk_bf16_f32 v154, v224, v225
    v_cvt_pk_bf16_f32 v158, v232, v233
    v_cvt_pk_bf16_f32 v162, v240, v241
    ds_write_addtid_b32 v148 offset:512
    ds_write_addtid_b32 v84 offset:13824
    ds_write_addtid_b32 v149 offset:5120
    ds_write_addtid_b32 v85 offset:18432
    ds_write_addtid_b32 v150 offset:9728
    ds_write_addtid_b32 v86 offset:23040
    ds_write_addtid_b32 v152 offset:768
    ds_write_addtid_b32 v88 offset:14080
    ds_write_addtid_b32 v153 offset:5376
    ds_write_addtid_b32 v89 offset:18688
    ds_write_addtid_b32 v154 offset:9984
    ds_write_addtid_b32 v90 offset:23296
    ds_write_addtid_b32 v156 offset:1024
    ds_write_addtid_b32 v92 offset:14336
    ds_write_addtid_b32 v157 offset:5632
    ds_write_addtid_b32 v93 offset:18944
    ds_write_addtid_b32 v158 offset:10240
    ds_write_addtid_b32 v94 offset:23552
    ds_write_addtid_b32 v160 offset:1280
    ds_write_addtid_b32 v96 offset:14592
    ds_write_addtid_b32 v161 offset:5888
    ds_write_addtid_b32 v97 offset:19200
    ds_write_addtid_b32 v162 offset:10496
    ds_write_addtid_b32 v98 offset:23808
    v_mov_b32 v24, 0
    buffer_atomic_add v24, v22, s[36:39], 0 offen offset:16 sc0 sc1
    s_waitcnt vmcnt(6)
    v_xor_b32 v5, s44, v103
    s_waitcnt vmcnt(5)
    v_bitop3_b32 v5, v5, v107, s44 bitop3:0xf6
    s_waitcnt vmcnt(4)
    v_bitop3_b32 v5, v5, v111, s44 bitop3:0xf6
    s_waitcnt vmcnt(3)
    v_bitop3_b32 v5, v5, v167, s44 bitop3:0xf6
    s_waitcnt vmcnt(2)
    v_bitop3_b32 v5, v5, v171, s44 bitop3:0xf6
    s_waitcnt vmcnt(1)
    v_bitop3_b32 v5, v5, v175, s44 bitop3:0xf6
    v_cmp_ne_u32 vcc, 0, v5
    s_cbranch_vccnz Lslow11
Lgot12:
    v_and_b32 v167, 0xffff0000, v166
    v_and_b32 v171, 0xffff0000, v170
    v_and_b32 v175, 0xffff0000, v174
    v_lshlrev_b32 v166, 16, v166
    v_lshlrev_b32 v170, 16, v170
    v_lshlrev_b32 v174, 16, v174
    v_lshlrev_b32 v212, 16, v100
    v_lshlrev_b32 v220, 16, v104
    v_lshlrev_b32 v228, 16, v108
    v_and_b32 v213, 0xffff0000, v100
    v_and_b32 v221, 0xffff0000, v104
    v_and_b32 v229, 0xffff0000, v108
    v_lshlrev_b32 v214, 16, v101
    v_lshlrev_b32 v222, 16, v105
    v_lshlrev_b32 v230, 16, v109
    v_and_b32 v215, 0xffff0000, v101
    v_and_b32 v223, 0xffff0000, v105
    v_and_b32 v231, 0xffff0000, v109
    v_lshlrev_b32 v216, 16, v102
    v_lshlrev_b32 v224, 16, v106
    v_lshlrev_b32 v232, 16, v110
    v_and_b32 v217, 0xffff0000, v102
    v_and_b32 v225, 0xffff0000, v106
    v_and_b32 v233, 0xffff0000, v110
    v_pk_mul_f32 v[166:167], v[166:167], v[164:165]
    v_pk_mul_f32 v[170:171], v[170:171], v[168:169]
    v_pk_mul_f32 v[174:175], v[174:175], v[172:173]
    v_pk_fma_f32 v[212:213], v[212:213], v[164:165], v[166:167] neg_lo:[0,0,1] neg_hi:[0,0,1]
    v_pk_fma_f32 v[220:221], v[220:221], v[168:169], v[170:171] neg_lo:[0,0,1] neg_hi:[0,0,1]
    v_pk_fma_f32 v[228:229], v[228:229], v[172:173], v[174:175] neg_lo:[0,0,1] neg_hi:[0,0,1]
    v_pk_fma_f32 v[214:215], v[214:215], v[164:165], v[166:167] neg_lo:[0,0,1] neg_hi:[0,0,1]
    v_pk_fma_f32 v[222:223], v[222:223], v[168:169], v[170:171] neg_lo:[0,0,1] neg_hi:[0,0,1]
    v_pk_fma_f32 v[230:231], v[230:231], v[172:173], v[174:175] neg_lo:[0,0,1] neg_hi:[0,0,1]
    v_pk_fma_f32 v[216:217], v[216:217], v[164:165], v[166:167] neg_lo:[0,0,1] neg_hi:[0,0,1]
    v_pk_fma_f32 v[224:225], v[224:225], v[168:169], v[170:171] neg_lo:[0,0,1] neg_hi:[0,0,1]
    v_pk_fma_f32 v[232:233], v[232:233], v[172:173], v[174:175] neg_lo:[0,0,1] neg_hi:[0,0,1]
    v_cvt_pk_bf16_f32 v164, v212, v213
    v_cvt_pk_bf16_f32 v168, v220, v221
    v_cvt_pk_bf16_f32 v172, v228, v229
    v_cvt_pk_bf16_f32 v165, v214, v215
    v_cvt_pk_bf16_f32 v169, v222, v223
    v_cvt_pk_bf16_f32 v173, v230, v231
    v_cvt_pk_bf16_f32 v166, v216, v217
    v_cvt_pk_bf16_f32 v170, v224, v225
    v_cvt_pk_bf16_f32 v174, v232, v233
    ds_write_addtid_b32 v164 offset:1536
    ds_write_addtid_b32 v100 offset:14848
    ds_write_addtid_b32 v165 offset:6144
    ds_write_addtid_b32 v101 offset:19456
    ds_write_addtid_b32 v166 offset:10752
    ds_write_addtid_b32 v102 offset:24064
    ds_write_addtid_b32 v168 offset:1792
    ds_write_addtid_b32 v104 offset:15104
    ds_write_addtid_b32 v169 offset:6400
    ds_write_addtid_b32 v105 offset:19712
    ds_write_addtid_b32 v170 offset:11008
    ds_write_addtid_b32 v106 offset:24320
    ds_write_addtid_b32 v172 offset:2048
    ds_write_addtid_b32 v108 offset:15360
    ds_write_addtid_b32 v173 offset:6656
    ds_write_addtid_b32 v109 offset:19968
    ds_write_addtid_b32 v174 offset:11264
    ds_write_addtid_b32 v110 offset:24576
    s_add_u32 s50, s44, 20
    s_waitcnt vmcnt(0)
    v_cmp_ne_u32 vcc, s50, v24
    s_nop 0
    s_and_b64 vcc, vcc, 0xf
    s_cbranch_scc1 Lslow14
Lgot15:
    s_waitcnt lgkmcnt(0)
    s_barrier
    ds_read_b128 v[72:75], v9 offset:608
    ds_read_b64 v[76:77], v8 offset:1928
    ds_read_b64 v[78:79], v8 offset:1920
    ds_read_b128 v[80:83], v9 offset:1120
    ds_read_b64 v[84:85], v8 offset:1416
    ds_read_b64 v[86:87], v8 offset:1408
    ds_read_b128 v[88:91], v9 offset:1632
    ds_read_b64 v[92:93], v8 offset:904
    ds_read_b64 v[94:95], v8 offset:896
    ds_read_b128 v[96:99], v9 offset:2144
    s_waitcnt lgkmcnt(7)
    v_mfma_f32_16x16x32_bf16 v[32:35], v[76:79], v[72:75], 0
    s_waitcnt lgkmcnt(6)
    ds_read_b64 v[100:101], v8 offset:392
    ds_read_b64 v[102:103], v8 offset:384
    v_mfma_f32_16x16x32_bf16 v[36:39], v[76:79], v[80:83], 0
    s_waitcnt lgkmcnt(6)
    ds_read_b128 v[104:107], v9 offset:2656
    v_mfma_f32_16x16x32_bf16 v[32:35], v[84:87], v[80:83], v[32:35]
    s_waitcnt lgkmcnt(6)
    ds_read_b128 v[108:111], v9 offset:3168
    buffer_load_dwordx4 a[0:3], v4, s[36:39], s6 offen offset:0 sc1
    v_mfma_f32_16x16x32_bf16 v[40:43], v[76:79], v[88:91], 0
    v_mfma_f32_16x16x32_bf16 v[36:39], v[84:87], v[88:91], v[36:39]
Lwarm1_2:
    s_cbranch_execz Lwarm1_3
    s_waitcnt lgkmcnt(5)
    ds_read_b128 v[112:115], v9 offset:3680
    v_mfma_f32_16x16x32_bf16 v[32:35], v[92:95], v[88:91], v[32:35]
    s_waitcnt lgkmcnt(5)
    ds_read_b128 v[116:119], v9 offset:544
    ds_read_b64 v[120:121], v8 offset:1992
    v_mfma_f32_16x16x32_bf16 v[44:47], v[76:79], v[96:99], 0
    ds_read_b64 v[122:123], v8 offset:1984
    v_mfma_f32_16x16x32_bf16 v[40:43], v[84:87], v[96:99], v[40:43]
    ds_read_b128 v[124:127], v9 offset:1056
    buffer_load_dwordx4 a[4:7], v4, s[36:39], s6 offen offset:1024 sc1
    v_mfma_f32_16x16x32_bf16 v[36:39], v[92:95], v[96:99], v[36:39]
    s_waitcnt lgkmcnt(7)
    ds_read_b64 v[128:129], v8 offset:1480
    v_mfma_f32_16x16x32_bf16 v[32:35], v[100:103], v[96:99], v[32:35]
    s_waitcnt lgkmcnt(7)
    ds_read_b64 v[130:131], v8 offset:1472
    v_mfma_f32_16x16x32_bf16 v[44:47], v[84:87], v[104:107], v[44:47]
    ds_read_b128 v[132:135], v9 offset:1568
    v_mfma_f32_16x16x32_bf16 v[40:43], v[92:95], v[104:107], v[40:43]
    ds_read_b64 v[136:137], v8 offset:968
    v_mfma_f32_16x16x32_bf16 v[36:39], v[100:103], v[104:107], v[36:39]
    s_waitcnt lgkmcnt(9)
    ds_read_b64 v[138:139], v8 offset:960
    buffer_load_dwordx4 a[8:11], v4, s[36:39], s6 offen offset:2048 sc1
    v_mfma_f32_16x16x32_bf16 v[44:47], v[92:95], v[108:111], v[44:47]
    ds_read_b128 v[140:143], v9 offset:2080
    v_mfma_f32_16x16x32_bf16 v[40:43], v[100:103], v[108:111], v[40:43]
    s_waitcnt lgkmcnt(10)
    v_mfma_f32_16x16x32_bf16 v[44:47], v[100:103], v[112:115], v[44:47]
    s_waitcnt lgkmcnt(7)
    ds_read_b64 v[144:145], v8 offset:456
    v_mfma_f32_16x16x32_bf16 v[32:35], v[120:123], v[116:119], v[32:35]
    s_waitcnt lgkmcnt(7)
    ds_read_b64 v[146:147], v8 offset:448
    v_mfma_f32_16x16x32_bf16 v[36:39], v[120:123], v[124:127], v[36:39]
    s_waitcnt lgkmcnt(6)
    ds_read_b128 v[148:151], v9 offset:2592
    s_add_u32 s6, s6, 3072
    v_mfma_f32_16x16x32_bf16 v[32:35], v[128:131], v[124:127], v[32:35]
    s_waitcnt lgkmcnt(6)
    ds_read_b128 v[152:155], v9 offset:3104
    buffer_load_dwordx4 a[12:15], v4, s[36:39], s6 offen offset:0 sc1
    v_mfma_f32_16x16x32_bf16 v[40:43], v[120:123], v[132:135], v[40:43]
    v_mfma_f32_16x16x32_bf16 v[36:39], v[128:131], v[132:135], v[36:39]
    s_waitcnt lgkmcnt(5)
    ds_read_b128 v[156:159], v9 offset:3616
    ds_read_b128 v[160:163], v9 offset:672
    v_mfma_f32_16x16x32_bf16 v[32:35], v[136:139], v[132:135], v[32:35]
    s_waitcnt lgkmcnt(6)
    ds_read_b64 v[164:165], v8 offset:1864
    v_mfma_f32_16x16x32_bf16 v[44:47], v[120:123], v[140:143], v[44:47]
    ds_read_b64 v[166:167], v8 offset:1856
    buffer_load_dwordx4 a[16:19], v4, s[36:39], s6 offen offset:1024 sc1
    v_mfma_f32_16x16x32_bf16 v[40:43], v[128:131], v[140:143], v[40:43]
    ds_read_b128 v[168:171], v9 offset:1184
    v_mfma_f32_16x16x32_bf16 v[36:39], v[136:139], v[140:143], v[36:39]
    s_waitcnt lgkmcnt(7)
    ds_read_b64 v[172:173], v8 offset:1352
    v_mfma_f32_16x16x32_bf16 v[32:35], v[144:147], v[140:143], v[32:35]
    s_waitcnt lgkmcnt(7)
    ds_read_b64 v[174:175], v8 offset:1344
    v_mfma_f32_16x16x32_bf16 v[44:47], v[128:131], v[148:151], v[44:47]
    ds_read_b128 v[176:179], v9 offset:1696
    v_mfma_f32_16x16x32_bf16 v[40:43], v[136:139], v[148:151], v[40:43]
    ds_read_b64 v[180:181], v8 offset:840
    buffer_load_dwordx4 a[20:23], v4, s[36:39], s6 offen offset:2048 sc1
    v_mfma_f32_16x16x32_bf16 v[36:39], v[144:147], v[148:151], v[36:39]
    s_waitcnt lgkmcnt(9)
    ds_read_b64 v[182:183], v8 offset:832
    v_mfma_f32_16x16x32_bf16 v[44:47], v[136:139], v[152:155], v[44:47]
    ds_read_b128 v[72:75], v9 offset:2208
    v_mfma_f32_16x16x32_bf16 v[40:43], v[144:147], v[152:155], v[40:43]
    s_waitcnt lgkmcnt(10)
    v_mfma_f32_16x16x32_bf16 v[44:47], v[144:147], v[156:159], v[44:47]
    s_waitcnt lgkmcnt(7)
    ds_read_b64 v[76:77], v8 offset:328
    v_mfma_f32_16x16x32_bf16 v[32:35], v[164:167], v[160:163], v[32:35]
    s_waitcnt lgkmcnt(7)
    ds_read_b64 v[78:79], v8 offset:320
    s_add_u32 s6, s6, 3072
    v_mfma_f32_16x16x32_bf16 v[36:39], v[164:167], v[168:171], v[36:39]
    s_waitcnt lgkmcnt(6)
    ds_read_b128 v[80:83], v9 offset:2720
    buffer_load_dwordx4 a[24:27], v4, s[36:39], s6 offen offset:0 sc1
    v_mfma_f32_16x16x32_bf16 v[32:35], v[172:175], v[168:171], v[32:35]
    s_waitcnt lgkmcnt(6)
    v_mfma_f32_16x16x32_bf16 v[40:43], v[164:167], v[176:179], v[40:43]
    ds_read_b128 v[84:87], v9 offset:3232
    v_mfma_f32_16x16x32_bf16 v[36:39], v[172:175], v[176:179], v[36:39]
    s_waitcnt lgkmcnt(5)
    ds_read_b128 v[88:91], v9 offset:3744
    v_mfma_f32_16x16x32_bf16 v[32:35], v[180:183], v[176:179], v[32:35]
    s_waitcnt lgkmcnt(5)
    ds_read_b128 v[92:95], v9 offset:5216
    buffer_load_dwordx4 a[28:31], v4, s[36:39], s6 offen offset:1024 sc1
    v_mfma_f32_16x16x32_bf16 v[44:47], v[164:167], v[72:75], v[44:47]
    ds_read_b64 v[96:97], v8 offset:18568
    ds_read_b64 v[98:99], v8 offset:18560
    v_mfma_f32_16x16x32_bf16 v[40:43], v[172:175], v[72:75], v[40:43]
    ds_read_b128 v[100:103], v9 offset:5728
    v_mfma_f32_16x16x32_bf16 v[36:39], v[180:183], v[72:75], v[36:39]
    s_waitcnt lgkmcnt(7)
    ds_read_b64 v[104:105], v8 offset:18056
    v_mov_b32 v12, 0x3f803f80
    v_mfma_f32_16x16x32_bf16 v[32:35], v[76:79], v[72:75], v[32:35]
    s_waitcnt lgkmcnt(7)
    ds_read_b64 v[106:107], v8 offset:18048
    v_mov_b32 v13, 0x3f803f80
    v_mfma_f32_16x16x32_bf16 v[44:47], v[172:175], v[80:83], v[44:47]
    ds_read_b128 v[108:111], v9 offset:6240
    buffer_load_dwordx4 a[32:35], v4, s[36:39], s6 offen offset:2048 sc1
    v_mfma_f32_16x16x32_bf16 v[40:43], v[180:183], v[80:83], v[40:43]
    ds_read_b64 v[112:113], v8 offset:17544
    v_mov_b32 v14, 0x3f803f80
    v_mfma_f32_16x16x32_bf16 v[36:39], v[76:79], v[80:83], v[36:39]
    s_waitcnt lgkmcnt(9)
    ds_read_b64 v[114:115], v8 offset:17536
    v_mov_b32 v15, 0x3f803f80
    v_mfma_f32_16x16x32_bf16 v[44:47], v[180:183], v[84:87], v[44:47]
    ds_read_b128 v[116:119], v9 offset:6752
    v_lshrrev_b32 v7, 2, v1
    v_mfma_f32_16x16x32_bf16 v[40:43], v[76:79], v[84:87], v[40:43]
    s_waitcnt lgkmcnt(10)
    v_lshlrev_b32 v7, 6, v7
    v_and_b32 v6, 3, v1
    v_mfma_f32_16x16x32_bf16 v[44:47], v[76:79], v[88:91], v[44:47]
    s_waitcnt lgkmcnt(7)
    ds_read_b64 v[120:121], v8 offset:17032
    v_lshl_add_u32 v7, v6, 3, v7
    v_mfma_f32_16x16x32_bf16 v[48:51], v[96:99], v[92:95], 0
    s_waitcnt lgkmcnt(7)
    ds_read_b64 v[122:123], v8 offset:17024
    s_add_u32 s6, s6, 3072
    v_mfma_f32_16x16x32_bf16 v[52:55], v[96:99], v[100:103], 0
    s_waitcnt lgkmcnt(6)
    ds_read_b128 v[124:127], v9 offset:7264
    buffer_load_dwordx4 a[36:39], v4, s[36:39], s6 offen offset:0 sc1
    v_mfma_f32_16x16x32_bf16 v[48:51], v[104:107], v[100:103], v[48:51]
    s_waitcnt lgkmcnt(6)
    v_and_b32 v6, 1, v3
    v_lshl_add_u32 v7, v6, 5, v7
    v_mfma_f32_16x16x32_bf16 v[56:59], v[96:99], v[108:111], 0
    ds_read_b128 v[128:131], v9 offset:7776
    ds_write_b128 v29, v[32:35] offset:0
    v_mfma_f32_16x16x32_bf16 v[52:55], v[104:107], v[108:111], v[52:55]
    s_waitcnt lgkmcnt(6)
    ds_read_b128 v[132:135], v9 offset:8288
    buffer_load_dwordx4 a[40:43], v4, s[36:39], s6 offen offset:1024 sc1
    v_mfma_f32_16x16x32_bf16 v[48:51], v[112:115], v[108:111], v[48:51]
    s_waitcnt lgkmcnt(6)
    ds_read_b128 v[136:139], v9 offset:5152
    s_xor_b32 s57, s4, 0
    v_mfma_f32_16x16x32_bf16 v[60:63], v[96:99], v[116:119], 0
    s_mul_i32 s57, s57, 10240
    ds_read_b64 v[140:141], v8 offset:18632
    s_add_u32 s57, s57, 81920
    v_mfma_f32_16x16x32_bf16 v[56:59], v[104:107], v[116:119], v[56:59]
    ds_read_b64 v[142:143], v8 offset:18624
    ds_write_b128 v29, v[36:39] offset:1024
    v_mfma_f32_16x16x32_bf16 v[52:55], v[112:115], v[116:119], v[52:55]
    s_waitcnt lgkmcnt(8)
    ds_read_b128 v[144:147], v9 offset:5664
    v_add_u32 v64, s57, v7
    v_mfma_f32_16x16x32_bf16 v[48:51], v[120:123], v[116:119], v[48:51]
    s_waitcnt lgkmcnt(8)
    ds_read_b64 v[148:149], v8 offset:18120
    buffer_load_dwordx4 a[44:47], v4, s[36:39], s6 offen offset:2048 sc1
    v_mfma_f32_16x16x32_bf16 v[60:63], v[104:107], v[124:127], v[60:63]
    ds_read_b64 v[150:151], v8 offset:18112
    v_xor_b32 v68, 32, v64
    v_mfma_f32_16x16x32_bf16 v[56:59], v[112:115], v[124:127], v[56:59]
    ds_read_b128 v[152:155], v9 offset:6176
    ds_write_b128 v29, v[40:43] offset:2048
    v_mfma_f32_16x16x32_bf16 v[52:55], v[120:123], v[124:127], v[52:55]
    s_waitcnt lgkmcnt(11)
    ds_read_b64 v[156:157], v8 offset:17608
    s_xor_b32 s57, s4, 1
    v_mfma_f32_16x16x32_bf16 v[60:63], v[112:115], v[128:131], v[60:63]
    s_mul_i32 s57, s57, 10240
    ds_read_b64 v[158:159], v8 offset:17600
    s_add_u32 s57, s57, 81920
    v_mfma_f32_16x16x32_bf16 v[56:59], v[120:123], v[128:131], v[56:59]
    s_waitcnt lgkmcnt(11)
    ds_read_b128 v[160:163], v9 offset:6688
    v_add_u32 v65, s57, v7
    v_mfma_f32_16x16x32_bf16 v[60:63], v[120:123], v[132:135], v[60:63]
    s_waitcnt lgkmcnt(9)
    ds_read_b64 v[164:165], v8 offset:17096
    s_add_u32 s6, s6, 3072
    v_mfma_f32_16x16x32_bf16 v[48:51], v[140:143], v[136:139], v[48:51]
    s_waitcnt lgkmcnt(8)
    ds_read_b64 v[166:167], v8 offset:17088
    buffer_load_dwordx4 a[48:51], v4, s[36:39], s6 offen offset:0 sc1
    v_mfma_f32_16x16x32_bf16 v[52:55], v[140:143], v[144:147], v[52:55]
    s_waitcnt lgkmcnt(7)
    ds_read_b128 v[168:171], v9 offset:7200
    ds_write_b128 v29, v[44:47] offset:3072
    v_mfma_f32_16x16x32_bf16 v[48:51], v[148:151], v[144:147], v[48:51]
    s_waitcnt lgkmcnt(8)
    v_xor_b32 v69, 32, v65
    s_xor_b32 s57, s4, 2
    v_mfma_f32_16x16x32_bf16 v[56:59], v[140:143], v[152:155], v[56:59]
    ds_read_b128 v[172:175], v9 offset:7712
    buffer_load_dwordx4 a[52:55], v4, s[36:39], s6 offen offset:1024 sc1
    v_mfma_f32_16x16x32_bf16 v[52:55], v[148:151], v[152:155], v[52:55]
    s_waitcnt lgkmcnt(6)
    ds_read_b128 v[176:179], v9 offset:8224
    s_mul_i32 s57, s57, 10240
    v_mfma_f32_16x16x32_bf16 v[48:51], v[156:159], v[152:155], v[48:51]
    s_waitcnt lgkmcnt(6)
    ds_read_b128 v[180:183], v9 offset:5280
    s_add_u32 s57, s57, 81920
    v_mfma_f32_16x16x32_bf16 v[60:63], v[140:143], v[160:163], v[60:63]
    ds_read_b64 v[72:73], v8 offset:18504
    v_add_u32 v66, s57, v7
    v_mfma_f32_16x16x32_bf16 v[56:59], v[148:151], v[160:163], v[56:59]
    ds_read_b64 v[74:75], v8 offset:18496
    v_xor_b32 v70, 32, v66
    v_mfma_f32_16x16x32_bf16 v[52:55], v[156:159], v[160:163], v[52:55]
    s_waitcnt lgkmcnt(7)
    ds_read_b128 v[76:79], v9 offset:5792
    buffer_load_dwordx4 a[56:59], v4, s[36:39], s6 offen offset:2048 sc1
    v_mfma_f32_16x16x32_bf16 v[48:51], v[164:167], v[160:163], v[48:51]
    s_waitcnt lgkmcnt(7)
    ds_read_b64 v[80:81], v8 offset:17992
    s_xor_b32 s57, s4, 3
    v_mfma_f32_16x16x32_bf16 v[60:63], v[148:151], v[168:171], v[60:63]
    s_mul_i32 s57, s57, 10240
    ds_read_b64 v[82:83], v8 offset:17984
    s_add_u32 s57, s57, 81920
    v_mfma_f32_16x16x32_bf16 v[56:59], v[156:159], v[168:171], v[56:59]
    ds_read_b128 v[84:87], v9 offset:6304
    v_add_u32 v67, s57, v7
    v_mfma_f32_16x16x32_bf16 v[52:55], v[164:167], v[168:171], v[52:55]
    s_waitcnt lgkmcnt(8)
    ds_read_b64 v[88:89], v8 offset:17480
    v_xor_b32 v71, 32, v67
    v_mfma_f32_16x16x32_bf16 v[60:63], v[156:159], v[172:175], v[60:63]
    ds_read_b64 v[90:91], v8 offset:17472
    buffer_load_dwordx4 a[60:63], v4, s[36:39], s7 offen offset:0 sc1
    v_mfma_f32_16x16x32_bf16 v[56:59], v[164:167], v[172:175], v[56:59]
    s_waitcnt lgkmcnt(9)
    ds_read_b128 v[92:95], v9 offset:6816
    v_mfma_f32_16x16x32_bf16 v[60:63], v[164:167], v[176:179], v[60:63]
    s_waitcnt lgkmcnt(7)
    ds_read_b64 v[96:97], v8 offset:16968
    v_mfma_f32_16x16x32_bf16 v[48:51], v[72:75], v[180:183], v[48:51]
    s_waitcnt lgkmcnt(7)
    ds_read_b64 v[98:99], v8 offset:16960
    v_mfma_f32_16x16x32_bf16 v[52:55], v[72:75], v[76:79], v[52:55]
    s_waitcnt lgkmcnt(6)
    ds_read_b128 v[100:103], v9 offset:7328
    v_mfma_f32_16x16x32_bf16 v[48:51], v[80:83], v[76:79], v[48:51]
    s_waitcnt lgkmcnt(6)
    ds_read_b128 v[104:107], v9 offset:7840
    buffer_load_dwordx4 a[64:67], v4, s[36:39], s7 offen offset:1024 sc1
    v_mfma_f32_16x16x32_bf16 v[56:59], v[72:75], v[84:87], v[56:59]
    v_mfma_f32_16x16x32_bf16 v[52:55], v[80:83], v[84:87], v[52:55]
    s_waitcnt lgkmcnt(5)
    ds_read_b128 v[108:111], v9 offset:8352
    v_mfma_f32_16x16x32_bf16 v[48:51], v[88:91], v[84:87], v[48:51]
    s_waitcnt lgkmcnt(5)
    ds_read_b128 v[112:115], v9 offset:9824
    ds_read_b64 v[116:117], v8 offset:35208
    v_mfma_f32_16x16x32_bf16 v[60:63], v[72:75], v[92:95], v[60:63]
    ds_read_b64 v[118:119], v8 offset:35200
    v_mfma_f32_16x16x32_bf16 v[56:59], v[80:83], v[92:95], v[56:59]
    ds_read_b128 v[120:123], v9 offset:10336
    buffer_load_dwordx4 a[68:71], v4, s[36:39], s7 offen offset:2048 sc1
    v_mfma_f32_16x16x32_bf16 v[52:55], v[88:91], v[92:95], v[52:55]
    s_waitcnt lgkmcnt(7)
    ds_read_b64 v[124:125], v8 offset:34696
    v_mfma_f32_16x16x32_bf16 v[48:51], v[96:99], v[92:95], v[48:51]
    s_waitcnt lgkmcnt(7)
    ds_read_b64 v[126:127], v8 offset:34688
    v_mfma_f32_16x16x32_bf16 v[60:63], v[80:83], v[100:103], v[60:63]
    ds_read_b128 v[128:131], v9 offset:10848
    v_mfma_f32_16x16x32_bf16 v[56:59], v[88:91], v[100:103], v[56:59]
    ds_read_b64 v[132:133], v8 offset:34184
    v_mfma_f32_16x16x32_bf16 v[52:55], v[96:99], v[100:103], v[52:55]
    s_waitcnt lgkmcnt(9)
    ds_read_b64 v[134:135], v8 offset:34176
    s_add_u32 s7, s7, 3072
    v_mfma_f32_16x16x32_bf16 v[60:63], v[88:91], v[104:107], v[60:63]
    ds_read_b128 v[136:139], v9 offset:11360
    buffer_load_dwordx4 a[72:75], v4, s[36:39], s7 offen offset:0 sc1
    v_mfma_f32_16x16x32_bf16 v[56:59], v[96:99], v[104:107], v[56:59]
    s_waitcnt lgkmcnt(10)
    v_mfma_f32_16x16x32_bf16 v[60:63], v[96:99], v[108:111], v[60:63]
    s_waitcnt lgkmcnt(7)
    ds_read_b64 v[140:141], v8 offset:33672
    v_mfma_f32_16x16x32_bf16 v[32:35], v[116:119], v[112:115], 0
Lwarm2_2:
    s_cbranch_execz Lwarm2_3
    s_waitcnt lgkmcnt(7)
    ds_read_b64 v[142:143], v8 offset:33664
    v_mfma_f32_16x16x32_bf16 v[36:39], v[116:119], v[120:123], 0
    s_waitcnt lgkmcnt(6)
    ds_read_b128 v[144:147], v9 offset:11872
    buffer_load_dwordx4 a[76:79], v4, s[36:39], s7 offen offset:1024 sc1
    v_mfma_f32_16x16x32_bf16 v[32:35], v[124:127], v[120:123], v[32:35]
    s_waitcnt lgkmcnt(6)
    v_mfma_f32_16x16x32_bf16 v[40:43], v[116:119], v[128:131], 0
    ds_read_b128 v[148:151], v9 offset:12384
    ds_write_b128 v29, v[48:51] offset:4096
    v_mfma_f32_16x16x32_bf16 v[36:39], v[124:127], v[128:131], v[36:39]
    s_waitcnt lgkmcnt(6)
    ds_read_b128 v[152:155], v9 offset:12896
    v_mfma_f32_16x16x32_bf16 v[32:35], v[132:135], v[128:131], v[32:35]
    s_waitcnt lgkmcnt(6)
    ds_read_b128 v[156:159], v9 offset:9760
    ds_read_b64 v[160:161], v8 offset:35272
    v_mfma_f32_16x16x32_bf16 v[44:47], v[116:119], v[136:139], 0
    ds_read_b64 v[162:163], v8 offset:35264
    buffer_load_dwordx4 a[80:83], v4, s[36:39], s7 offen offset:2048 sc1
    v_mfma_f32_16x16x32_bf16 v[40:43], v[124:127], v[136:139], v[40:43]
    ds_read_b128 v[164:167], v9 offset:10272
    ds_write_b128 v29, v[52:55] offset:5120
    v_mfma_f32_16x16x32_bf16 v[36:39], v[132:135], v[136:139], v[36:39]
    s_waitcnt lgkmcnt(9)
    ds_read_b64 v[168:169], v8 offset:34760
    v_mfma_f32_16x16x32_bf16 v[32:35], v[140:143], v[136:139], v[32:35]
    s_waitcnt lgkmcnt(9)
    ds_read_b64 v[170:171], v8 offset:34752
    v_mfma_f32_16x16x32_bf16 v[44:47], v[124:127], v[144:147], v[44:47]
    ds_read_b128 v[172:175], v9 offset:10784
    v_mfma_f32_16x16x32_bf16 v[40:43], v[132:135], v[144:147], v[40:43]
    ds_read_b64 v[176:177], v8 offset:34248
    ds_write_b128 v29, v[56:59] offset:6144
    v_mfma_f32_16x16x32_bf16 v[36:39], v[140:143], v[144:147], v[36:39]
    s_waitcnt lgkmcnt(12)
    ds_read_b64 v[178:179], v8 offset:34240
    s_add_u32 s7, s7, 3072
    v_mfma_f32_16x16x32_bf16 v[44:47], v[132:135], v[148:151], v[44:47]
    ds_read_b128 v[180:183], v9 offset:11296
    buffer_load_dwordx4 a[84:87], v4, s[36:39], s7 offen offset:0 sc1
    v_mfma_f32_16x16x32_bf16 v[40:43], v[140:143], v[148:151], v[40:43]
    s_waitcnt lgkmcnt(12)
    v_mfma_f32_16x16x32_bf16 v[44:47], v[140:143], v[152:155], v[44:47]
    s_waitcnt lgkmcnt(9)
    ds_read_b64 v[72:73], v8 offset:33736
    ds_write_b128 v29, v[60:63] offset:7168
    v_mfma_f32_16x16x32_bf16 v[32:35], v[160:163], v[156:159], v[32:35]
    s_waitcnt lgkmcnt(10)
    ds_read_b64 v[74:75], v8 offset:33728
    buffer_load_dwordx4 a[88:91], v4, s[36:39], s7 offen offset:1024 sc1
    v_mfma_f32_16x16x32_bf16 v[36:39], v[160:163], v[164:167], v[36:39]
    s_waitcnt lgkmcnt(8)
    ds_read_b128 v[76:79], v9 offset:11808
    v_mfma_f32_16x16x32_bf16 v[32:35], v[168:171], v[164:167], v[32:35]
    s_waitcnt lgkmcnt(8)
    v_mfma_f32_16x16x32_bf16 v[40:43], v[160:163], v[172:175], v[40:43]
    ds_read_b128 v[80:83], v9 offset:12320
    v_mfma_f32_16x16x32_bf16 v[36:39], v[168:171], v[172:175], v[36:39]
    s_waitcnt lgkmcnt(6)
    ds_read_b128 v[84:87], v9 offset:12832
    v_mfma_f32_16x16x32_bf16 v[32:35], v[176:179], v[172:175], v[32:35]
    s_waitcnt lgkmcnt(6)
    ds_read_b128 v[88:91], v9 offset:9888
    buffer_load_dwordx4 a[92:95], v4, s[36:39], s7 offen offset:2048 sc1
    v_mfma_f32_16x16x32_bf16 v[44:47], v[160:163], v[180:183], v[44:47]
    ds_read_b64 v[92:93], v8 offset:35144
    ds_read_b64 v[94:95], v8 offset:35136
    v_mfma_f32_16x16x32_bf16 v[40:43], v[168:171], v[180:183], v[40:43]
    ds_read_b128 v[96:99], v9 offset:10400
    v_mfma_f32_16x16x32_bf16 v[36:39], v[176:179], v[180:183], v[36:39]
    s_waitcnt lgkmcnt(7)
    ds_read_b64 v[100:101], v8 offset:34632
    v_mfma_f32_16x16x32_bf16 v[32:35], v[72:75], v[180:183], v[32:35]
    s_waitcnt lgkmcnt(7)
    ds_read_b64 v[102:103], v8 offset:34624
    v_mfma_f32_16x16x32_bf16 v[44:47], v[168:171], v[76:79], v[44:47]
    s_add_u32 s7, s7, 3072
    ds_read_b128 v[104:107], v9 offset:10912
    buffer_load_dwordx4 a[96:99], v4, s[36:39], s7 offen offset:0 sc1
    v_mfma_f32_16x16x32_bf16 v[40:43], v[176:179], v[76:79], v[40:43]
    ds_read_b64 v[108:109], v8 offset:34120
    v_mfma_f32_16x16x32_bf16 v[36:39], v[72:75], v[76:79], v[36:39]
    s_waitcnt lgkmcnt(9)
    ds_read_b64 v[110:111], v8 offset:34112
    v_lshrrev_b32 v26, 3, v1
    v_mfma_f32_16x16x32_bf16 v[44:47], v[176:179], v[80:83], v[44:47]
    ds_read_b128 v[112:115], v9 offset:11424
    v_min_u32 v26, 1, v26
    v_mfma_f32_16x16x32_bf16 v[40:43], v[72:75], v[80:83], v[40:43]
    s_waitcnt lgkmcnt(10)
    v_lshlrev_b32 v26, 23, v26
    v_add_lshl_u32 v26, v26, v1, 7
    v_mfma_f32_16x16x32_bf16 v[44:47], v[72:75], v[84:87], v[44:47]
    s_waitcnt lgkmcnt(7)
    ds_read_b64 v[116:117], v8 offset:33608
    v_mov_b32 v24, 0
    v_mfma_f32_16x16x32_bf16 v[32:35], v[92:95], v[88:91], v[32:35]
    s_waitcnt lgkmcnt(7)
    ds_read_b64 v[118:119], v8 offset:33600
    buffer_atomic_add v24, v26, s[36:39], s16 offen offset:0 sc0 sc1
    v_mfma_f32_16x16x32_bf16 v[36:39], v[92:95], v[96:99], v[36:39]
    s_waitcnt lgkmcnt(6)
    ds_read_b128 v[120:123], v9 offset:11936
    buffer_load_dwordx4 a[100:103], v4, s[36:39], s7 offen offset:1024 sc1
    v_mfma_f32_16x16x32_bf16 v[32:35], v[100:103], v[96:99], v[32:35]
    s_waitcnt lgkmcnt(6)
    v_mfma_f32_16x16x32_bf16 v[40:43], v[92:95], v[104:107], v[40:43]
    v_mfma_f32_16x16x32_bf16 v[36:39], v[100:103], v[104:107], v[36:39]
    s_waitcnt lgkmcnt(4)
    ds_read_b128 v[124:127], v9 offset:12448
    buffer_load_dwordx4 a[104:107], v4, s[36:39], s7 offen offset:2048 sc1
    v_mfma_f32_16x16x32_bf16 v[32:35], v[108:111], v[104:107], v[32:35]
    s_waitcnt lgkmcnt(4)
    v_mfma_f32_16x16x32_bf16 v[44:47], v[92:95], v[112:115], v[44:47]
    ds_read_b128 v[128:131], v9 offset:12960
    v_mfma_f32_16x16x32_bf16 v[40:43], v[100:103], v[112:115], v[40:43]
    v_mfma_f32_16x16x32_bf16 v[36:39], v[108:111], v[112:115], v[36:39]
    s_waitcnt lgkmcnt(3)
    v_mfma_f32_16x16x32_bf16 v[32:35], v[116:119], v[112:115], v[32:35]
    s_waitcnt lgkmcnt(2)
    s_add_u32 s7, s7, 3072
    buffer_load_dwordx4 a[108:111], v4, s[36:39], s7 offen offset:0 sc1
    v_mfma_f32_16x16x32_bf16 v[44:47], v[100:103], v[120:123], v[44:47]
    v_mfma_f32_16x16x32_bf16 v[40:43], v[108:111], v[120:123], v[40:43]
    v_mfma_f32_16x16x32_bf16 v[36:39], v[116:119], v[120:123], v[36:39]
    s_waitcnt lgkmcnt(1)
    v_mfma_f32_16x16x32_bf16 v[44:47], v[108:111], v[124:127], v[44:47]
    v_mfma_f32_16x16x32_bf16 v[40:43], v[116:119], v[124:127], v[40:43]
    s_waitcnt lgkmcnt(0)
    v_mfma_f32_16x16x32_bf16 v[44:47], v[116:119], v[128:131], v[44:47]
    ds_write_b128 v29, v[32:35] offset:8192
    s_nop 1
    ds_write_b128 v29, v[36:39] offset:9216
    s_nop 1
    ds_write_b128 v29, v[40:43] offset:10240
    s_nop 0
    ds_write_b128 v29, v[44:47] offset:11264
    s_add_u32 s50, s44, 27
    s_waitcnt vmcnt(3)
    v_cmp_ne_u32 vcc, s50, v24
    s_nop 0
    s_and_b64 vcc, vcc, 0xff
    s_cbranch_scc1 Lslow17
Lgot18:
    s_waitcnt lgkmcnt(0)
    s_barrier
    s_add_u32 m0, s12, 81920
    s_add_u32 s54, s11, 0
    buffer_load_dwordx4 v4, s[36:39], s54 offen offset:0 sc1 lds
    buffer_load_dwordx4 v4, s[36:39], s54 offen offset:1024 sc1 lds
    buffer_load_dwordx4 v4, s[36:39], s54 offen offset:2048 sc1 lds
    buffer_load_dwordx4 v4, s[36:39], s54 offen offset:3072 sc1 lds
    s_add_u32 m0, s12, 86016
    s_add_u32 s54, s11, 4096
    buffer_load_dwordx4 v4, s[36:39], s54 offen offset:0 sc1 lds
    buffer_load_dwordx4 v4, s[36:39], s54 offen offset:1024 sc1 lds
    buffer_load_dwordx4 v4, s[36:39], s54 offen offset:2048 sc1 lds
    buffer_load_dwordx4 v4, s[36:39], s54 offen offset:3072 sc1 lds
    s_add_u32 m0, s12, 90112
    s_add_u32 s54, s11, 8192
    buffer_load_dwordx4 v4, s[36:39], s54 offen offset:0 sc1 lds
    buffer_load_dwordx4 v4, s[36:39], s54 offen offset:1024 sc1 lds
    buffer_load_dwordx4 a[112:115], v4, s[36:39], s7 offen offset:1024 sc1
    buffer_load_dwordx4 a[116:119], v4, s[36:39], s7 offen offset:2048 sc1
    buffer_load_dwordx4 a[120:123], v4, s[36:39], s8 offen offset:0 sc1
    buffer_load_dwordx4 a[124:127], v4, s[36:39], s8 offen offset:1024 sc1
    buffer_load_dwordx4 a[128:131], v4, s[36:39], s8 offen offset:2048 sc1
    s_add_u32 s8, s8, 3072
    buffer_load_dwordx4 a[132:135], v4, s[36:39], s8 offen offset:0 sc1
    buffer_load_dwordx4 a[136:139], v4, s[36:39], s8 offen offset:1024 sc1
    buffer_load_dwordx4 a[140:143], v4, s[36:39], s8 offen offset:2048 sc1
    v_mov_b32 v24, 0
    buffer_atomic_add v24, v23, s[36:39], s16 offen offset:4 sc0 sc1
    v_mfma_f32_16x16x32_bf16 v[180:183], a[0:3], v[12:15], 0
    v_mfma_f32_16x16x32_bf16 v[184:187], a[4:7], v[12:15], 0
    v_mfma_f32_16x16x32_bf16 v[188:191], a[8:11], v[12:15], 0
    v_mfma_f32_16x16x32_bf16 v[180:183], a[12:15], v[12:15], v[180:183]
    v_mfma_f32_16x16x32_bf16 v[184:187], a[16:19], v[12:15], v[184:187]
    v_mfma_f32_16x16x32_bf16 v[188:191], a[20:23], v[12:15], v[188:191]
    v_mfma_f32_16x16x32_bf16 v[180:183], a[24:27], v[12:15], v[180:183]
    v_mfma_f32_16x16x32_bf16 v[184:187], a[28:31], v[12:15], v[184:187]
    v_mfma_f32_16x16x32_bf16 v[188:191], a[32:35], v[12:15], v[188:191]
    v_mfma_f32_16x16x32_bf16 v[180:183], a[36:39], v[12:15], v[180:183]
    v_mfma_f32_16x16x32_bf16 v[184:187], a[40:43], v[12:15], v[184:187]
    v_mfma_f32_16x16x32_bf16 v[188:191], a[44:47], v[12:15], v[188:191]
    v_mfma_f32_16x16x32_bf16 v[180:183], a[48:51], v[12:15], v[180:183]
    v_mfma_f32_16x16x32_bf16 v[184:187], a[52:55], v[12:15], v[184:187]
    v_mfma_f32_16x16x32_bf16 v[188:191], a[56:59], v[12:15], v[188:191]
    v_mfma_f32_16x16x32_bf16 v[180:183], a[60:63], v[12:15], v[180:183]
    v_mfma_f32_16x16x32_bf16 v[184:187], a[64:67], v[12:15], v[184:187]
    v_mfma_f32_16x16x32_bf16 v[188:191], a[68:71], v[12:15], v[188:191]
    s_branch Lconvd
Lhelp:
    s_cmp_eq_u32 s45, 3
    s_cbranch_scc1 Lwarm_reth
    s_mov_b64 exec, 0
    s_cmp_eq_u32 s45, 0
    s_cbranch_scc1 Lwarm0
    s_cmp_eq_u32 s45, 1
    s_cbranch_scc1 Lwarm1
    s_branch Lwarm2
Lwarm_reth:
    s_sub_u32 s3, s2, 214
    s_add_u32 s67, s3, 168
    s_cmp_eq_u32 s45, 0
    s_cselect_b32 s67, s67, 192
    s_lshl2_add_u32 s3, s3, s45
    s_mul_i32 s66, s45, 20480
    s_mov_b32 s63, 1073741824
    s_barrier
    s_mul_i32 s59, s3, 10240
    v_add_u32 v5, s59, v4
    v_add_u32 v6, 4096, v5
    v_add_u32 v7, 8192, v5
    s_add_u32 m0, s66, 0
    s_nop 0
    global_load_lds_dwordx4 v5, s[28:29] offset:0
    global_load_lds_dwordx4 v5, s[28:29] offset:1024
    global_load_lds_dwordx4 v5, s[28:29] offset:2048
    global_load_lds_dwordx4 v5, s[28:29] offset:3072
    s_add_u32 m0, s66, 4096
    s_nop 0
    global_load_lds_dwordx4 v6, s[28:29] offset:0
    global_load_lds_dwordx4 v6, s[28:29] offset:1024
    global_load_lds_dwordx4 v6, s[28:29] offset:2048
    global_load_lds_dwordx4 v6, s[28:29] offset:3072
    s_add_u32 m0, s66, 8192
    s_nop 0
    global_load_lds_dwordx4 v7, s[28:29] offset:0
    global_load_lds_dwordx4 v7, s[28:29] offset:1024
    s_cmp_ge_u32 s67, 192
    s_cbranch_scc1 Lw2a
    s_mul_i32 s59, s67, 10240
    v_add_u32 v5, s59, v4
    v_add_u32 v6, 4096, v5
    v_add_u32 v7, 8192, v5
    s_add_u32 m0, s66, 10240
    s_nop 0
    global_load_lds_dwordx4 v5, s[28:29] offset:0
    global_load_lds_dwordx4 v5, s[28:29] offset:1024
    global_load_lds_dwordx4 v5, s[28:29] offset:2048
    global_load_lds_dwordx4 v5, s[28:29] offset:3072
    s_add_u32 m0, s66, 14336
    s_nop 0
    global_load_lds_dwordx4 v6, s[28:29] offset:0
    global_load_lds_dwordx4 v6, s[28:29] offset:1024
    global_load_lds_dwordx4 v6, s[28:29] offset:2048
    global_load_lds_dwordx4 v6, s[28:29] offset:3072
    s_add_u32 m0, s66, 18432
    s_nop 0
    global_load_lds_dwordx4 v7, s[28:29] offset:0
    global_load_lds_dwordx4 v7, s[28:29] offset:1024
Lw2a:
    s_cmp_lg_u32 s45, 3
    s_cbranch_scc1 Lwarm_reth3
    s_mov_b64 exec, 0
    s_branch Lwarm3
Lwarm_reth3:
    v_bfe_u32 v5, v1, 2, 2
    v_mul_u32_u24 v61, 1280, v5
    v_and_b32 v5, 3, v1
    v_lshl_add_u32 v61, v5, 3, v61
    v_lshl_add_u32 v61, v3, 5, v61
    v_add_u32 v61, s66, v61
    v_add_u32 v5, 0, v3
    v_mul_u32_u24 v6, 13108, v5
    v_lshrrev_b32 v6, 16, v6
    v_mul_u32_u24 v6, 240640, v6
    v_lshl_add_u32 v6, v5, 10, v6
    v_lshl_add_u32 v104, v2, 4, v6
    v_add_u32 v5, 4, v3
    v_mul_u32_u24 v6, 13108, v5
    v_lshrrev_b32 v6, 16, v6
    v_mul_u32_u24 v6, 240640, v6
    v_lshl_add_u32 v6, v5, 10, v6
    v_lshl_add_u32 v105, v2, 4, v6
    v_add_u32 v5, 8, v3
    v_mul_u32_u24 v6, 13108, v5
    v_lshrrev_b32 v6, 16, v6
    v_mul_u32_u24 v6, 240640, v6
    v_lshl_add_u32 v6, v5, 10, v6
    v_lshl_add_u32 v106, v2, 4, v6
    v_add_u32 v5, 12, v3
    v_mul_u32_u24 v6, 13108, v5
    v_lshrrev_b32 v6, 16, v6
    v_mul_u32_u24 v6, 240640, v6
    v_lshl_add_u32 v6, v5, 10, v6
    v_lshl_add_u32 v107, v2, 4, v6
    v_add_u32 v5, 16, v3
    v_mul_u32_u24 v6, 13108, v5
    v_lshrrev_b32 v6, 16, v6
    v_mul_u32_u24 v6, 240640, v6
    v_lshl_add_u32 v6, v5, 10, v6
    v_lshl_add_u32 v108, v2, 4, v6
    v_add_u32 v5, 20, v3
    v_mul_u32_u24 v6, 13108, v5
    v_lshrrev_b32 v6, 16, v6
    v_mul_u32_u24 v6, 240640, v6
    v_lshl_add_u32 v6, v5, 10, v6
    v_lshl_add_u32 v109, v2, 4, v6
    v_add_u32 v5, 24, v3
    v_mul_u32_u24 v6, 13108, v5
    v_lshrrev_b32 v6, 16, v6
    v_mul_u32_u24 v6, 240640, v6
    v_lshl_add_u32 v6, v5, 10, v6
    v_lshl_add_u32 v110, v2, 4, v6
    v_add_u32 v5, 28, v3
    v_mul_u32_u24 v6, 13108, v5
    v_lshrrev_b32 v6, 16, v6
    v_mul_u32_u24 v6, 240640, v6
    v_lshl_add_u32 v6, v5, 10, v6
    v_lshl_add_u32 v111, v2, 4, v6
    v_add_u32 v5, 32, v3
    v_mul_u32_u24 v6, 13108, v5
    v_lshrrev_b32 v6, 16, v6
    v_mul_u32_u24 v6, 240640, v6
    v_lshl_add_u32 v6, v5, 10, v6
    v_lshl_add_u32 v112, v2, 4, v6
    v_add_u32 v5, 36, v3
    v_mul_u32_u24 v6, 13108, v5
    v_lshrrev_b32 v6, 16, v6
    v_mul_u32_u24 v6, 240640, v6
    v_lshl_add_u32 v6, v5, 10, v6
    v_lshl_add_u32 v113, v2, 4, v6
    v_mov_b32 v12, 0x3f803f80
    v_mov_b32 v13, 0x3f803f80
    v_mov_b32 v14, 0x3f803f80
    v_mov_b32 v15, 0x3f803f80
    v_lshrrev_b32 v7, 2, v1
    v_lshlrev_b32 v7, 6, v7
    v_and_b32 v6, 3, v1
    v_lshl_add_u32 v7, v6, 3, v7
    v_and_b32 v6, 1, v3
    v_lshl_add_u32 v7, v6, 5, v7
    s_xor_b32 s57, s4, 0
    s_mul_i32 s57, s57, 10240
    s_add_u32 s57, s57, 81920
    v_add_u32 v64, s57, v7
    v_xor_b32 v68, 32, v64
    s_xor_b32 s57, s4, 1
    s_mul_i32 s57, s57, 10240
    s_add_u32 s57, s57, 81920
    v_add_u32 v65, s57, v7
    v_xor_b32 v69, 32, v65
    s_xor_b32 s57, s4, 2
    s_mul_i32 s57, s57, 10240
    s_add_u32 s57, s57, 81920
    v_add_u32 v66, s57, v7
    v_xor_b32 v70, 32, v66
    s_xor_b32 s57, s4, 3
    s_mul_i32 s57, s57, 10240
    s_add_u32 s57, s57, 81920
    v_add_u32 v67, s57, v7
    v_xor_b32 v71, 32, v67
    s_lshr_b32 s60, s3, 2
    s_and_b32 s58, s3, 3
    s_mul_i32 s61, s3, 2731
    s_lshr_b32 s61, s61, 16
    s_lshl_b32 s61, s61, 7
    s_add_u32 s61, s61, 262156
    s_mul_i32 s59, s60, 5120
    s_lshl_b32 s58, s58, 8
    s_add_u32 s59, s59, s58
    s_add_u32 s59, s59, 10612736
    s_waitcnt vmcnt(0)
    ds_read_b64_tr_b16 v[148:149], v61 offset:0
    ds_read_b64_tr_b16 v[150:151], v61 offset:5120
    ds_read_b64_tr_b16 v[152:153], v61 offset:128
    ds_read_b64_tr_b16 v[154:155], v61 offset:5248
    ds_read_b64_tr_b16 v[156:157], v61 offset:256
    ds_read_b64_tr_b16 v[158:159], v61 offset:5376
    ds_read_b64_tr_b16 v[160:161], v61 offset:384
    ds_read_b64_tr_b16 v[162:163], v61 offset:5504
    ds_read_b64_tr_b16 v[164:165], v61 offset:512
    ds_read_b64_tr_b16 v[166:167], v61 offset:5632
    ds_read_b64_tr_b16 v[168:169], v61 offset:640
    ds_read_b64_tr_b16 v[170:171], v61 offset:5760
    ds_read_b64_tr_b16 v[172:173], v61 offset:768
    ds_read_b64_tr_b16 v[174:175], v61 offset:5888
    ds_read_b64_tr_b16 v[176:177], v61 offset:896
    ds_read_b64_tr_b16 v[178:179], v61 offset:6016
    ds_read_b64_tr_b16 v[180:181], v61 offset:1024
    ds_read_b64_tr_b16 v[182:183], v61 offset:6144
    ds_read_b64_tr_b16 v[184:185], v61 offset:1152
    ds_read_b64_tr_b16 v[186:187], v61 offset:6272
    s_waitcnt lgkmcnt(15)
    buffer_store_dwordx4 v[148:151], v104, s[36:39], s59 offen sc1
    buffer_store_dwordx4 v[152:155], v105, s[36:39], s59 offen sc1
    s_waitcnt lgkmcnt(14)
    buffer_store_dwordx4 v[156:159], v106, s[36:39], s59 offen sc1
    s_waitcnt lgkmcnt(12)
    buffer_store_dwordx4 v[160:163], v107, s[36:39], s59 offen sc1
    s_waitcnt lgkmcnt(10)
    buffer_store_dwordx4 v[164:167], v108, s[36:39], s59 offen sc1
    s_waitcnt lgkmcnt(8)
    buffer_store_dwordx4 v[168:171], v109, s[36:39], s59 offen sc1
    s_waitcnt lgkmcnt(6)
    buffer_store_dwordx4 v[172:175], v110, s[36:39], s59 offen sc1
    s_waitcnt lgkmcnt(4)
    buffer_store_dwordx4 v[176:179], v111, s[36:39], s59 offen sc1
    s_waitcnt lgkmcnt(2)
    buffer_store_dwordx4 v[180:183], v112, s[36:39], s59 offen sc1
    s_waitcnt lgkmcnt(0)
    buffer_store_dwordx4 v[184:187], v113, s[36:39], s59 offen sc1
    s_cmp_ge_u32 s67, 192
    s_cbranch_scc1 Lw2one
    s_lshr_b32 s60, s67, 2
    s_and_b32 s58, s67, 3
    s_mul_i32 s63, s67, 2731
    s_lshr_b32 s63, s63, 16
    s_lshl_b32 s63, s63, 7
    s_add_u32 s63, s63, 262156
    s_mul_i32 s59, s60, 5120
    s_lshl_b32 s58, s58, 8
    s_add_u32 s59, s59, s58
    s_add_u32 s59, s59, 10612736
    ds_read_b64_tr_b16 v[148:149], v61 offset:10240
    ds_read_b64_tr_b16 v[150:151], v61 offset:15360
    ds_read_b64_tr_b16 v[152:153], v61 offset:10368
    ds_read_b64_tr_b16 v[154:155], v61 offset:15488
    ds_read_b64_tr_b16 v[156:157], v61 offset:10496
    ds_read_b64_tr_b16 v[158:159], v61 offset:15616
    ds_read_b64_tr_b16 v[160:161], v61 offset:10624
    ds_read_b64_tr_b16 v[162:163], v61 offset:15744
    ds_read_b64_tr_b16 v[164:165], v61 offset:10752
    ds_read_b64_tr_b16 v[166:167], v61 offset:15872
    ds_read_b64_tr_b16 v[168:169], v61 offset:10880
    ds_read_b64_tr_b16 v[170:171], v61 offset:16000
    ds_read_b64_tr_b16 v[172:173], v61 offset:11008
    ds_read_b64_tr_b16 v[174:175], v61 offset:16128
    ds_read_b64_tr_b16 v[176:177], v61 offset:11136
    ds_read_b64_tr_b16 v[178:179], v61 offset:16256
    ds_read_b64_tr_b16 v[180:181], v61 offset:11264
    ds_read_b64_tr_b16 v[182:183], v61 offset:16384
    ds_read_b64_tr_b16 v[184:185], v61 offset:11392
    ds_read_b64_tr_b16 v[186:187], v61 offset:16512
    s_waitcnt lgkmcnt(15)
    buffer_store_dwordx4 v[148:151], v104, s[36:39], s59 offen sc1
    buffer_store_dwordx4 v[152:155], v105, s[36:39], s59 offen sc1
    s_waitcnt lgkmcnt(14)
    buffer_store_dwordx4 v[156:159], v106, s[36:39], s59 offen sc1
    s_waitcnt lgkmcnt(12)
    buffer_store_dwordx4 v[160:163], v107, s[36:39], s59 offen sc1
    s_waitcnt lgkmcnt(10)
    buffer_store_dwordx4 v[164:167], v108, s[36:39], s59 offen sc1
    s_waitcnt lgkmcnt(8)
    buffer_store_dwordx4 v[168:171], v109, s[36:39], s59 offen sc1
    s_waitcnt lgkmcnt(6)
    buffer_store_dwordx4 v[172:175], v110, s[36:39], s59 offen sc1
    s_waitcnt lgkmcnt(4)
    buffer_store_dwordx4 v[176:179], v111, s[36:39], s59 offen sc1
    s_waitcnt lgkmcnt(2)
    buffer_store_dwordx4 v[180:183], v112, s[36:39], s59 offen sc1
    s_waitcnt lgkmcnt(0)
    buffer_store_dwordx4 v[184:187], v113, s[36:39], s59 offen sc1
Lw2one:
    s_cmp_lg_u32 s45, 3
    s_cbranch_scc1 Lhnp
    v_mov_b32 v24, 0
    buffer_atomic_add v24, v22, s[36:39], 0 offen offset:16 sc0 sc1
    s_add_u32 s50, s44, 20
    s_waitcnt vmcnt(0)
    v_cmp_ne_u32 vcc, s50, v24
    s_nop 0
    s_and_b64 vcc, vcc, 0xf
    s_cbranch_scc1 Lslow20
Lgot21:
Lhnp:
    s_barrier
    buffer_load_dwordx4 a[0:3], v4, s[36:39], s6 offen offset:0 sc1
    buffer_load_dwordx4 a[4:7], v4, s[36:39], s6 offen offset:1024 sc1
    buffer_load_dwordx4 a[8:11], v4, s[36:39], s6 offen offset:2048 sc1
    s_add_u32 s6, s6, 3072
    buffer_load_dwordx4 a[12:15], v4, s[36:39], s6 offen offset:0 sc1
    buffer_load_dwordx4 a[16:19], v4, s[36:39], s6 offen offset:1024 sc1
    buffer_load_dwordx4 a[20:23], v4, s[36:39], s6 offen offset:2048 sc1
    s_add_u32 s6, s6, 3072
    buffer_load_dwordx4 a[24:27], v4, s[36:39], s6 offen offset:0 sc1
    buffer_load_dwordx4 a[28:31], v4, s[36:39], s6 offen offset:1024 sc1
    buffer_load_dwordx4 a[32:35], v4, s[36:39], s6 offen offset:2048 sc1
    s_add_u32 s6, s6, 3072
    buffer_load_dwordx4 a[36:39], v4, s[36:39], s6 offen offset:0 sc1
    buffer_load_dwordx4 a[40:43], v4, s[36:39], s6 offen offset:1024 sc1
    buffer_load_dwordx4 a[44:47], v4, s[36:39], s6 offen offset:2048 sc1
    s_add_u32 s6, s6, 3072
    buffer_load_dwordx4 a[48:51], v4, s[36:39], s6 offen offset:0 sc1
    buffer_load_dwordx4 a[52:55], v4, s[36:39], s6 offen offset:1024 sc1
    buffer_load_dwordx4 a[56:59], v4, s[36:39], s6 offen offset:2048 sc1
    buffer_load_dwordx4 a[60:63], v4, s[36:39], s7 offen offset:0 sc1
    buffer_load_dwordx4 a[64:67], v4, s[36:39], s7 offen offset:1024 sc1
    buffer_load_dwordx4 a[68:71], v4, s[36:39], s7 offen offset:2048 sc1
    s_add_u32 s7, s7, 3072
    buffer_load_dwordx4 a[72:75], v4, s[36:39], s7 offen offset:0 sc1
    buffer_load_dwordx4 a[76:79], v4, s[36:39], s7 offen offset:1024 sc1
    buffer_load_dwordx4 a[80:83], v4, s[36:39], s7 offen offset:2048 sc1
    s_add_u32 s7, s7, 3072
    buffer_load_dwordx4 a[84:87], v4, s[36:39], s7 offen offset:0 sc1
    buffer_load_dwordx4 a[88:91], v4, s[36:39], s7 offen offset:1024 sc1
    buffer_load_dwordx4 a[92:95], v4, s[36:39], s7 offen offset:2048 sc1
    s_add_u32 s7, s7, 3072
    buffer_load_dwordx4 a[96:99], v4, s[36:39], s7 offen offset:0 sc1
    buffer_load_dwordx4 a[100:103], v4, s[36:39], s7 offen offset:1024 sc1
    buffer_load_dwordx4 a[104:107], v4, s[36:39], s7 offen offset:2048 sc1
    s_add_u32 s7, s7, 3072
    buffer_load_dwordx4 a[108:111], v4, s[36:39], s7 offen offset:0 sc1
    v_mov_b32 v24, 0
    buffer_atomic_add v24, v23, s[36:39], s16 offen offset:0 sc0 sc1
    s_waitcnt vmcnt(29)
    buffer_atomic_add v27, v30, s[36:39], s61 offen offset:0 sc1
    buffer_atomic_add v27, v30, s[36:39], s63 offen offset:0 sc1
    s_add_u32 s50, s44, 27
    s_waitcnt vmcnt(2)
    v_cmp_ne_u32 vcc, s50, v24
    s_nop 0
    s_and_b64 vcc, vcc, 0x7
    s_cbranch_scc1 Lslow23
Lgot24:
    s_add_u32 m0, s12, 81920
    s_add_u32 s54, s11, 0
    buffer_load_dwordx4 v4, s[36:39], s54 offen offset:0 sc1 lds
    buffer_load_dwordx4 v4, s[36:39], s54 offen offset:1024 sc1 lds
    buffer_load_dwordx4 v4, s[36:39], s54 offen offset:2048 sc1 lds
    buffer_load_dwordx4 v4, s[36:39], s54 offen offset:3072 sc1 lds
    s_add_u32 m0, s12, 86016
    s_add_u32 s54, s11, 4096
    buffer_load_dwordx4 v4, s[36:39], s54 offen offset:0 sc1 lds
    buffer_load_dwordx4 v4, s[36:39], s54 offen offset:1024 sc1 lds
    buffer_load_dwordx4 v4, s[36:39], s54 offen offset:2048 sc1 lds
    buffer_load_dwordx4 v4, s[36:39], s54 offen offset:3072 sc1 lds
    s_add_u32 m0, s12, 90112
    s_add_u32 s54, s11, 8192
    buffer_load_dwordx4 v4, s[36:39], s54 offen offset:0 sc1 lds
    buffer_load_dwordx4 v4, s[36:39], s54 offen offset:1024 sc1 lds
    buffer_load_dwordx4 a[112:115], v4, s[36:39], s7 offen offset:1024 sc1
    buffer_load_dwordx4 a[116:119], v4, s[36:39], s7 offen offset:2048 sc1
    buffer_load_dwordx4 a[120:123], v4, s[36:39], s8 offen offset:0 sc1
    buffer_load_dwordx4 a[124:127], v4, s[36:39], s8 offen offset:1024 sc1
    buffer_load_dwordx4 a[128:131], v4, s[36:39], s8 offen offset:2048 sc1
    s_add_u32 s8, s8, 3072
    buffer_load_dwordx4 a[132:135], v4, s[36:39], s8 offen offset:0 sc1
    buffer_load_dwordx4 a[136:139], v4, s[36:39], s8 offen offset:1024 sc1
    buffer_load_dwordx4 a[140:143], v4, s[36:39], s8 offen offset:2048 sc1
    v_mov_b32 v24, 0
    buffer_atomic_add v24, v23, s[36:39], s16 offen offset:4 sc0 sc1
    v_mfma_f32_16x16x32_bf16 v[180:183], a[0:3], v[12:15], 0
    v_mfma_f32_16x16x32_bf16 v[184:187], a[4:7], v[12:15], 0
    v_mfma_f32_16x16x32_bf16 v[188:191], a[8:11], v[12:15], 0
    v_mfma_f32_16x16x32_bf16 v[180:183], a[12:15], v[12:15], v[180:183]
    v_mfma_f32_16x16x32_bf16 v[184:187], a[16:19], v[12:15], v[184:187]
    v_mfma_f32_16x16x32_bf16 v[188:191], a[20:23], v[12:15], v[188:191]
    v_mfma_f32_16x16x32_bf16 v[180:183], a[24:27], v[12:15], v[180:183]
    v_mfma_f32_16x16x32_bf16 v[184:187], a[28:31], v[12:15], v[184:187]
    v_mfma_f32_16x16x32_bf16 v[188:191], a[32:35], v[12:15], v[188:191]
    v_mfma_f32_16x16x32_bf16 v[180:183], a[36:39], v[12:15], v[180:183]
    v_mfma_f32_16x16x32_bf16 v[184:187], a[40:43], v[12:15], v[184:187]
    v_mfma_f32_16x16x32_bf16 v[188:191], a[44:47], v[12:15], v[188:191]
    v_mfma_f32_16x16x32_bf16 v[180:183], a[48:51], v[12:15], v[180:183]
    v_mfma_f32_16x16x32_bf16 v[184:187], a[52:55], v[12:15], v[184:187]
    v_mfma_f32_16x16x32_bf16 v[188:191], a[56:59], v[12:15], v[188:191]
    v_mfma_f32_16x16x32_bf16 v[180:183], a[60:63], v[12:15], v[180:183]
    v_mfma_f32_16x16x32_bf16 v[184:187], a[64:67], v[12:15], v[184:187]
    v_mfma_f32_16x16x32_bf16 v[188:191], a[68:71], v[12:15], v[188:191]
Lconvd:
Lwarm0_3:
    s_cbranch_execz Lwarm0_4
    s_waitcnt vmcnt(9)
    s_waitcnt lgkmcnt(0)
    s_barrier
    ds_read_b64_tr_b16 v[120:121], v64 offset:0
    ds_read_b64_tr_b16 v[122:123], v64 offset:1024
    ds_read_b64_tr_b16 v[124:125], v68 offset:0
    ds_read_b64_tr_b16 v[126:127], v68 offset:1024
    ds_read_b64_tr_b16 v[128:129], v64 offset:2048
    ds_read_b64_tr_b16 v[130:131], v64 offset:3072
    ds_read_b64_tr_b16 v[132:133], v68 offset:2048
    ds_read_b64_tr_b16 v[134:135], v68 offset:3072
    s_waitcnt lgkmcnt(6)
    v_mfma_f32_16x16x32_bf16 v[72:75], a[0:3], v[120:123], 0
    s_waitcnt lgkmcnt(4)
    ds_read_b64_tr_b16 v[136:137], v64 offset:4096
    v_lshrrev_b32 v6, 1, v1
    v_mfma_f32_16x16x32_bf16 v[84:87], a[0:3], v[124:127], 0
    s_add_u32 s8, s8, 3072
    ds_read_b64_tr_b16 v[138:139], v64 offset:5120
    buffer_load_dwordx4 a[144:147], v4, s[36:39], s8 offen offset:0 sc1
    v_mfma_f32_16x16x32_bf16 v[76:79], a[4:7], v[120:123], 0
    v_min_u32 v6, 1, v6
    v_lshl_add_u32 v6, v6, 23, v1
    v_mfma_f32_16x16x32_bf16 v[88:91], a[4:7], v[124:127], 0
    s_lshl_b32 s55, s45, 8
    ds_read_b64_tr_b16 v[140:141], v68 offset:4096
    v_lshl_add_u32 v155, v6, 7, s55
    v_mfma_f32_16x16x32_bf16 v[80:83], a[8:11], v[120:123], 0
    s_lshl_b32 s55, s48, 5
    ds_read_b64_tr_b16 v[142:143], v68 offset:5120
    v_xor_b32 v7, s55, v7
    v_mfma_f32_16x16x32_bf16 v[92:95], a[8:11], v[124:127], 0
    s_waitcnt lgkmcnt(6)
    buffer_load_dwordx4 a[148:151], v4, s[36:39], s8 offen offset:1024 sc1
    s_mul_i32 s56, s49, 5120
    v_mfma_f32_16x16x32_bf16 v[72:75], a[12:15], v[128:131], v[72:75]
    s_waitcnt lgkmcnt(4)
    ds_read_b64_tr_b16 v[120:121], v64 offset:6144
    s_add_u32 s56, s56, 81920
    v_mfma_f32_16x16x32_bf16 v[84:87], a[12:15], v[132:135], v[84:87]
    s_lshl_b32 s55, s45, 10
    ds_read_b64_tr_b16 v[122:123], v64 offset:7168
    s_add_u32 s55, s55, s56
    v_mfma_f32_16x16x32_bf16 v[76:79], a[16:19], v[128:131], v[76:79]
Lwarm1_3:
    s_cbranch_execz Lwarm1_4
    v_add_u32 v8, s55, v7
    s_add_u32 s56, s56, 4096
    v_mfma_f32_16x16x32_bf16 v[88:91], a[16:19], v[132:135], v[88:91]
    ds_read_b64_tr_b16 v[124:125], v68 offset:6144
    buffer_load_dwordx4 a[152:155], v4, s[36:39], s8 offen offset:2048 sc1
    v_mfma_f32_16x16x32_bf16 v[80:83], a[20:23], v[128:131], v[80:83]
    ds_read_b64_tr_b16 v[126:127], v68 offset:7168
    v_add_u32 v9, s56, v7
    v_mfma_f32_16x16x32_bf16 v[92:95], a[20:23], v[132:135], v[92:95]
    s_waitcnt lgkmcnt(6)
    s_lshl2_add_u32 s18, s46, s45
    s_lshl_b32 s18, s18, 7
    v_mfma_f32_16x16x32_bf16 v[72:75], a[24:27], v[136:139], v[72:75]
    s_waitcnt lgkmcnt(4)
    ds_read_b64_tr_b16 v[128:129], v64 offset:8192
    s_add_u32 s18, s18, 280576
    v_mfma_f32_16x16x32_bf16 v[84:87], a[24:27], v[140:143], v[84:87]
    s_add_u32 s8, s8, 3072
    ds_read_b64_tr_b16 v[130:131], v64 offset:9216
    buffer_load_dwordx4 a[156:159], v4, s[36:39], s8 offen offset:0 sc1
    v_mfma_f32_16x16x32_bf16 v[76:79], a[28:31], v[136:139], v[76:79]
    v_lshlrev_b32 v28, 4, v0
    v_add_u32 v29, 4096, v28
    v_mfma_f32_16x16x32_bf16 v[88:91], a[28:31], v[140:143], v[88:91]
    s_mov_b32 s20, 0x22222222
    ds_read_b64_tr_b16 v[132:133], v68 offset:8192
    s_mov_b32 s21, 0x22222222
    v_mfma_f32_16x16x32_bf16 v[80:83], a[32:35], v[136:139], v[80:83]
    s_mov_b32 s22, 0x44444444
    ds_read_b64_tr_b16 v[134:135], v68 offset:9216
    s_mov_b32 s23, 0x44444444
    v_mfma_f32_16x16x32_bf16 v[92:95], a[32:35], v[140:143], v[92:95]
    s_waitcnt lgkmcnt(6)
    s_mov_b32 s24, 0x88888888
    s_mov_b32 s25, 0x88888888
    v_mfma_f32_16x16x32_bf16 v[72:75], a[36:39], v[120:123], v[72:75]
    s_waitcnt lgkmcnt(4)
    ds_read_b64_tr_b16 v[136:137], v65 offset:0
    buffer_load_dwordx4 a[160:163], v4, s[36:39], s8 offen offset:1024 sc1
    v_mfma_f32_16x16x32_bf16 v[84:87], a[36:39], v[124:127], v[84:87]
    ds_read_b64_tr_b16 v[138:139], v65 offset:1024
    v_lshrrev_b32 v7, 2, v2
    v_mfma_f32_16x16x32_bf16 v[76:79], a[40:43], v[120:123], v[76:79]
    v_lshl_add_u32 v6, v7, 4, v2
    v_lshrrev_b32 v7, 1, v3
    v_mfma_f32_16x16x32_bf16 v[88:91], a[40:43], v[124:127], v[88:91]
    ds_read_b64_tr_b16 v[140:141], v69 offset:0
    v_lshl_add_u32 v6, v6, 1, v7
    v_mfma_f32_16x16x32_bf16 v[80:83], a[44:47], v[120:123], v[80:83]
    ds_read_b64_tr_b16 v[142:143], v69 offset:1024
    buffer_load_dwordx4 a[164:167], v4, s[36:39], s8 offen offset:2048 sc1
    v_mfma_f32_16x16x32_bf16 v[92:95], a[44:47], v[124:127], v[92:95]
    s_waitcnt lgkmcnt(6)
    v_lshlrev_b32 v42, 3, v6
    s_mul_i32 s19, s45, 18432
    v_mfma_f32_16x16x32_bf16 v[72:75], a[48:51], v[128:131], v[72:75]
    s_waitcnt lgkmcnt(4)
    ds_read_b64_tr_b16 v[120:121], v65 offset:2048
    s_add_u32 s19, s19, 8192
    v_mfma_f32_16x16x32_bf16 v[84:87], a[48:51], v[132:135], v[84:87]
    ds_read_b64_tr_b16 v[122:123], v65 offset:3072
    v_add_u32 v10, s19, v4
    v_mfma_f32_16x16x32_bf16 v[76:79], a[52:55], v[128:131], v[76:79]
    s_add_u32 s8, s8, 3072
    buffer_load_dwordx4 a[168:171], v4, s[36:39], s8 offen offset:0 sc1
    v_mul_u32_u24 v7, 49152, v7
    v_mfma_f32_16x16x32_bf16 v[88:91], a[52:55], v[132:135], v[88:91]
    ds_read_b64_tr_b16 v[124:125], v69 offset:2048
    v_lshl_add_u32 v7, v2, 4, v7
    v_mfma_f32_16x16x32_bf16 v[80:83], a[56:59], v[128:131], v[80:83]
    ds_read_b64_tr_b16 v[126:127], v69 offset:3072
    v_and_b32 v6, 1, v3
    v_mfma_f32_16x16x32_bf16 v[92:95], a[56:59], v[132:135], v[92:95]
    s_waitcnt lgkmcnt(6)
    v_lshl_add_u32 v158, v6, 8, v7
    v_lshl_add_u32 v159, v6, 30, v7
    v_mfma_f32_16x16x32_bf16 v[72:75], a[60:63], v[136:139], v[72:75]
    s_waitcnt lgkmcnt(4)
    s_waitcnt vmcnt(14)
    ds_read_b64_tr_b16 v[128:129], v65 offset:4096
    ds_add_rtn_u32 v26, v21, v27 offset:512
    v_mfma_f32_16x16x32_bf16 v[84:87], a[60:63], v[140:143], v[84:87]
    buffer_load_dwordx4 a[172:175], v4, s[36:39], s8 offen offset:1024 sc1
    s_lshl2_add_u32 s14, s47, s45
    v_mfma_f32_16x16x32_bf16 v[76:79], a[64:67], v[136:139], v[76:79]
    s_mul_i32 s10, s14, 768
    ds_read_b64_tr_b16 v[130:131], v65 offset:5120
    s_mul_i32 s55, s46, 98304
    v_mfma_f32_16x16x32_bf16 v[88:91], a[64:67], v[140:143], v[88:91]
    s_add_u32 s10, s10, s55
    s_add_u32 s10, s10, 12578816
    s_lshr_b32 s14, s47, 2
    v_mfma_f32_16x16x32_bf16 v[80:83], a[68:71], v[136:139], v[80:83]
    s_lshl2_add_u32 s14, s46, s14
    s_lshl_b32 s14, s14, 7
    s_add_u32 s14, s14, 280576
    v_mfma_f32_16x16x32_bf16 v[92:95], a[68:71], v[140:143], v[92:95]
    ds_read_b64_tr_b16 v[132:133], v69 offset:4096
    buffer_load_dwordx4 a[176:179], v4, s[36:39], s8 offen offset:2048 sc1
    v_mfma_f32_16x16x32_bf16 v[48:51], v[136:139], v[136:139], 0
    s_waitcnt lgkmcnt(2)
    v_xor_b32 v26, 2, v26
    v_lshl_add_u32 v26, v26, 29, v30
    v_mfma_f32_16x16x32_bf16 v[56:59], v[12:15], v[136:139], 0
    ds_read_b64_tr_b16 v[134:135], v69 offset:5120
    buffer_atomic_add v25, v26, s[36:39], s68 offen offset:8 sc1
    v_mfma_f32_16x16x32_bf16 v[52:55], v[140:143], v[140:143], 0
    s_mul_i32 s15, s49, 245760
    s_mul_i32 s55, s45, 61440
    s_add_u32 s15, s15, s55
    v_mfma_f32_16x16x32_bf16 v[60:63], v[12:15], v[140:143], 0
    buffer_load_dwordx4 a[180:183], v4, s[36:39], s9 offen offset:0 sc1
    s_add_u32 s15, s15, 10612736
    v_mfma_f32_16x16x32_bf16 v[72:75], a[72:75], v[120:123], v[72:75]
    ds_read_b64_tr_b16 v[136:137], v65 offset:6144
    v_add_u32 v20, 4096, v4
    v_mfma_f32_16x16x32_bf16 v[84:87], a[72:75], v[124:127], v[84:87]
    s_xor_b32 s56, s45, 0
    s_lshl_b32 s56, s56, 10
    v_add_u32 v16, s56, v4
    v_mfma_f32_16x16x32_bf16 v[76:79], a[76:79], v[120:123], v[76:79]
    s_xor_b32 s56, s45, 1
    s_lshl_b32 s56, s56, 10
    v_add_u32 v17, s56, v4
    v_mfma_f32_16x16x32_bf16 v[88:91], a[76:79], v[124:127], v[88:91]
    ds_read_b64_tr_b16 v[138:139], v65 offset:7168
    buffer_load_dwordx4 a[184:187], v4, s[36:39], s9 offen offset:1024 sc1
    v_mfma_f32_16x16x32_bf16 v[80:83], a[80:83], v[120:123], v[80:83]
    s_xor_b32 s56, s45, 2
    s_lshl_b32 s56, s56, 10
    v_add_u32 v18, s56, v4
    v_mfma_f32_16x16x32_bf16 v[92:95], a[80:83], v[124:127], v[92:95]
    s_xor_b32 s56, s45, 3
    s_lshl_b32 s56, s56, 10
    v_add_u32 v19, s56, v4
    v_mfma_f32_16x16x32_bf16 v[48:51], v[120:123], v[120:123], v[48:51]
    s_lshl1_add_u32 s56, s46, s48
    ds_read_b64_tr_b16 v[140:141], v69 offset:6144
    s_mul_i32 s17, s56, 49152
    v_mfma_f32_16x16x32_bf16 v[56:59], v[12:15], v[120:123], v[56:59]
    s_mul_i32 s57, s45, 12288
    s_add_u32 s17, s17, s57
    s_add_u32 s17, s17, 12578816
    v_mfma_f32_16x16x32_bf16 v[52:55], v[124:127], v[124:127], v[52:55]
    buffer_load_dwordx4 a[188:191], v4, s[36:39], s9 offen offset:2048 sc1
    s_and_b32 s13, s46, 3
    v_mfma_f32_16x16x32_bf16 v[60:63], v[12:15], v[124:127], v[60:63]
    s_lshl1_add_u32 s13, s13, s48
    ds_read_b64_tr_b16 v[142:143], v69 offset:7168
    s_lshl_b32 s13, s13, 5
    v_mfma_f32_16x16x32_bf16 v[180:183], a[72:75], v[12:15], v[180:183]
    s_and_b32 s57, s46, 12
    s_add_u32 s13, s13, s57
    s_mul_i32 s13, s13, 1280
    v_mfma_f32_16x16x32_bf16 v[184:187], a[76:79], v[12:15], v[184:187]
    s_mul_i32 s57, s49, 160
    s_add_u32 s13, s13, s57
    s_add_u32 s56, s46, s49
    v_mfma_f32_16x16x32_bf16 v[188:191], a[80:83], v[12:15], v[188:191]
    s_waitcnt lgkmcnt(6)
    s_add_u32 s50, s44, 27
    s_waitcnt vmcnt(13)
    v_cmp_ne_u32 vcc, s50, v24
    s_nop 0
    s_and_b64 vcc, vcc, 0x7
    s_cbranch_scc1 Lslow26
Lgot27:
    s_mul_i32 s57, s56, 21846
    s_lshr_b32 s57, s57, 16
    v_mfma_f32_16x16x32_bf16 v[72:75], a[84:87], v[128:131], v[72:75]
    s_waitcnt lgkmcnt(4)
    ds_read_b64_tr_b16 v[120:121], v65 offset:8192
    s_add_u32 m0, s12, 122880
    v_mfma_f32_16x16x32_bf16 v[84:87], a[84:87], v[132:135], v[84:87]
    s_add_u32 s54, s11, 40960
    buffer_load_dwordx4 v4, s[36:39], s54 offen offset:0 sc1 lds
    s_mul_i32 s57, s57, 3
    v_mfma_f32_16x16x32_bf16 v[76:79], a[88:91], v[128:131], v[76:79]
    s_sub_u32 s56, s56, s57
    s_mul_i32 s56, s56, 0
    s_mul_i32 s26, s56, 20480
    v_mfma_f32_16x16x32_bf16 v[88:91], a[88:91], v[132:135], v[88:91]
    ds_read_b64_tr_b16 v[122:123], v65 offset:9216
    buffer_load_dwordx4 v4, s[36:39], s54 offen offset:1024 sc1 lds
    v_mfma_f32_16x16x32_bf16 v[80:83], a[92:95], v[128:131], v[80:83]
    ds_read_b64_tr_b16 v[32:33], v8 offset:0
    ds_read_b64_tr_b16 v[172:173], v9 offset:0
    v_mfma_f32_16x16x32_bf16 v[92:95], a[92:95], v[132:135], v[92:95]
    s_add_u32 s26, s26, s15
    s_lshl_b32 s29, s56, 12
    s_add_u32 s29, s29, s17
    v_mfma_f32_16x16x32_bf16 v[48:51], v[128:131], v[128:131], v[48:51]
    s_lshl_b32 s56, s56, 1
    ds_read_b64_tr_b16 v[124:125], v69 offset:8192
    s_lshr_b32 s56, 9, s56
    v_mfma_f32_16x16x32_bf16 v[56:59], v[12:15], v[128:131], v[56:59]
    s_and_b32 s56, s56, 3
    s_mul_i32 s27, s56, 20480
    s_add_u32 s27, s27, s15
    v_mfma_f32_16x16x32_bf16 v[52:55], v[132:135], v[132:135], v[52:55]
    buffer_load_dwordx4 v4, s[36:39], s54 offen offset:2048 sc1 lds
    s_lshl_b32 s30, s56, 12
    v_mfma_f32_16x16x32_bf16 v[60:63], v[12:15], v[132:135], v[60:63]
    s_add_u32 s30, s30, s17
    ds_read_b64_tr_b16 v[126:127], v69 offset:9216
    s_lshl_b32 s56, s56, 1
    v_mfma_f32_16x16x32_bf16 v[180:183], a[84:87], v[12:15], v[180:183]
    s_lshr_b32 s56, 9, s56
    s_and_b32 s56, s56, 3
    s_mul_i32 s28, s56, 20480
    v_mfma_f32_16x16x32_bf16 v[184:187], a[88:91], v[12:15], v[184:187]
    s_add_u32 s28, s28, s15
    s_lshl_b32 s31, s56, 12
    s_add_u32 s31, s31, s17
    v_mfma_f32_16x16x32_bf16 v[188:191], a[92:95], v[12:15], v[188:191]
    s_waitcnt lgkmcnt(8)
    buffer_load_dwordx4 v4, s[36:39], s54 offen offset:3072 sc1 lds
    s_lshl_b32 s56, s56, 1
    v_mfma_f32_16x16x32_bf16 v[72:75], a[96:99], v[136:139], v[72:75]
    s_waitcnt lgkmcnt(6)
    ds_read_b64_tr_b16 v[128:129], v66 offset:0
    s_lshr_b32 s56, 9, s56
    v_mfma_f32_16x16x32_bf16 v[84:87], a[96:99], v[140:143], v[84:87]
    s_and_b32 s56, s56, 3
    s_sub_u32 s56, 3, s45
    s_mul_i32 s56, s56, 21504
    v_mfma_f32_16x16x32_bf16 v[76:79], a[100:103], v[136:139], v[76:79]
    s_add_u32 s56, s56, 78080
    v_mul_u32_u24 v6, 336, v2
    v_lshl_add_u32 v6, v3, 4, v6
    v_mfma_f32_16x16x32_bf16 v[88:91], a[100:103], v[140:143], v[88:91]
    s_add_u32 m0, s12, 126976
    ds_read_b64_tr_b16 v[130:131], v66 offset:1024
    v_add_u32 v22, s56, v6
    v_mfma_f32_16x16x32_bf16 v[80:83], a[104:107], v[136:139], v[80:83]
    s_add_u32 s54, s11, 45056
    buffer_load_dwordx4 v4, s[36:39], s54 offen offset:0 sc1 lds
    s_mov_b32 s62, 0x0c0c0c0c
    v_mfma_f32_16x16x32_bf16 v[92:95], a[104:107], v[140:143], v[92:95]
    s_cmp_eq_u32 s45, 0
    s_cselect_b32 s59, 0x01000c0c, s62
    s_cselect_b32 s60, 0xffff0000, 0
    v_mfma_f32_16x16x32_bf16 v[48:51], v[136:139], v[136:139], v[48:51]
    ds_read_b64_tr_b16 v[132:133], v70 offset:0
    v_mfma_f32_16x16x32_bf16 v[56:59], v[12:15], v[136:139], v[56:59]
    v_mfma_f32_16x16x32_bf16 v[52:55], v[140:143], v[140:143], v[52:55]
    ds_read_b64_tr_b16 v[134:135], v70 offset:1024
    buffer_load_dwordx4 v4, s[36:39], s54 offen offset:1024 sc1 lds
    v_mfma_f32_16x16x32_bf16 v[60:63], v[12:15], v[140:143], v[60:63]
    v_mfma_f32_16x16x32_bf16 v[180:183], a[96:99], v[12:15], v[180:183]
    v_mfma_f32_16x16x32_bf16 v[184:187], a[100:103], v[12:15], v[184:187]
    v_mfma_f32_16x16x32_bf16 v[188:191], a[104:107], v[12:15], v[188:191]
    s_waitcnt lgkmcnt(8)
    buffer_load_dwordx4 v4, s[36:39], s54 offen offset:2048 sc1 lds
    v_mfma_f32_16x16x32_bf16 v[72:75], a[108:111], v[120:123], v[72:75]
    s_waitcnt lgkmcnt(4)
    ds_read_b64_tr_b16 v[136:137], v66 offset:2048
    v_mfma_f32_16x16x32_bf16 v[84:87], a[108:111], v[124:127], v[84:87]
    v_mfma_f32_16x16x32_bf16 v[76:79], a[112:115], v[120:123], v[76:79]
    v_mfma_f32_16x16x32_bf16 v[88:91], a[112:115], v[124:127], v[88:91]
    ds_read_b64_tr_b16 v[138:139], v66 offset:3072
    buffer_load_dwordx4 v4, s[36:39], s54 offen offset:3072 sc1 lds
    v_mfma_f32_16x16x32_bf16 v[80:83], a[116:119], v[120:123], v[80:83]
    v_mfma_f32_16x16x32_bf16 v[92:95], a[116:119], v[124:127], v[92:95]
    v_mfma_f32_16x16x32_bf16 v[48:51], v[120:123], v[120:123], v[48:51]
    ds_read_b64_tr_b16 v[140:141], v70 offset:2048
    v_mfma_f32_16x16x32_bf16 v[56:59], v[12:15], v[120:123], v[56:59]
    s_add_u32 m0, s12, 131072
    s_add_u32 s54, s11, 49152
    buffer_load_dwordx4 v4, s[36:39], s54 offen offset:0 sc1 lds
    v_mfma_f32_16x16x32_bf16 v[52:55], v[124:127], v[124:127], v[52:55]
    v_mfma_f32_16x16x32_bf16 v[60:63], v[12:15], v[124:127], v[60:63]
    ds_read_b64_tr_b16 v[142:143], v70 offset:3072
    v_mfma_f32_16x16x32_bf16 v[180:183], a[108:111], v[12:15], v[180:183]
    v_mfma_f32_16x16x32_bf16 v[184:187], a[112:115], v[12:15], v[184:187]
    v_mfma_f32_16x16x32_bf16 v[188:191], a[116:119], v[12:15], v[188:191]
    s_waitcnt lgkmcnt(6)
    buffer_load_dwordx4 v4, s[36:39], s54 offen offset:1024 sc1 lds
    v_mfma_f32_16x16x32_bf16 v[72:75], a[120:123], v[128:131], v[72:75]
    s_waitcnt lgkmcnt(4)
    ds_read_b64_tr_b16 v[120:121], v66 offset:4096
    v_mfma_f32_16x16x32_bf16 v[84:87], a[120:123], v[132:135], v[84:87]
    v_mfma_f32_16x16x32_bf16 v[76:79], a[124:127], v[128:131], v[76:79]
    ds_read_b64_tr_b16 v[122:123], v66 offset:5120
    v_mfma_f32_16x16x32_bf16 v[88:91], a[124:127], v[132:135], v[88:91]
    s_add_u32 s9, s9, 3072
    ds_read_b64_tr_b16 v[124:125], v70 offset:4096
    buffer_load_dwordx4 a[192:195], v4, s[36:39], s9 offen offset:0 sc1
    v_mfma_f32_16x16x32_bf16 v[80:83], a[128:131], v[128:131], v[80:83]
    v_mfma_f32_16x16x32_bf16 v[92:95], a[128:131], v[132:135], v[92:95]
    ds_read_b64_tr_b16 v[126:127], v70 offset:5120
    v_mov_b32 v43, 0
    v_mfma_f32_16x16x32_bf16 v[180:183], a[120:123], v[12:15], v[180:183]
    buffer_atomic_add v43, v155, s[36:39], s16 offen offset:12 sc0 sc1
    v_mfma_f32_16x16x32_bf16 v[184:187], a[124:127], v[12:15], v[184:187]
    buffer_load_dwordx4 a[196:199], v4, s[36:39], s9 offen offset:1024 sc1
    v_mfma_f32_16x16x32_bf16 v[188:191], a[128:131], v[12:15], v[188:191]
    s_waitcnt lgkmcnt(6)
    v_mfma_f32_16x16x32_bf16 v[72:75], a[132:135], v[136:139], v[72:75]
    s_waitcnt lgkmcnt(4)
    ds_read_b64_tr_b16 v[128:129], v66 offset:6144
    v_mov_b32 v24, 0
    v_mfma_f32_16x16x32_bf16 v[84:87], a[132:135], v[140:143], v[84:87]
Lwarm2_3:
    s_cbranch_execz Lwarm_ret
    ds_read_b64_tr_b16 v[130:131], v66 offset:7168
    buffer_atomic_add v24, v23, s[36:39], s16 offen offset:8 sc0 sc1
    v_mfma_f32_16x16x32_bf16 v[76:79], a[136:139], v[136:139], v[76:79]
    v_mfma_f32_16x16x32_bf16 v[88:91], a[136:139], v[140:143], v[88:91]
    ds_read_b64_tr_b16 v[132:133], v70 offset:6144
    buffer_load_dwordx4 a[200:203], v4, s[36:39], s9 offen offset:2048 sc1
    v_mfma_f32_16x16x32_bf16 v[80:83], a[140:143], v[136:139], v[80:83]
    v_mfma_f32_16x16x32_bf16 v[92:95], a[140:143], v[140:143], v[92:95]
    v_mfma_f32_16x16x32_bf16 v[180:183], a[132:135], v[12:15], v[180:183]
    ds_read_b64_tr_b16 v[134:135], v70 offset:7168
    v_mfma_f32_16x16x32_bf16 v[184:187], a[136:139], v[12:15], v[184:187]
    s_add_u32 s9, s9, 3072
    buffer_load_dwordx4 a[204:207], v4, s[36:39], s9 offen offset:0 sc1
    v_mfma_f32_16x16x32_bf16 v[188:191], a[140:143], v[12:15], v[188:191]
    s_waitcnt vmcnt(28) lgkmcnt(6)
    v_mfma_f32_16x16x32_bf16 v[72:75], a[144:147], v[120:123], v[72:75]
    s_waitcnt lgkmcnt(4)
    ds_read_b64_tr_b16 v[136:137], v66 offset:8192
    v_mfma_f32_16x16x32_bf16 v[84:87], a[144:147], v[124:127], v[84:87]
    s_waitcnt vmcnt(27)
    v_mfma_f32_16x16x32_bf16 v[76:79], a[148:151], v[120:123], v[76:79]
    ds_read_b64_tr_b16 v[138:139], v66 offset:9216
    buffer_load_dwordx4 a[208:211], v4, s[36:39], s9 offen offset:1024 sc1
    v_mfma_f32_16x16x32_bf16 v[88:91], a[148:151], v[124:127], v[88:91]
    s_waitcnt vmcnt(27)
    v_mfma_f32_16x16x32_bf16 v[80:83], a[152:155], v[120:123], v[80:83]
    ds_read_b64_tr_b16 v[140:141], v70 offset:8192
    v_mfma_f32_16x16x32_bf16 v[92:95], a[152:155], v[124:127], v[92:95]
    v_mfma_f32_16x16x32_bf16 v[180:183], a[144:147], v[12:15], v[180:183]
    ds_read_b64_tr_b16 v[142:143], v70 offset:9216
    buffer_load_dwordx4 a[212:215], v4, s[36:39], s9 offen offset:2048 sc1
    v_mfma_f32_16x16x32_bf16 v[184:187], a[148:151], v[12:15], v[184:187]
    v_mfma_f32_16x16x32_bf16 v[188:191], a[152:155], v[12:15], v[188:191]
    s_waitcnt vmcnt(27) lgkmcnt(6)
    v_mfma_f32_16x16x32_bf16 v[72:75], a[156:159], v[128:131], v[72:75]
    s_waitcnt lgkmcnt(4)
    ds_read_b64_tr_b16 v[120:121], v67 offset:0
    v_mfma_f32_16x16x32_bf16 v[84:87], a[156:159], v[132:135], v[84:87]
    s_waitcnt vmcnt(26)
    v_mfma_f32_16x16x32_bf16 v[76:79], a[160:163], v[128:131], v[76:79]
    s_add_u32 s9, s9, 3072
    ds_read_b64_tr_b16 v[122:123], v67 offset:1024
    buffer_load_dwordx4 a[216:219], v4, s[36:39], s9 offen offset:0 sc1
    v_mfma_f32_16x16x32_bf16 v[88:91], a[160:163], v[132:135], v[88:91]
    s_waitcnt vmcnt(26)
    v_mfma_f32_16x16x32_bf16 v[80:83], a[164:167], v[128:131], v[80:83]
    ds_read_b64_tr_b16 v[124:125], v71 offset:0
    v_mfma_f32_16x16x32_bf16 v[92:95], a[164:167], v[132:135], v[92:95]
    v_mfma_f32_16x16x32_bf16 v[180:183], a[156:159], v[12:15], v[180:183]
    ds_read_b64_tr_b16 v[126:127], v71 offset:1024
    buffer_load_dwordx4 a[220:223], v4, s[36:39], s9 offen offset:1024 sc1
    v_mfma_f32_16x16x32_bf16 v[184:187], a[160:163], v[12:15], v[184:187]
    v_mfma_f32_16x16x32_bf16 v[188:191], a[164:167], v[12:15], v[188:191]
    s_waitcnt vmcnt(26) lgkmcnt(6)
    v_mfma_f32_16x16x32_bf16 v[72:75], a[168:171], v[136:139], v[72:75]
    s_waitcnt lgkmcnt(4)
    ds_read_b64_tr_b16 v[128:129], v67 offset:2048
    v_mfma_f32_16x16x32_bf16 v[84:87], a[168:171], v[140:143], v[84:87]
    s_waitcnt vmcnt(25)
    ds_read_b64_tr_b16 v[130:131], v67 offset:3072
    buffer_load_dwordx4 a[224:227], v4, s[36:39], s9 offen offset:2048 sc1
    v_mfma_f32_16x16x32_bf16 v[76:79], a[172:175], v[136:139], v[76:79]
    v_mfma_f32_16x16x32_bf16 v[88:91], a[172:175], v[140:143], v[88:91]
    s_waitcnt vmcnt(25)
    v_mfma_f32_16x16x32_bf16 v[80:83], a[176:179], v[136:139], v[80:83]
    ds_read_b64_tr_b16 v[132:133], v71 offset:2048
    v_mfma_f32_16x16x32_bf16 v[92:95], a[176:179], v[140:143], v[92:95]
    v_mfma_f32_16x16x32_bf16 v[180:183], a[168:171], v[12:15], v[180:183]
    s_add_u32 s9, s9, 3072
    ds_read_b64_tr_b16 v[134:135], v71 offset:3072
    buffer_load_dwordx4 a[228:231], v4, s[36:39], s9 offen offset:0 sc1
    v_mfma_f32_16x16x32_bf16 v[184:187], a[172:175], v[12:15], v[184:187]
    v_mfma_f32_16x16x32_bf16 v[188:191], a[176:179], v[12:15], v[188:191]
    s_waitcnt vmcnt(24) lgkmcnt(6)
    v_mfma_f32_16x16x32_bf16 v[72:75], a[180:183], v[120:123], v[72:75]
    s_waitcnt lgkmcnt(4)
    ds_read_b64_tr_b16 v[136:137], v67 offset:4096
    v_mfma_f32_16x16x32_bf16 v[84:87], a[180:183], v[124:127], v[84:87]
    s_waitcnt vmcnt(23)
    ds_read_b64_tr_b16 v[138:139], v67 offset:5120
    buffer_load_dwordx4 a[232:235], v4, s[36:39], s9 offen offset:1024 sc1
    v_mfma_f32_16x16x32_bf16 v[76:79], a[184:187], v[120:123], v[76:79]
    v_mfma_f32_16x16x32_bf16 v[88:91], a[184:187], v[124:127], v[88:91]
    s_waitcnt vmcnt(23)
    v_mfma_f32_16x16x32_bf16 v[80:83], a[188:191], v[120:123], v[80:83]
    ds_read_b64_tr_b16 v[140:141], v71 offset:4096
    v_mfma_f32_16x16x32_bf16 v[92:95], a[188:191], v[124:127], v[92:95]
    ds_read_b64_tr_b16 v[142:143], v71 offset:5120
    buffer_load_dwordx4 a[236:239], v4, s[36:39], s9 offen offset:2048 sc1
    v_mfma_f32_16x16x32_bf16 v[180:183], a[180:183], v[12:15], v[180:183]
    v_mfma_f32_16x16x32_bf16 v[184:187], a[184:187], v[12:15], v[184:187]
    v_mfma_f32_16x16x32_bf16 v[188:191], a[188:191], v[12:15], v[188:191]
    s_waitcnt vmcnt(13) lgkmcnt(6)
    v_mfma_f32_16x16x32_bf16 v[72:75], a[192:195], v[128:131], v[72:75]
    s_waitcnt lgkmcnt(4)
    ds_read_b64_tr_b16 v[120:121], v67 offset:6144
    v_mfma_f32_16x16x32_bf16 v[84:87], a[192:195], v[132:135], v[84:87]
    s_waitcnt vmcnt(11)
    s_add_u32 s50, s44, 24
    v_cmp_ne_u32 vcc, s50, v43
    s_nop 0
    s_and_b64 vcc, vcc, 0x3
    s_cbranch_scc1 Lslow29
Lgot30:
    s_add_u32 s58, s26, 0
    buffer_load_dwordx4 v[192:195], v16, s[36:39], s58 offen sc1
    v_mfma_f32_16x16x32_bf16 v[76:79], a[196:199], v[128:131], v[76:79]
    ds_read_b64_tr_b16 v[122:123], v67 offset:7168
    v_mfma_f32_16x16x32_bf16 v[88:91], a[196:199], v[132:135], v[88:91]
    s_waitcnt vmcnt(10)
    v_cndmask_b32 v57, v48, v49, s[20:21]
    v_cndmask_b32 v61, v52, v53, s[20:21]
    v_mfma_f32_16x16x32_bf16 v[80:83], a[200:203], v[128:131], v[80:83]
    ds_read_b64_tr_b16 v[124:125], v71 offset:6144
    v_cndmask_b32 v57, v57, v50, s[22:23]
    v_mfma_f32_16x16x32_bf16 v[92:95], a[200:203], v[132:135], v[92:95]
    v_cndmask_b32 v61, v61, v54, s[22:23]
    v_cndmask_b32 v57, v57, v51, s[24:25]
    v_mfma_f32_16x16x32_bf16 v[180:183], a[192:195], v[12:15], v[180:183]
    ds_read_b64_tr_b16 v[126:127], v71 offset:7168
    v_cndmask_b32 v61, v61, v55, s[24:25]
    v_mfma_f32_16x16x32_bf16 v[184:187], a[196:199], v[12:15], v[184:187]
    ds_write2_b64 v28, v[56:57], v[60:61] offset0:0 offset1:1
    buffer_load_dwordx4 v[196:199], v17, s[36:39], s58 offen sc1
    v_mfma_f32_16x16x32_bf16 v[188:191], a[200:203], v[12:15], v[188:191]
    s_waitcnt vmcnt(10) lgkmcnt(7)
    v_mfma_f32_16x16x32_bf16 v[72:75], a[204:207], v[136:139], v[72:75]
    s_waitcnt lgkmcnt(5)
    ds_read_b64_tr_b16 v[128:129], v67 offset:8192
    buffer_load_dwordx4 v[200:203], v18, s[36:39], s58 offen sc1
    v_mfma_f32_16x16x32_bf16 v[84:87], a[204:207], v[140:143], v[84:87]
    s_waitcnt vmcnt(10)
    v_mfma_f32_16x16x32_bf16 v[76:79], a[208:211], v[136:139], v[76:79]
    ds_read_b64_tr_b16 v[130:131], v67 offset:9216
    v_mfma_f32_16x16x32_bf16 v[88:91], a[208:211], v[140:143], v[88:91]
    s_waitcnt vmcnt(9)
    v_mfma_f32_16x16x32_bf16 v[80:83], a[212:215], v[136:139], v[80:83]
    ds_read_b64_tr_b16 v[132:133], v71 offset:8192
    v_mfma_f32_16x16x32_bf16 v[92:95], a[212:215], v[140:143], v[92:95]
    ds_read_b64_tr_b16 v[134:135], v71 offset:9216
    buffer_load_dwordx4 v[204:207], v19, s[36:39], s58 offen sc1
    v_mfma_f32_16x16x32_bf16 v[180:183], a[204:207], v[12:15], v[180:183]
    v_mfma_f32_16x16x32_bf16 v[184:187], a[208:211], v[12:15], v[184:187]
    v_mfma_f32_16x16x32_bf16 v[188:191], a[212:215], v[12:15], v[188:191]
    s_waitcnt vmcnt(9) lgkmcnt(7)
    v_mfma_f32_16x16x32_bf16 v[72:75], a[216:219], v[120:123], v[72:75]
    s_waitcnt lgkmcnt(5)
    buffer_load_dwordx4 v[208:211], v20, s[36:39], s58 offen sc1
    v_mfma_f32_16x16x32_bf16 v[84:87], a[216:219], v[124:127], v[84:87]
    s_waitcnt lgkmcnt(0)
    s_barrier
    s_waitcnt vmcnt(9)
    ds_read_b64_tr_b16 v[136:137], v64 offset:40960
    v_mfma_f32_16x16x32_bf16 v[76:79], a[220:223], v[120:123], v[76:79]
    v_mfma_f32_16x16x32_bf16 v[88:91], a[220:223], v[124:127], v[88:91]
    s_waitcnt vmcnt(8)
    ds_read_b64_tr_b16 v[138:139], v64 offset:41984
    v_mfma_f32_16x16x32_bf16 v[80:83], a[224:227], v[120:123], v[80:83]
    s_add_u32 s58, s26, 5120
    ds_read_b64_tr_b16 v[140:141], v68 offset:40960
    buffer_load_dwordx4 v[212:215], v16, s[36:39], s58 offen sc1
    v_mfma_f32_16x16x32_bf16 v[92:95], a[224:227], v[124:127], v[92:95]
    v_mfma_f32_16x16x32_bf16 v[180:183], a[216:219], v[12:15], v[180:183]
    v_mfma_f32_16x16x32_bf16 v[184:187], a[220:223], v[12:15], v[184:187]
    ds_read_b64_tr_b16 v[142:143], v68 offset:41984
    v_mfma_f32_16x16x32_bf16 v[188:191], a[224:227], v[12:15], v[188:191]
    s_waitcnt vmcnt(8)
    v_mfma_f32_16x16x32_bf16 v[72:75], a[228:231], v[128:131], v[72:75]
    s_add_u32 s50, s44, 27
    v_cmp_ne_u32 vcc, s50, v24
    s_nop 0
    s_and_b64 vcc, vcc, 0x7
    s_cbranch_scc1 Lslow32
Lgot33:
    ds_read_b64_tr_b16 v[120:121], v64 offset:43008
    s_add_u32 m0, s12, 81920
    v_mfma_f32_16x16x32_bf16 v[84:87], a[228:231], v[132:135], v[84:87]
    s_waitcnt vmcnt(7)
    s_add_u32 s54, s11, 81920
    buffer_load_dwordx4 v4, s[36:39], s54 offen offset:0 sc1 lds
    v_mfma_f32_16x16x32_bf16 v[76:79], a[232:235], v[128:131], v[76:79]
    ds_read_b64_tr_b16 v[122:123], v64 offset:44032
    ds_read2st64_b64 v[144:147], v42 offset0:0 offset1:2
    v_mfma_f32_16x16x32_bf16 v[88:91], a[232:235], v[132:135], v[88:91]
    s_waitcnt vmcnt(7)
    ds_read_b64_tr_b16 v[124:125], v68 offset:43008
    ds_read2st64_b64 v[148:151], v42 offset0:4 offset1:6
    v_mfma_f32_16x16x32_bf16 v[80:83], a[236:239], v[128:131], v[80:83]
    v_mfma_f32_16x16x32_bf16 v[92:95], a[236:239], v[132:135], v[92:95]
    ds_read_b64_tr_b16 v[126:127], v68 offset:44032
    buffer_load_dwordx4 v4, s[36:39], s54 offen offset:1024 sc1 lds
    v_mfma_f32_16x16x32_bf16 v[180:183], a[228:231], v[12:15], v[180:183]
    v_mfma_f32_16x16x32_bf16 v[184:187], a[232:235], v[12:15], v[184:187]
    v_mfma_f32_16x16x32_bf16 v[188:191], a[236:239], v[12:15], v[188:191]
    s_waitcnt lgkmcnt(8)
    v_mfma_f32_16x16x32_bf16 v[96:99], a[0:3], v[136:139], 0
    s_waitcnt lgkmcnt(6)
    ds_read_b64_tr_b16 v[128:129], v64 offset:45056
    v_mfma_f32_16x16x32_bf16 v[108:111], a[0:3], v[140:143], 0
    ds_read_b64_tr_b16 v[130:131], v64 offset:46080
    s_waitcnt lgkmcnt(5)
    v_add_f32 v144, v144, v146
    v_mfma_f32_16x16x32_bf16 v[100:103], a[4:7], v[136:139], 0
    buffer_load_dwordx4 v4, s[36:39], s54 offen offset:2048 sc1 lds
    v_add_f32 v145, v145, v147
    v_mfma_f32_16x16x32_bf16 v[112:115], a[4:7], v[140:143], 0
    ds_read_b64_tr_b16 v[132:133], v68 offset:45056
    s_waitcnt lgkmcnt(4)
    v_add_f32 v148, v148, v150
    v_mfma_f32_16x16x32_bf16 v[104:107], a[8:11], v[136:139], 0
    ds_read_b64_tr_b16 v[134:135], v68 offset:46080
    v_add_f32 v149, v149, v151
    v_mfma_f32_16x16x32_bf16 v[116:119], a[8:11], v[140:143], 0
    v_add_f32 v144, v144, v148
    v_add_f32 v145, v145, v149
    v_mfma_f32_16x16x32_bf16 v[96:99], a[12:15], v[120:123], v[96:99]
    s_waitcnt lgkmcnt(4)
    ds_read_b64_tr_b16 v[136:137], v64 offset:47104
    v_mul_f32 v144, 986500301, v144
    v_mfma_f32_16x16x32_bf16 v[108:111], a[12:15], v[124:127], v[108:111]
    ds_read_b64_tr_b16 v[138:139], v64 offset:48128
    buffer_load_dwordx4 v4, s[36:39], s54 offen offset:3072 sc1 lds
    v_mfma_f32_16x16x32_bf16 v[100:103], a[16:19], v[120:123], v[100:103]
    v_mul_f32 v145, 986500301, v145
    v_cvt_pk_bf16_f32 v152, 0, v144
    v_mfma_f32_16x16x32_bf16 v[112:115], a[16:19], v[124:127], v[112:115]
    ds_read_b64_tr_b16 v[140:141], v68 offset:47104
    v_cvt_pk_bf16_f32 v153, 0, v144
    v_mfma_f32_16x16x32_bf16 v[104:107], a[20:23], v[120:123], v[104:107]
    ds_read_b64_tr_b16 v[142:143], v68 offset:48128
    v_fma_f32 v145, -v144, v144, v145
    v_mfma_f32_16x16x32_bf16 v[116:119], a[20:23], v[124:127], v[116:119]
    s_waitcnt lgkmcnt(6)
    v_max_f32 v145, 0, v145
    v_mfma_f32_16x16x32_bf16 v[96:99], a[24:27], v[128:131], v[96:99]
    s_waitcnt lgkmcnt(4)
    v_permlane32_swap_b32 v152, v153
    v_mfma_f32_16x16x32_bf16 v[108:111], a[24:27], v[132:135], v[108:111]
    s_add_u32 m0, s12, 86016
    ds_read_b64_tr_b16 v[120:121], v64 offset:49152
    v_cvt_pk_bf16_f32 v145, 0, v145
    v_mfma_f32_16x16x32_bf16 v[100:103], a[28:31], v[128:131], v[100:103]
    s_add_u32 s54, s11, 86016
    ds_read_b64_tr_b16 v[122:123], v64 offset:50176
    buffer_load_dwordx4 v4, s[36:39], s54 offen offset:0 sc1 lds
    v_mfma_f32_16x16x32_bf16 v[112:115], a[28:31], v[132:135], v[112:115]
    ds_read_b64_tr_b16 v[124:125], v68 offset:49152
    v_add_f32 v145, 0x3727c5ac, v145
    v_mfma_f32_16x16x32_bf16 v[104:107], a[32:35], v[128:131], v[104:107]
    ds_read_b64_tr_b16 v[126:127], v68 offset:50176
    v_cvt_pk_bf16_f32 v145, 0, v145
    v_mfma_f32_16x16x32_bf16 v[116:119], a[32:35], v[132:135], v[116:119]
    s_waitcnt lgkmcnt(6)
    v_sqrt_f32 v145, v145
    v_mfma_f32_16x16x32_bf16 v[96:99], a[36:39], v[136:139], v[96:99]
    s_waitcnt lgkmcnt(4)
    ds_read_b64_tr_b16 v[128:129], v65 offset:40960
    buffer_load_dwordx4 v4, s[36:39], s54 offen offset:1024 sc1 lds
    v_mfma_f32_16x16x32_bf16 v[108:111], a[36:39], v[140:143], v[108:111]
    ds_read_b64_tr_b16 v[130:131], v65 offset:41984
    v_fma_f32 v72, -v180, v152, v72
    v_mfma_f32_16x16x32_bf16 v[100:103], a[40:43], v[136:139], v[100:103]
    v_fma_f32 v84, -v180, v153, v84
    v_cvt_pk_bf16_f32 v145, 0, v145
    v_mfma_f32_16x16x32_bf16 v[112:115], a[40:43], v[140:143], v[112:115]
    ds_read_b64_tr_b16 v[132:133], v69 offset:40960
    v_fma_f32 v73, -v181, v152, v73
    v_mfma_f32_16x16x32_bf16 v[104:107], a[44:47], v[136:139], v[104:107]
    v_rcp_f32 v154, v145
    v_mfma_f32_16x16x32_bf16 v[116:119], a[44:47], v[140:143], v[116:119]
    s_waitcnt lgkmcnt(5)
    ds_read_b64_tr_b16 v[134:135], v69 offset:41984
    v_mul_f32 v156, v145, v145
    v_mfma_f32_16x16x32_bf16 v[96:99], a[48:51], v[120:123], v[96:99]
    s_waitcnt lgkmcnt(4)
    ds_read_b64_tr_b16 v[136:137], v65 offset:43008
    buffer_load_dwordx4 v4, s[36:39], s54 offen offset:2048 sc1 lds
    v_mfma_f32_16x16x32_bf16 v[108:111], a[48:51], v[124:127], v[108:111]
    ds_read_b64_tr_b16 v[138:139], v65 offset:44032
    v_fma_f32 v85, -v181, v153, v85
    v_mfma_f32_16x16x32_bf16 v[100:103], a[52:55], v[120:123], v[100:103]
    v_mul_f32 v154, 0xbfb8aa3b, v154
    v_fma_f32 v74, -v182, v152, v74
    v_mfma_f32_16x16x32_bf16 v[112:115], a[52:55], v[124:127], v[112:115]
    ds_read_b64_tr_b16 v[140:141], v69 offset:43008
    v_fma_f32 v86, -v182, v153, v86
    v_mfma_f32_16x16x32_bf16 v[104:107], a[56:59], v[120:123], v[104:107]
    ds_read_b64_tr_b16 v[142:143], v69 offset:44032
    v_fma_f32 v75, -v183, v152, v75
    v_mfma_f32_16x16x32_bf16 v[116:119], a[56:59], v[124:127], v[116:119]
Lwarm0_4:
    s_cbranch_execz Lwarm_ret
    s_waitcnt lgkmcnt(6)
    buffer_load_dwordx4 v4, s[36:39], s54 offen offset:3072 sc1 lds
    v_fma_f32 v87, -v183, v153, v87
    v_mfma_f32_16x16x32_bf16 v[96:99], a[60:63], v[128:131], v[96:99]
    s_waitcnt lgkmcnt(4)
    ds_read_b64_tr_b16 v[120:121], v65 offset:45056
    v_fma_f32 v76, -v184, v152, v76
    v_mfma_f32_16x16x32_bf16 v[108:111], a[60:63], v[132:135], v[108:111]
    v_fma_f32 v88, -v184, v153, v88
    v_fma_f32 v77, -v185, v152, v77
    v_mfma_f32_16x16x32_bf16 v[100:103], a[64:67], v[128:131], v[100:103]
    ds_read_b64_tr_b16 v[122:123], v65 offset:46080
    v_fma_f32 v89, -v185, v153, v89
    v_mfma_f32_16x16x32_bf16 v[112:115], a[64:67], v[132:135], v[112:115]
    v_fma_f32 v78, -v186, v152, v78
    v_fma_f32 v90, -v186, v153, v90
    v_mfma_f32_16x16x32_bf16 v[104:107], a[68:71], v[128:131], v[104:107]
    v_fma_f32 v79, -v187, v152, v79
    v_fma_f32 v91, -v187, v153, v91
    v_mfma_f32_16x16x32_bf16 v[116:119], a[68:71], v[132:135], v[116:119]
    s_add_u32 m0, s12, 90112
    ds_read_b64_tr_b16 v[124:125], v69 offset:45056
    v_fma_f32 v80, -v188, v152, v80
    v_mfma_f32_16x16x32_bf16 v[48:51], v[128:131], v[128:131], 0
    s_add_u32 s54, s11, 90112
    buffer_load_dwordx4 v4, s[36:39], s54 offen offset:0 sc1 lds
    v_fma_f32 v92, -v188, v153, v92
    v_mfma_f32_16x16x32_bf16 v[56:59], v[12:15], v[128:131], 0
    ds_read_b64_tr_b16 v[126:127], v69 offset:46080
    v_fma_f32 v81, -v189, v152, v81
    v_mfma_f32_16x16x32_bf16 v[52:55], v[132:135], v[132:135], 0
    v_fma_f32 v93, -v189, v153, v93
    v_fma_f32 v82, -v190, v152, v82
    v_mfma_f32_16x16x32_bf16 v[60:63], v[12:15], v[132:135], 0
    s_waitcnt lgkmcnt(6)
    v_fma_f32 v94, -v190, v153, v94
    v_fma_f32 v83, -v191, v152, v83
    v_mfma_f32_16x16x32_bf16 v[96:99], a[72:75], v[136:139], v[96:99]
    s_waitcnt lgkmcnt(4)
    ds_read_b64_tr_b16 v[128:129], v65 offset:47104
    buffer_load_dwordx4 v4, s[36:39], s54 offen offset:1024 sc1 lds
    v_mfma_f32_16x16x32_bf16 v[108:111], a[72:75], v[140:143], v[108:111]
    ds_read_b64_tr_b16 v[130:131], v65 offset:48128
    v_fma_f32 v95, -v191, v153, v95
    v_mfma_f32_16x16x32_bf16 v[100:103], a[76:79], v[136:139], v[100:103]
    v_permlane32_swap_b32 v72, v84
    v_mfma_f32_16x16x32_bf16 v[112:115], a[76:79], v[140:143], v[112:115]
    v_permlane32_swap_b32 v73, v85
    v_mfma_f32_16x16x32_bf16 v[104:107], a[80:83], v[136:139], v[104:107]
    v_permlane32_swap_b32 v74, v86
    v_mfma_f32_16x16x32_bf16 v[116:119], a[80:83], v[140:143], v[116:119]
    v_permlane32_swap_b32 v75, v87
    v_mfma_f32_16x16x32_bf16 v[48:51], v[136:139], v[136:139], v[48:51]
    s_add_u32 s58, s27, 0
    v_permlane32_swap_b32 v76, v88
    v_mfma_f32_16x16x32_bf16 v[56:59], v[12:15], v[136:139], v[56:59]
    s_add_u32 m0, s19, 0
    ds_read_b64_tr_b16 v[132:133], v69 offset:47104
    buffer_load_dwordx4 v17, s[36:39], s58 offen sc1 lds
    v_mfma_f32_16x16x32_bf16 v[52:55], v[140:143], v[140:143], v[52:55]
    v_permlane32_swap_b32 v77, v89
    v_mfma_f32_16x16x32_bf16 v[60:63], v[12:15], v[140:143], v[60:63]
    s_waitcnt lgkmcnt(5)
    v_permlane32_swap_b32 v78, v90
    v_mfma_f32_16x16x32_bf16 v[96:99], a[84:87], v[120:123], v[96:99]
    s_waitcnt lgkmcnt(3)
    ds_read_b64_tr_b16 v[134:135], v69 offset:48128
    ds_read_b64_tr_b16 v[136:137], v65 offset:49152
    v_mfma_f32_16x16x32_bf16 v[108:111], a[84:87], v[124:127], v[108:111]
    s_add_u32 m0, s19, 1024
    ds_read_b64_tr_b16 v[138:139], v65 offset:50176
    buffer_load_dwordx4 v18, s[36:39], s58 offen sc1 lds
    v_mfma_f32_16x16x32_bf16 v[100:103], a[88:91], v[120:123], v[100:103]
    v_permlane32_swap_b32 v79, v91
    v_mfma_f32_16x16x32_bf16 v[112:115], a[88:91], v[124:127], v[112:115]
    v_permlane32_swap_b32 v80, v92
    v_mfma_f32_16x16x32_bf16 v[104:107], a[92:95], v[120:123], v[104:107]
    ds_read_b64_tr_b16 v[34:35], v8 offset:40960
    ds_read_b64_tr_b16 v[174:175], v9 offset:40960
    v_mfma_f32_16x16x32_bf16 v[116:119], a[92:95], v[124:127], v[116:119]
    v_permlane32_swap_b32 v81, v93
    v_mfma_f32_16x16x32_bf16 v[48:51], v[120:123], v[120:123], v[48:51]
    v_permlane32_swap_b32 v82, v94
    v_mfma_f32_16x16x32_bf16 v[56:59], v[12:15], v[120:123], v[56:59]
    s_add_u32 m0, s19, 2048
    ds_read_b64_tr_b16 v[140:141], v69 offset:49152
    buffer_load_dwordx4 v19, s[36:39], s58 offen sc1 lds
    v_mfma_f32_16x16x32_bf16 v[52:55], v[124:127], v[124:127], v[52:55]
    v_permlane32_swap_b32 v83, v95
    v_mfma_f32_16x16x32_bf16 v[60:63], v[12:15], v[124:127], v[60:63]
    s_waitcnt lgkmcnt(7)
    ds_read_b64_tr_b16 v[142:143], v69 offset:50176
    v_mul_f32 v168, v80, v154
    v_mfma_f32_16x16x32_bf16 v[96:99], a[96:99], v[128:131], v[96:99]
    s_waitcnt lgkmcnt(6)
    ds_read_b64_tr_b16 v[120:121], v66 offset:40960
    v_mul_f32 v169, v81, v154
    v_mfma_f32_16x16x32_bf16 v[108:111], a[96:99], v[132:135], v[108:111]
    v_exp_f32 v168, v168
    v_mfma_f32_16x16x32_bf16 v[100:103], a[100:103], v[128:131], v[100:103]
    s_add_u32 m0, s19, 3072
    ds_read_b64_tr_b16 v[122:123], v66 offset:41984
    buffer_load_dwordx4 v20, s[36:39], s58 offen sc1 lds
    v_mfma_f32_16x16x32_bf16 v[112:115], a[100:103], v[132:135], v[112:115]
    v_exp_f32 v169, v169
    v_mfma_f32_16x16x32_bf16 v[104:107], a[104:107], v[128:131], v[104:107]
    v_mul_f32 v80, v80, v92
    v_mul_f32 v81, v81, v93
    v_mfma_f32_16x16x32_bf16 v[116:119], a[104:107], v[132:135], v[116:119]
    ds_read_b64_tr_b16 v[124:125], v70 offset:40960
    v_fma_f32 v168, v168, v156, v156
    v_mfma_f32_16x16x32_bf16 v[48:51], v[128:131], v[128:131], v[48:51]
    ds_read_b64_tr_b16 v[126:127], v70 offset:41984
    v_fma_f32 v169, v169, v156, v156
    v_mfma_f32_16x16x32_bf16 v[56:59], v[12:15], v[128:131], v[56:59]
    v_rcp_f32 v168, v168
    v_mfma_f32_16x16x32_bf16 v[52:55], v[132:135], v[132:135], v[52:55]
    s_add_u32 s58, s27, 5120
    v_rcp_f32 v169, v169
    v_mfma_f32_16x16x32_bf16 v[60:63], v[12:15], v[132:135], v[60:63]
    s_waitcnt lgkmcnt(8)
    s_add_u32 m0, s19, 4096
    s_nop 0
    buffer_load_dwordx4 v16, s[36:39], s58 offen sc1 lds
    v_mfma_f32_16x16x32_bf16 v[96:99], a[108:111], v[136:139], v[96:99]
    s_waitcnt lgkmcnt(4)
    ds_read_b64_tr_b16 v[128:129], v66 offset:43008
    v_mul_f32 v80, v80, v168
    v_mfma_f32_16x16x32_bf16 v[108:111], a[108:111], v[140:143], v[108:111]
    v_mul_f32 v81, v81, v169
    v_cvt_pk_bf16_f32 v164, v80, v81
    v_mfma_f32_16x16x32_bf16 v[100:103], a[112:115], v[136:139], v[100:103]
    ds_read_b64_tr_b16 v[130:131], v66 offset:44032
    v_mul_f32 v170, v82, v154
    v_mfma_f32_16x16x32_bf16 v[112:115], a[112:115], v[140:143], v[112:115]
    s_add_u32 m0, s19, 5120
    ds_read_b64_tr_b16 v[132:133], v70 offset:43008
    buffer_load_dwordx4 v17, s[36:39], s58 offen sc1 lds
    v_mfma_f32_16x16x32_bf16 v[104:107], a[116:119], v[136:139], v[104:107]
    ds_read_b64_tr_b16 v[134:135], v70 offset:44032
    v_mul_f32 v171, v83, v154
    v_mfma_f32_16x16x32_bf16 v[116:119], a[116:119], v[140:143], v[116:119]
    v_exp_f32 v170, v170
    v_mfma_f32_16x16x32_bf16 v[48:51], v[136:139], v[136:139], v[48:51]
    v_exp_f32 v171, v171
    v_mfma_f32_16x16x32_bf16 v[56:59], v[12:15], v[136:139], v[56:59]
    v_mul_f32 v82, v82, v94
    v_mul_f32 v83, v83, v95
    v_mfma_f32_16x16x32_bf16 v[52:55], v[140:143], v[140:143], v[52:55]
    v_fma_f32 v170, v170, v156, v156
    v_fma_f32 v171, v171, v156, v156
    v_mfma_f32_16x16x32_bf16 v[60:63], v[12:15], v[140:143], v[60:63]
    s_waitcnt lgkmcnt(6)
    v_rcp_f32 v170, v170
    v_mfma_f32_16x16x32_bf16 v[96:99], a[120:123], v[120:123], v[96:99]
    s_waitcnt lgkmcnt(4)
    ds_read_b64_tr_b16 v[136:137], v66 offset:45056
    s_add_u32 m0, s19, 6144
    v_mfma_f32_16x16x32_bf16 v[108:111], a[120:123], v[124:127], v[108:111]
    ds_read_b64_tr_b16 v[138:139], v66 offset:46080
    buffer_load_dwordx4 v18, s[36:39], s58 offen sc1 lds
    v_mfma_f32_16x16x32_bf16 v[100:103], a[124:127], v[120:123], v[100:103]
    v_rcp_f32 v171, v171
    v_mfma_f32_16x16x32_bf16 v[112:115], a[124:127], v[124:127], v[112:115]
    ds_read_b64_tr_b16 v[140:141], v70 offset:45056
    v_mul_f32 v82, v82, v170
    v_mfma_f32_16x16x32_bf16 v[104:107], a[128:131], v[120:123], v[104:107]
    s_add_u32 m0, s19, 7168
    ds_read_b64_tr_b16 v[142:143], v70 offset:46080
    buffer_load_dwordx4 v19, s[36:39], s58 offen sc1 lds
    v_mfma_f32_16x16x32_bf16 v[116:119], a[128:131], v[124:127], v[116:119]
    s_waitcnt lgkmcnt(6)
    v_mul_f32 v83, v83, v171
    v_cvt_pk_bf16_f32 v165, v82, v83
    v_mfma_f32_16x16x32_bf16 v[96:99], a[132:135], v[128:131], v[96:99]
    s_waitcnt lgkmcnt(4)
    ds_read_b64_tr_b16 v[120:121], v66 offset:47104
    v_mul_f32 v168, v72, v154
    v_mfma_f32_16x16x32_bf16 v[108:111], a[132:135], v[132:135], v[108:111]
    ds_read_b64_tr_b16 v[122:123], v66 offset:48128
    v_mul_f32 v169, v73, v154
    v_mfma_f32_16x16x32_bf16 v[100:103], a[136:139], v[128:131], v[100:103]
    v_permlane16_swap_b32 v164, v166
    v_mfma_f32_16x16x32_bf16 v[112:115], a[136:139], v[132:135], v[112:115]
    v_permlane16_swap_b32 v165, v167
    v_mfma_f32_16x16x32_bf16 v[104:107], a[140:143], v[128:131], v[104:107]
    s_add_u32 m0, s19, 8192
    ds_read_b64_tr_b16 v[124:125], v70 offset:47104
    buffer_load_dwordx4 v20, s[36:39], s58 offen sc1 lds
    v_mfma_f32_16x16x32_bf16 v[116:119], a[140:143], v[132:135], v[116:119]
    s_waitcnt lgkmcnt(5)
    ds_read_b64_tr_b16 v[126:127], v70 offset:48128
    s_add_u32 s55, s10, 0
    v_mfma_f32_16x16x32_bf16 v[96:99], a[144:147], v[136:139], v[96:99]
    s_waitcnt lgkmcnt(4)
    ds_read_b64_tr_b16 v[128:129], v66 offset:49152
    buffer_store_dwordx4 v[164:167], v159, s[36:39], s55 offen offset:512 sc1
    v_mfma_f32_16x16x32_bf16 v[108:111], a[144:147], v[140:143], v[108:111]
    v_exp_f32 v168, v168
    v_mfma_f32_16x16x32_bf16 v[100:103], a[148:151], v[136:139], v[100:103]
    v_exp_f32 v169, v169
    v_mfma_f32_16x16x32_bf16 v[112:115], a[148:151], v[140:143], v[112:115]
    s_add_u32 s58, s26, 5120
    ds_read_b64_tr_b16 v[130:131], v66 offset:50176
    buffer_load_dwordx4 v[216:219], v17, s[36:39], s58 offen sc1
    v_mfma_f32_16x16x32_bf16 v[104:107], a[152:155], v[136:139], v[104:107]
    ds_read_b64_tr_b16 v[132:133], v70 offset:49152
    v_mul_f32 v72, v72, v84
    v_mfma_f32_16x16x32_bf16 v[116:119], a[152:155], v[140:143], v[116:119]
    s_waitcnt lgkmcnt(5)
    ds_read_b64_tr_b16 v[134:135], v70 offset:50176
    v_mul_f32 v73, v73, v85
    v_mfma_f32_16x16x32_bf16 v[96:99], a[156:159], v[120:123], v[96:99]
    s_waitcnt lgkmcnt(4)
    ds_read_b64_tr_b16 v[136:137], v67 offset:40960
    v_fma_f32 v168, v168, v156, v156
    v_mfma_f32_16x16x32_bf16 v[108:111], a[156:159], v[124:127], v[108:111]
    ds_read_b64_tr_b16 v[138:139], v67 offset:41984
    v_fma_f32 v169, v169, v156, v156
    v_mfma_f32_16x16x32_bf16 v[100:103], a[160:163], v[120:123], v[100:103]
    v_rcp_f32 v168, v168
    v_mfma_f32_16x16x32_bf16 v[112:115], a[160:163], v[124:127], v[112:115]
    ds_read_b64_tr_b16 v[140:141], v71 offset:40960
    buffer_load_dwordx4 v[220:223], v18, s[36:39], s58 offen sc1
    v_mfma_f32_16x16x32_bf16 v[104:107], a[164:167], v[120:123], v[104:107]
    v_rcp_f32 v169, v169
    v_mfma_f32_16x16x32_bf16 v[116:119], a[164:167], v[124:127], v[116:119]
    s_waitcnt lgkmcnt(5)
    ds_read_b64_tr_b16 v[142:143], v71 offset:41984
    v_mul_f32 v72, v72, v168
    v_mfma_f32_16x16x32_bf16 v[96:99], a[168:171], v[128:131], v[96:99]
    s_waitcnt lgkmcnt(4)
    ds_read_b64_tr_b16 v[120:121], v67 offset:43008
    v_mul_f32 v73, v73, v169
    v_mfma_f32_16x16x32_bf16 v[108:111], a[168:171], v[132:135], v[108:111]
    ds_read_b64_tr_b16 v[122:123], v67 offset:44032
    v_cvt_pk_bf16_f32 v160, v72, v73
    v_mfma_f32_16x16x32_bf16 v[100:103], a[172:175], v[128:131], v[100:103]
    buffer_load_dwordx4 v[224:227], v19, s[36:39], s58 offen sc1
    v_mul_f32 v170, v74, v154
    v_mfma_f32_16x16x32_bf16 v[112:115], a[172:175], v[132:135], v[112:115]
    ds_read_b64_tr_b16 v[124:125], v71 offset:43008
    v_mul_f32 v171, v75, v154
    v_mfma_f32_16x16x32_bf16 v[104:107], a[176:179], v[128:131], v[104:107]
    v_exp_f32 v170, v170
    v_mfma_f32_16x16x32_bf16 v[116:119], a[176:179], v[132:135], v[116:119]
    s_waitcnt lgkmcnt(5)
    v_exp_f32 v171, v171
    v_mfma_f32_16x16x32_bf16 v[96:99], a[180:183], v[136:139], v[96:99]
    s_waitcnt lgkmcnt(3)
    ds_read_b64_tr_b16 v[126:127], v71 offset:44032
    v_mul_f32 v74, v74, v86
    v_mfma_f32_16x16x32_bf16 v[108:111], a[180:183], v[140:143], v[108:111]
    ds_read_b64_tr_b16 v[128:129], v67 offset:45056
    v_mul_f32 v75, v75, v87
    v_mfma_f32_16x16x32_bf16 v[100:103], a[184:187], v[136:139], v[100:103]
    ds_read_b64_tr_b16 v[130:131], v67 offset:46080
    buffer_load_dwordx4 v[228:231], v20, s[36:39], s58 offen sc1
    v_mfma_f32_16x16x32_bf16 v[112:115], a[184:187], v[140:143], v[112:115]
    ds_read_b64_tr_b16 v[132:133], v71 offset:45056
    v_fma_f32 v170, v170, v156, v156
    v_mfma_f32_16x16x32_bf16 v[104:107], a[188:191], v[136:139], v[104:107]
    ds_read_b64_tr_b16 v[134:135], v71 offset:46080
    v_fma_f32 v171, v171, v156, v156
    v_mfma_f32_16x16x32_bf16 v[116:119], a[188:191], v[140:143], v[116:119]
    s_waitcnt lgkmcnt(6)
    v_rcp_f32 v170, v170
    v_mfma_f32_16x16x32_bf16 v[96:99], a[192:195], v[120:123], v[96:99]
    s_waitcnt lgkmcnt(4)
    v_rcp_f32 v171, v171
    v_mfma_f32_16x16x32_bf16 v[108:111], a[192:195], v[124:127], v[108:111]
    s_add_u32 s58, s26, 10240
    ds_read_b64_tr_b16 v[136:137], v67 offset:47104
    buffer_load_dwordx4 v[232:235], v16, s[36:39], s58 offen sc1
    v_mfma_f32_16x16x32_bf16 v[100:103], a[196:199], v[120:123], v[100:103]
    ds_read_b64_tr_b16 v[138:139], v67 offset:48128
    v_mul_f32 v74, v74, v170
    v_mfma_f32_16x16x32_bf16 v[112:115], a[196:199], v[124:127], v[112:115]
    ds_read_b64_tr_b16 v[140:141], v71 offset:47104
    v_cndmask_b32 v57, v48, v49, s[20:21]
    v_mfma_f32_16x16x32_bf16 v[104:107], a[200:203], v[120:123], v[104:107]
    ds_read_b64_tr_b16 v[142:143], v71 offset:48128
    v_cndmask_b32 v61, v52, v53, s[20:21]
    v_mfma_f32_16x16x32_bf16 v[116:119], a[200:203], v[124:127], v[116:119]
    s_waitcnt lgkmcnt(6)
    v_cndmask_b32 v57, v57, v50, s[22:23]
    v_cndmask_b32 v61, v61, v54, s[22:23]
    v_mfma_f32_16x16x32_bf16 v[96:99], a[204:207], v[128:131], v[96:99]
    s_waitcnt lgkmcnt(4)
    ds_read_b64_tr_b16 v[120:121], v67 offset:49152
    v_cndmask_b32 v57, v57, v51, s[24:25]
    v_mfma_f32_16x16x32_bf16 v[108:111], a[204:207], v[132:135], v[108:111]
    ds_read_b64_tr_b16 v[122:123], v67 offset:50176
    v_cndmask_b32 v61, v61, v55, s[24:25]
    v_mfma_f32_16x16x32_bf16 v[100:103], a[208:211], v[128:131], v[100:103]
    ds_write2_b64 v29, v[56:57], v[60:61] offset0:0 offset1:1
    buffer_load_dwordx4 v[236:239], v17, s[36:39], s58 offen sc1
    v_mfma_f32_16x16x32_bf16 v[112:115], a[208:211], v[132:135], v[112:115]
Lwarm1_4:
    s_cbranch_execz Lwarm_ret
    ds_read_b64_tr_b16 v[124:125], v71 offset:49152
    v_mul_f32 v75, v75, v171
    v_mfma_f32_16x16x32_bf16 v[104:107], a[212:215], v[128:131], v[104:107]
    ds_read_b64_tr_b16 v[126:127], v71 offset:50176
    v_cvt_pk_bf16_f32 v161, v74, v75
    v_mfma_f32_16x16x32_bf16 v[116:119], a[212:215], v[132:135], v[116:119]
    s_waitcnt lgkmcnt(7)
    v_mul_f32 v168, v76, v154
    v_mul_f32 v169, v77, v154
    v_mfma_f32_16x16x32_bf16 v[96:99], a[216:219], v[136:139], v[96:99]
    s_waitcnt lgkmcnt(5)
    buffer_load_dwordx4 v[240:243], v18, s[36:39], s58 offen sc1
    v_mfma_f32_16x16x32_bf16 v[108:111], a[216:219], v[140:143], v[108:111]
    s_waitcnt vmcnt(17)
    s_waitcnt lgkmcnt(0)
    s_barrier
    v_exp_f32 v168, v168
    v_mfma_f32_16x16x32_bf16 v[100:103], a[220:223], v[136:139], v[100:103]
    ds_read_b64_tr_b16 v[128:129], v64 offset:0
    ds_read_b64_tr_b16 v[130:131], v64 offset:1024
    v_mfma_f32_16x16x32_bf16 v[112:115], a[220:223], v[140:143], v[112:115]
    v_exp_f32 v169, v169
    v_mfma_f32_16x16x32_bf16 v[104:107], a[224:227], v[136:139], v[104:107]
    ds_read_b64_tr_b16 v[132:133], v68 offset:0
    v_mul_f32 v76, v76, v88
    v_mfma_f32_16x16x32_bf16 v[116:119], a[224:227], v[140:143], v[116:119]
    ds_read_b64_tr_b16 v[134:135], v68 offset:1024
    v_mul_f32 v77, v77, v89
    v_mfma_f32_16x16x32_bf16 v[96:99], a[228:231], v[120:123], v[96:99]
    s_add_u32 m0, s12, 122880
    ds_read_b64_tr_b16 v[136:137], v64 offset:2048
    v_fma_f32 v168, v168, v156, v156
    v_mfma_f32_16x16x32_bf16 v[108:111], a[228:231], v[124:127], v[108:111]
    s_add_u32 s54, s11, 122880
    ds_read_b64_tr_b16 v[138:139], v64 offset:3072
    buffer_load_dwordx4 v4, s[36:39], s54 offen offset:0 sc1 lds
    v_mfma_f32_16x16x32_bf16 v[100:103], a[232:235], v[120:123], v[100:103]
    ds_read2st64_b64 v[144:147], v42 offset0:8 offset1:10
    ds_read2st64_b64 v[148:151], v42 offset0:12 offset1:14
    v_mfma_f32_16x16x32_bf16 v[112:115], a[232:235], v[124:127], v[112:115]
    ds_read_b64_tr_b16 v[140:141], v68 offset:2048
    v_fma_f32 v169, v169, v156, v156
    v_mfma_f32_16x16x32_bf16 v[104:107], a[236:239], v[120:123], v[104:107]
    v_rcp_f32 v168, v168
    v_mfma_f32_16x16x32_bf16 v[116:119], a[236:239], v[124:127], v[116:119]
    v_rcp_f32 v169, v169
    v_mul_f32 v76, v76, v168
    v_mul_f32 v77, v77, v169
    v_cvt_pk_bf16_f32 v162, v76, v77
    v_mul_f32 v170, v78, v154
    v_mul_f32 v171, v79, v154
    v_exp_f32 v170, v170
    v_exp_f32 v171, v171
    v_mul_f32 v78, v78, v90
    v_mul_f32 v79, v79, v91
    v_fma_f32 v170, v170, v156, v156
    v_fma_f32 v171, v171, v156, v156
    v_rcp_f32 v170, v170
    v_rcp_f32 v171, v171
    v_mul_f32 v78, v78, v170
    v_mul_f32 v79, v79, v171
    v_cvt_pk_bf16_f32 v163, v78, v79
    buffer_store_dwordx4 v[160:163], v158, s[36:39], s55 offen sc1
    s_waitcnt lgkmcnt(7)
    ds_read_b64_tr_b16 v[142:143], v68 offset:3072
    buffer_load_dwordx4 v4, s[36:39], s54 offen offset:1024 sc1 lds
    v_mfma_f32_16x16x32_bf16 v[72:75], a[0:3], v[128:131], 0
    s_waitcnt lgkmcnt(6)
    ds_read_b64_tr_b16 v[120:121], v64 offset:4096
    v_mfma_f32_16x16x32_bf16 v[84:87], a[0:3], v[132:135], 0
    ds_read_b64_tr_b16 v[122:123], v64 offset:5120
    s_waitcnt lgkmcnt(5)
    v_add_f32 v144, v144, v146
    v_mfma_f32_16x16x32_bf16 v[76:79], a[4:7], v[128:131], 0
    v_add_f32 v145, v145, v147
    s_waitcnt lgkmcnt(4)
    v_add_f32 v148, v148, v150
    v_mfma_f32_16x16x32_bf16 v[88:91], a[4:7], v[132:135], 0
    ds_read_b64_tr_b16 v[124:125], v68 offset:4096
    v_add_f32 v149, v149, v151
    v_mfma_f32_16x16x32_bf16 v[80:83], a[8:11], v[128:131], 0
    ds_read_b64_tr_b16 v[126:127], v68 offset:5120
    buffer_load_dwordx4 v4, s[36:39], s54 offen offset:2048 sc1 lds
    v_mfma_f32_16x16x32_bf16 v[92:95], a[8:11], v[132:135], 0
    v_add_f32 v144, v144, v148
    v_add_f32 v145, v145, v149
    v_mfma_f32_16x16x32_bf16 v[72:75], a[12:15], v[136:139], v[72:75]
    s_waitcnt lgkmcnt(4)
    ds_read_b64_tr_b16 v[128:129], v64 offset:6144
    v_mul_f32 v144, 986500301, v144
    v_mfma_f32_16x16x32_bf16 v[84:87], a[12:15], v[140:143], v[84:87]
    ds_read_b64_tr_b16 v[130:131], v64 offset:7168
    v_mul_f32 v145, 986500301, v145
    v_mfma_f32_16x16x32_bf16 v[76:79], a[16:19], v[136:139], v[76:79]
    v_cvt_pk_bf16_f32 v152, 0, v144
    v_cvt_pk_bf16_f32 v153, 0, v144
    v_mfma_f32_16x16x32_bf16 v[88:91], a[16:19], v[140:143], v[88:91]
    ds_read_b64_tr_b16 v[132:133], v68 offset:6144
    buffer_load_dwordx4 v4, s[36:39], s54 offen offset:3072 sc1 lds
    v_mfma_f32_16x16x32_bf16 v[80:83], a[20:23], v[136:139], v[80:83]
    ds_read_b64_tr_b16 v[134:135], v68 offset:7168
    v_fma_f32 v145, -v144, v144, v145
    v_mfma_f32_16x16x32_bf16 v[92:95], a[20:23], v[140:143], v[92:95]
    s_waitcnt lgkmcnt(6)
    v_max_f32 v145, 0, v145
    v_mfma_f32_16x16x32_bf16 v[72:75], a[24:27], v[120:123], v[72:75]
    s_waitcnt lgkmcnt(4)
    v_permlane32_swap_b32 v152, v153
    v_mfma_f32_16x16x32_bf16 v[84:87], a[24:27], v[124:127], v[84:87]
    ds_read_b64_tr_b16 v[136:137], v64 offset:8192
    v_cvt_pk_bf16_f32 v145, 0, v145
    v_mfma_f32_16x16x32_bf16 v[76:79], a[28:31], v[120:123], v[76:79]
    s_add_u32 m0, s12, 126976
    ds_read_b64_tr_b16 v[138:139], v64 offset:9216
    v_add_f32 v145, 0x3727c5ac, v145
    v_mfma_f32_16x16x32_bf16 v[88:91], a[28:31], v[124:127], v[88:91]
    s_add_u32 s54, s11, 126976
    ds_read_b64_tr_b16 v[140:141], v68 offset:8192
    buffer_load_dwordx4 v4, s[36:39], s54 offen offset:0 sc1 lds
    v_mfma_f32_16x16x32_bf16 v[80:83], a[32:35], v[120:123], v[80:83]
    ds_read_b64_tr_b16 v[142:143], v68 offset:9216
    v_cvt_pk_bf16_f32 v145, 0, v145
    v_mfma_f32_16x16x32_bf16 v[92:95], a[32:35], v[124:127], v[92:95]
    s_waitcnt lgkmcnt(6)
    v_sqrt_f32 v145, v145
    v_mfma_f32_16x16x32_bf16 v[72:75], a[36:39], v[128:131], v[72:75]
    s_waitcnt lgkmcnt(4)
    ds_read_b64_tr_b16 v[120:121], v65 offset:0
    v_fma_f32 v96, -v180, v152, v96
    v_mfma_f32_16x16x32_bf16 v[84:87], a[36:39], v[132:135], v[84:87]
    ds_read_b64_tr_b16 v[122:123], v65 offset:1024
    buffer_load_dwordx4 v4, s[36:39], s54 offen offset:1024 sc1 lds
    v_mfma_f32_16x16x32_bf16 v[76:79], a[40:43], v[128:131], v[76:79]
    v_fma_f32 v108, -v180, v153, v108
    v_cvt_pk_bf16_f32 v145, 0, v145
    v_mfma_f32_16x16x32_bf16 v[88:91], a[40:43], v[132:135], v[88:91]
    ds_read_b64_tr_b16 v[124:125], v69 offset:0
    v_fma_f32 v97, -v181, v152, v97
    v_mfma_f32_16x16x32_bf16 v[80:83], a[44:47], v[128:131], v[80:83]
    v_rcp_f32 v154, v145
    v_mfma_f32_16x16x32_bf16 v[92:95], a[44:47], v[132:135], v[92:95]
    s_waitcnt lgkmcnt(5)
    ds_read_b64_tr_b16 v[126:127], v69 offset:1024
    v_mul_f32 v156, v145, v145
    v_mfma_f32_16x16x32_bf16 v[72:75], a[48:51], v[136:139], v[72:75]
    s_waitcnt lgkmcnt(4)
    ds_read_b64_tr_b16 v[128:129], v65 offset:2048
    v_fma_f32 v109, -v181, v153, v109
    v_mfma_f32_16x16x32_bf16 v[84:87], a[48:51], v[140:143], v[84:87]
    ds_read_b64_tr_b16 v[130:131], v65 offset:3072
    buffer_load_dwordx4 v4, s[36:39], s54 offen offset:2048 sc1 lds
    v_mfma_f32_16x16x32_bf16 v[76:79], a[52:55], v[136:139], v[76:79]
    v_mul_f32 v154, 0xbfb8aa3b, v154
    v_fma_f32 v98, -v182, v152, v98
    v_mfma_f32_16x16x32_bf16 v[88:91], a[52:55], v[140:143], v[88:91]
    ds_read_b64_tr_b16 v[132:133], v69 offset:2048
    v_fma_f32 v110, -v182, v153, v110
    v_mfma_f32_16x16x32_bf16 v[80:83], a[56:59], v[136:139], v[80:83]
    ds_read_b64_tr_b16 v[134:135], v69 offset:3072
    v_fma_f32 v99, -v183, v152, v99
    v_mfma_f32_16x16x32_bf16 v[92:95], a[56:59], v[140:143], v[92:95]
    s_waitcnt lgkmcnt(6)
    v_fma_f32 v111, -v183, v153, v111
    v_fma_f32 v100, -v184, v152, v100
    v_mfma_f32_16x16x32_bf16 v[72:75], a[60:63], v[120:123], v[72:75]
    s_waitcnt lgkmcnt(4)
    ds_read_b64_tr_b16 v[136:137], v65 offset:4096
    buffer_load_dwordx4 v4, s[36:39], s54 offen offset:3072 sc1 lds
    v_mfma_f32_16x16x32_bf16 v[84:87], a[60:63], v[124:127], v[84:87]
    v_fma_f32 v112, -v184, v153, v112
    v_fma_f32 v101, -v185, v152, v101
    v_mfma_f32_16x16x32_bf16 v[76:79], a[64:67], v[120:123], v[76:79]
    ds_read_b64_tr_b16 v[138:139], v65 offset:5120
    v_fma_f32 v113, -v185, v153, v113
    v_mfma_f32_16x16x32_bf16 v[88:91], a[64:67], v[124:127], v[88:91]
    v_fma_f32 v102, -v186, v152, v102
    v_fma_f32 v114, -v186, v153, v114
    v_mfma_f32_16x16x32_bf16 v[80:83], a[68:71], v[120:123], v[80:83]
    v_fma_f32 v103, -v187, v152, v103
    v_fma_f32 v115, -v187, v153, v115
    v_mfma_f32_16x16x32_bf16 v[92:95], a[68:71], v[124:127], v[92:95]
    s_add_u32 m0, s12, 131072
    ds_read_b64_tr_b16 v[140:141], v69 offset:4096
    v_fma_f32 v104, -v188, v152, v104
    v_mfma_f32_16x16x32_bf16 v[48:51], v[120:123], v[120:123], 0
    s_add_u32 s54, s11, 131072
    buffer_load_dwordx4 v4, s[36:39], s54 offen offset:0 sc1 lds
    v_fma_f32 v116, -v188, v153, v116
    v_mfma_f32_16x16x32_bf16 v[56:59], v[12:15], v[120:123], 0
    ds_read_b64_tr_b16 v[142:143], v69 offset:5120
    v_fma_f32 v105, -v189, v152, v105
    v_mfma_f32_16x16x32_bf16 v[52:55], v[124:127], v[124:127], 0
    v_fma_f32 v117, -v189, v153, v117
    v_fma_f32 v106, -v190, v152, v106
    v_mfma_f32_16x16x32_bf16 v[60:63], v[12:15], v[124:127], 0
    s_waitcnt lgkmcnt(6)
    v_fma_f32 v118, -v190, v153, v118
    v_fma_f32 v107, -v191, v152, v107
    v_mfma_f32_16x16x32_bf16 v[72:75], a[72:75], v[128:131], v[72:75]
    s_waitcnt lgkmcnt(4)
    ds_read_b64_tr_b16 v[120:121], v65 offset:6144
    buffer_load_dwordx4 v4, s[36:39], s54 offen offset:1024 sc1 lds
    v_mfma_f32_16x16x32_bf16 v[84:87], a[72:75], v[132:135], v[84:87]
    ds_read_b64_tr_b16 v[122:123], v65 offset:7168
    v_fma_f32 v119, -v191, v153, v119
    v_mfma_f32_16x16x32_bf16 v[76:79], a[76:79], v[128:131], v[76:79]
    v_permlane32_swap_b32 v96, v108
    v_mfma_f32_16x16x32_bf16 v[88:91], a[76:79], v[132:135], v[88:91]
    v_permlane32_swap_b32 v97, v109
    v_mfma_f32_16x16x32_bf16 v[80:83], a[80:83], v[128:131], v[80:83]
    v_permlane32_swap_b32 v98, v110
    v_mfma_f32_16x16x32_bf16 v[92:95], a[80:83], v[132:135], v[92:95]
    s_add_u32 s58, s27, 10240
    v_permlane32_swap_b32 v99, v111
    v_mfma_f32_16x16x32_bf16 v[48:51], v[128:131], v[128:131], v[48:51]
    s_add_u32 m0, s19, 9216
    ds_read_b64_tr_b16 v[124:125], v69 offset:6144
    buffer_load_dwordx4 v16, s[36:39], s58 offen sc1 lds
    v_mfma_f32_16x16x32_bf16 v[56:59], v[12:15], v[128:131], v[56:59]
    v_permlane32_swap_b32 v100, v112
    v_mfma_f32_16x16x32_bf16 v[52:55], v[132:135], v[132:135], v[52:55]
    v_permlane32_swap_b32 v101, v113
    v_mfma_f32_16x16x32_bf16 v[60:63], v[12:15], v[132:135], v[60:63]
    s_waitcnt lgkmcnt(5)
    v_permlane32_swap_b32 v102, v114
    v_mfma_f32_16x16x32_bf16 v[72:75], a[84:87], v[136:139], v[72:75]
    s_waitcnt lgkmcnt(3)
    ds_read_b64_tr_b16 v[126:127], v69 offset:7168
    ds_read_b64_tr_b16 v[128:129], v65 offset:8192
    v_mfma_f32_16x16x32_bf16 v[84:87], a[84:87], v[140:143], v[84:87]
    s_add_u32 m0, s19, 10240
    ds_read_b64_tr_b16 v[130:131], v65 offset:9216
    buffer_load_dwordx4 v17, s[36:39], s58 offen sc1 lds
    v_mfma_f32_16x16x32_bf16 v[76:79], a[88:91], v[136:139], v[76:79]
    v_permlane32_swap_b32 v103, v115
    v_mfma_f32_16x16x32_bf16 v[88:91], a[88:91], v[140:143], v[88:91]
    v_permlane32_swap_b32 v104, v116
    v_mfma_f32_16x16x32_bf16 v[80:83], a[92:95], v[136:139], v[80:83]
    ds_read_b64_tr_b16 v[36:37], v8 offset:0
    ds_read_b64_tr_b16 v[176:177], v9 offset:0
    v_mfma_f32_16x16x32_bf16 v[92:95], a[92:95], v[140:143], v[92:95]
    v_permlane32_swap_b32 v105, v117
    v_mfma_f32_16x16x32_bf16 v[48:51], v[136:139], v[136:139], v[48:51]
    s_add_u32 m0, s19, 11264
    ds_read_b64_tr_b16 v[132:133], v69 offset:8192
    buffer_load_dwordx4 v18, s[36:39], s58 offen sc1 lds
    v_mfma_f32_16x16x32_bf16 v[56:59], v[12:15], v[136:139], v[56:59]
    v_permlane32_swap_b32 v106, v118
    v_mfma_f32_16x16x32_bf16 v[52:55], v[140:143], v[140:143], v[52:55]
    v_permlane32_swap_b32 v107, v119
    v_mfma_f32_16x16x32_bf16 v[60:63], v[12:15], v[140:143], v[60:63]
    s_waitcnt lgkmcnt(7)
    ds_read_b64_tr_b16 v[134:135], v69 offset:9216
    v_mul_f32 v168, v104, v154
    v_mfma_f32_16x16x32_bf16 v[72:75], a[96:99], v[120:123], v[72:75]
    s_waitcnt lgkmcnt(6)
    s_waitcnt vmcnt(12)
    ds_read_b64_tr_b16 v[136:137], v66 offset:0
    buffer_atomic_add v27, v31, s[36:39], s14 offen offset:0 sc1
    v_mfma_f32_16x16x32_bf16 v[84:87], a[96:99], v[124:127], v[84:87]
    s_add_u32 m0, s19, 12288
    ds_read_b64_tr_b16 v[138:139], v66 offset:1024
    buffer_load_dwordx4 v19, s[36:39], s58 offen sc1 lds
    v_mfma_f32_16x16x32_bf16 v[76:79], a[100:103], v[120:123], v[76:79]
    ds_read_b64_tr_b16 v[140:141], v70 offset:0
    v_mul_f32 v169, v105, v154
    v_mfma_f32_16x16x32_bf16 v[88:91], a[100:103], v[124:127], v[88:91]
    v_exp_f32 v168, v168
    v_mfma_f32_16x16x32_bf16 v[80:83], a[104:107], v[120:123], v[80:83]
    v_exp_f32 v169, v169
    v_mfma_f32_16x16x32_bf16 v[92:95], a[104:107], v[124:127], v[92:95]
    v_mul_f32 v104, v104, v116
    v_mul_f32 v105, v105, v117
    v_mfma_f32_16x16x32_bf16 v[48:51], v[120:123], v[120:123], v[48:51]
    s_add_u32 m0, s19, 13312
    ds_read_b64_tr_b16 v[142:143], v70 offset:1024
    buffer_load_dwordx4 v20, s[36:39], s58 offen sc1 lds
    v_mfma_f32_16x16x32_bf16 v[56:59], v[12:15], v[120:123], v[56:59]
    v_fma_f32 v168, v168, v156, v156
    v_fma_f32 v169, v169, v156, v156
    v_mfma_f32_16x16x32_bf16 v[52:55], v[124:127], v[124:127], v[52:55]
    v_rcp_f32 v168, v168
    v_mfma_f32_16x16x32_bf16 v[60:63], v[12:15], v[124:127], v[60:63]
    s_waitcnt lgkmcnt(8)
    v_rcp_f32 v169, v169
    v_mfma_f32_16x16x32_bf16 v[72:75], a[108:111], v[128:131], v[72:75]
    s_waitcnt lgkmcnt(4)
    ds_read_b64_tr_b16 v[120:121], v66 offset:2048
    v_mul_f32 v104, v104, v168
    v_mfma_f32_16x16x32_bf16 v[84:87], a[108:111], v[132:135], v[84:87]
    s_add_u32 s58, s27, 15360
    v_mul_f32 v105, v105, v169
    v_cvt_pk_bf16_f32 v164, v104, v105
    v_mfma_f32_16x16x32_bf16 v[76:79], a[112:115], v[128:131], v[76:79]
Lwarm3:
    s_cbranch_execz Lwarm3_1
    s_add_u32 m0, s19, 14336
    ds_read_b64_tr_b16 v[122:123], v66 offset:3072
    buffer_load_dwordx4 v16, s[36:39], s58 offen sc1 lds
    v_mfma_f32_16x16x32_bf16 v[88:91], a[112:115], v[132:135], v[88:91]
    v_mul_f32 v170, v106, v154
    v_mul_f32 v171, v107, v154
    v_mfma_f32_16x16x32_bf16 v[80:83], a[116:119], v[128:131], v[80:83]
    v_exp_f32 v170, v170
    v_mfma_f32_16x16x32_bf16 v[92:95], a[116:119], v[132:135], v[92:95]
    v_exp_f32 v171, v171
    v_mfma_f32_16x16x32_bf16 v[48:51], v[128:131], v[128:131], v[48:51]
    s_add_u32 m0, s19, 15360
    ds_read_b64_tr_b16 v[124:125], v70 offset:2048
    buffer_load_dwordx4 v17, s[36:39], s58 offen sc1 lds
    v_mfma_f32_16x16x32_bf16 v[56:59], v[12:15], v[128:131], v[56:59]
    ds_read_b64_tr_b16 v[126:127], v70 offset:3072
    v_mul_f32 v106, v106, v118
    v_mfma_f32_16x16x32_bf16 v[52:55], v[132:135], v[132:135], v[52:55]
    v_mul_f32 v107, v107, v119
    v_fma_f32 v170, v170, v156, v156
    v_mfma_f32_16x16x32_bf16 v[60:63], v[12:15], v[132:135], v[60:63]
    s_waitcnt lgkmcnt(6)
    v_fma_f32 v171, v171, v156, v156
    v_mfma_f32_16x16x32_bf16 v[72:75], a[120:123], v[136:139], v[72:75]
    s_waitcnt lgkmcnt(4)
    v_rcp_f32 v170, v170
    v_mfma_f32_16x16x32_bf16 v[84:87], a[120:123], v[140:143], v[84:87]
    ds_read_b64_tr_b16 v[128:129], v66 offset:4096
    ds_read_b64_tr_b16 v[130:131], v66 offset:5120
    v_mfma_f32_16x16x32_bf16 v[76:79], a[124:127], v[136:139], v[76:79]
    s_add_u32 m0, s19, 16384
    ds_read_b64_tr_b16 v[132:133], v70 offset:4096
    buffer_load_dwordx4 v18, s[36:39], s58 offen sc1 lds
    v_mfma_f32_16x16x32_bf16 v[88:91], a[124:127], v[140:143], v[88:91]
    v_rcp_f32 v171, v171
    v_mfma_f32_16x16x32_bf16 v[80:83], a[128:131], v[136:139], v[80:83]
    ds_read_b64_tr_b16 v[134:135], v70 offset:5120
    v_mul_f32 v106, v106, v170
    v_mfma_f32_16x16x32_bf16 v[92:95], a[128:131], v[140:143], v[92:95]
    s_waitcnt lgkmcnt(6)
    v_mul_f32 v107, v107, v171
    v_cvt_pk_bf16_f32 v165, v106, v107
    v_mfma_f32_16x16x32_bf16 v[72:75], a[132:135], v[120:123], v[72:75]
    s_waitcnt lgkmcnt(4)
    ds_read_b64_tr_b16 v[136:137], v66 offset:6144
    v_mul_f32 v168, v96, v154
    v_mfma_f32_16x16x32_bf16 v[84:87], a[132:135], v[124:127], v[84:87]
    s_add_u32 m0, s19, 17408
    ds_read_b64_tr_b16 v[138:139], v66 offset:7168
    buffer_load_dwordx4 v19, s[36:39], s58 offen sc1 lds
    v_mfma_f32_16x16x32_bf16 v[76:79], a[136:139], v[120:123], v[76:79]
    ds_read_b64_tr_b16 v[140:141], v70 offset:6144
    v_mul_f32 v169, v97, v154
    v_mfma_f32_16x16x32_bf16 v[88:91], a[136:139], v[124:127], v[88:91]
    v_permlane16_swap_b32 v164, v166
    v_mfma_f32_16x16x32_bf16 v[80:83], a[140:143], v[120:123], v[80:83]
    v_permlane16_swap_b32 v165, v167
    v_mfma_f32_16x16x32_bf16 v[92:95], a[140:143], v[124:127], v[92:95]
    s_waitcnt lgkmcnt(5)
    ds_read_b64_tr_b16 v[142:143], v70 offset:7168
    s_add_u32 s55, s10, 1572864
    v_mfma_f32_16x16x32_bf16 v[72:75], a[144:147], v[128:131], v[72:75]
    s_waitcnt lgkmcnt(4)
    ds_read_b64_tr_b16 v[120:121], v66 offset:8192
    buffer_store_dwordx4 v[164:167], v159, s[36:39], s55 offen offset:512 sc1
    v_mfma_f32_16x16x32_bf16 v[84:87], a[144:147], v[132:135], v[84:87]
    s_add_u32 s58, s26, 10240
    ds_read_b64_tr_b16 v[122:123], v66 offset:9216
    buffer_load_dwordx4 v[244:247], v19, s[36:39], s58 offen sc1
    v_mfma_f32_16x16x32_bf16 v[76:79], a[148:151], v[128:131], v[76:79]
    v_exp_f32 v168, v168
    v_mfma_f32_16x16x32_bf16 v[88:91], a[148:151], v[132:135], v[88:91]
    v_exp_f32 v169, v169
    v_mfma_f32_16x16x32_bf16 v[80:83], a[152:155], v[128:131], v[80:83]
    ds_read_b64_tr_b16 v[124:125], v70 offset:8192
    v_mul_f32 v96, v96, v108
    v_mfma_f32_16x16x32_bf16 v[92:95], a[152:155], v[132:135], v[92:95]
    s_waitcnt lgkmcnt(5)
    ds_read_b64_tr_b16 v[126:127], v70 offset:9216
    buffer_load_dwordx4 v[248:251], v20, s[36:39], s58 offen sc1
    v_mfma_f32_16x16x32_bf16 v[72:75], a[156:159], v[136:139], v[72:75]
    s_waitcnt lgkmcnt(4)
    ds_read_b64_tr_b16 v[128:129], v67 offset:0
    v_mul_f32 v97, v97, v109
    v_mfma_f32_16x16x32_bf16 v[84:87], a[156:159], v[140:143], v[84:87]
    ds_read_b64_tr_b16 v[130:131], v67 offset:1024
    v_fma_f32 v168, v168, v156, v156
    v_mfma_f32_16x16x32_bf16 v[76:79], a[160:163], v[136:139], v[76:79]
    ds_read_b64_tr_b16 v[132:133], v71 offset:0
    v_fma_f32 v169, v169, v156, v156
    v_mfma_f32_16x16x32_bf16 v[88:91], a[160:163], v[140:143], v[88:91]
    v_rcp_f32 v168, v168
    v_mfma_f32_16x16x32_bf16 v[80:83], a[164:167], v[136:139], v[80:83]
    s_add_u32 s58, s26, 15360
    ds_read_b64_tr_b16 v[134:135], v71 offset:1024
    buffer_load_dwordx4 v[252:255], v16, s[36:39], s58 offen sc1
    v_mfma_f32_16x16x32_bf16 v[92:95], a[164:167], v[140:143], v[92:95]
    s_waitcnt lgkmcnt(6)
    v_rcp_f32 v169, v169
    v_mfma_f32_16x16x32_bf16 v[72:75], a[168:171], v[120:123], v[72:75]
    s_waitcnt lgkmcnt(4)
    ds_read_b64_tr_b16 v[136:137], v67 offset:2048
    v_mul_f32 v96, v96, v168
    v_mfma_f32_16x16x32_bf16 v[84:87], a[168:171], v[124:127], v[84:87]
    ds_read_b64_tr_b16 v[138:139], v67 offset:3072
    v_mul_f32 v97, v97, v169
    v_mfma_f32_16x16x32_bf16 v[76:79], a[172:175], v[120:123], v[76:79]
    v_cvt_pk_bf16_f32 v160, v96, v97
    v_mul_f32 v170, v98, v154
    v_mfma_f32_16x16x32_bf16 v[88:91], a[172:175], v[124:127], v[88:91]
    ds_read_b64_tr_b16 v[140:141], v71 offset:2048
    v_mul_f32 v171, v99, v154
    v_mfma_f32_16x16x32_bf16 v[80:83], a[176:179], v[120:123], v[80:83]
    ds_read_b64_tr_b16 v[142:143], v71 offset:3072
    buffer_load_dwordx4 a[240:243], v17, s[36:39], s58 offen sc1
    v_mfma_f32_16x16x32_bf16 v[92:95], a[176:179], v[124:127], v[92:95]
    s_waitcnt lgkmcnt(6)
    v_exp_f32 v170, v170
    v_mfma_f32_16x16x32_bf16 v[72:75], a[180:183], v[128:131], v[72:75]
    s_waitcnt lgkmcnt(4)
    v_exp_f32 v171, v171
    v_mfma_f32_16x16x32_bf16 v[84:87], a[180:183], v[132:135], v[84:87]
    ds_read_b64_tr_b16 v[120:121], v67 offset:4096
    v_mul_f32 v98, v98, v110
    v_mfma_f32_16x16x32_bf16 v[76:79], a[184:187], v[128:131], v[76:79]
    ds_read_b64_tr_b16 v[122:123], v67 offset:5120
    v_mul_f32 v99, v99, v111
    v_mfma_f32_16x16x32_bf16 v[88:91], a[184:187], v[132:135], v[88:91]
    ds_read_b64_tr_b16 v[124:125], v71 offset:4096
    buffer_load_dwordx4 a[244:247], v18, s[36:39], s58 offen sc1
    v_mfma_f32_16x16x32_bf16 v[80:83], a[188:191], v[128:131], v[80:83]
    ds_read_b64_tr_b16 v[126:127], v71 offset:5120
    v_fma_f32 v170, v170, v156, v156
    v_mfma_f32_16x16x32_bf16 v[92:95], a[188:191], v[132:135], v[92:95]
    s_waitcnt lgkmcnt(6)
    v_fma_f32 v171, v171, v156, v156
    v_mfma_f32_16x16x32_bf16 v[72:75], a[192:195], v[136:139], v[72:75]
    s_waitcnt lgkmcnt(4)
    v_rcp_f32 v170, v170
    v_mfma_f32_16x16x32_bf16 v[84:87], a[192:195], v[140:143], v[84:87]
    ds_read_b64_tr_b16 v[128:129], v67 offset:6144
    ds_read_b64_tr_b16 v[130:131], v67 offset:7168
    v_mfma_f32_16x16x32_bf16 v[76:79], a[196:199], v[136:139], v[76:79]
    ds_read_b64_tr_b16 v[132:133], v71 offset:6144
    buffer_load_dwordx4 a[248:251], v19, s[36:39], s58 offen sc1
    v_mfma_f32_16x16x32_bf16 v[88:91], a[196:199], v[140:143], v[88:91]
    v_cndmask_b32 v57, v48, v49, s[20:21]
    v_cndmask_b32 v61, v52, v53, s[20:21]
    v_mfma_f32_16x16x32_bf16 v[80:83], a[200:203], v[136:139], v[80:83]
    ds_read_b64_tr_b16 v[134:135], v71 offset:7168
    v_cndmask_b32 v57, v57, v50, s[22:23]
    v_mfma_f32_16x16x32_bf16 v[92:95], a[200:203], v[140:143], v[92:95]
    s_waitcnt lgkmcnt(6)
    v_cndmask_b32 v61, v61, v54, s[22:23]
    v_cndmask_b32 v57, v57, v51, s[24:25]
    v_mfma_f32_16x16x32_bf16 v[72:75], a[204:207], v[120:123], v[72:75]
    s_waitcnt lgkmcnt(4)
    ds_read_b64_tr_b16 v[136:137], v67 offset:8192
    v_cndmask_b32 v61, v61, v55, s[24:25]
    v_mfma_f32_16x16x32_bf16 v[84:87], a[204:207], v[124:127], v[84:87]
    ds_read_b64_tr_b16 v[138:139], v67 offset:9216
    ds_write2_b64 v28, v[56:57], v[60:61] offset0:0 offset1:1
    v_mfma_f32_16x16x32_bf16 v[76:79], a[208:211], v[120:123], v[76:79]
    ds_read_b64_tr_b16 v[140:141], v71 offset:8192
    buffer_load_dwordx4 a[252:255], v20, s[36:39], s58 offen sc1
    v_mfma_f32_16x16x32_bf16 v[88:91], a[208:211], v[124:127], v[88:91]
    v_rcp_f32 v171, v171
    v_mfma_f32_16x16x32_bf16 v[80:83], a[212:215], v[120:123], v[80:83]
    ds_read_b64_tr_b16 v[142:143], v71 offset:9216
    v_mul_f32 v98, v98, v170
    v_mfma_f32_16x16x32_bf16 v[92:95], a[212:215], v[124:127], v[92:95]
    s_waitcnt lgkmcnt(7)
    v_mul_f32 v99, v99, v171
    v_cvt_pk_bf16_f32 v161, v98, v99
    v_mfma_f32_16x16x32_bf16 v[72:75], a[216:219], v[128:131], v[72:75]
    s_waitcnt lgkmcnt(5)
    v_mul_f32 v168, v100, v154
    v_mul_f32 v169, v101, v154
    v_mfma_f32_16x16x32_bf16 v[84:87], a[216:219], v[132:135], v[84:87]
    s_add_u32 s58, s27, 0
    buffer_load_dwordx4 v[44:47], v16, s[36:39], s58 offen sc1
    s_waitcnt vmcnt(19)
    s_waitcnt lgkmcnt(0)
    s_barrier
    v_exp_f32 v168, v168
    v_mfma_f32_16x16x32_bf16 v[76:79], a[220:223], v[128:131], v[76:79]
    ds_read_b64_tr_b16 v[120:121], v64 offset:40960
    ds_read_b64_tr_b16 v[122:123], v64 offset:41984
    v_mfma_f32_16x16x32_bf16 v[88:91], a[220:223], v[132:135], v[88:91]
    v_exp_f32 v169, v169
    v_mfma_f32_16x16x32_bf16 v[80:83], a[224:227], v[128:131], v[80:83]
    ds_read_b64_tr_b16 v[124:125], v68 offset:40960
    v_mul_f32 v100, v100, v112
    v_mfma_f32_16x16x32_bf16 v[92:95], a[224:227], v[132:135], v[92:95]
    ds_read_b64_tr_b16 v[126:127], v68 offset:41984
    v_mul_f32 v101, v101, v113
    v_mfma_f32_16x16x32_bf16 v[72:75], a[228:231], v[136:139], v[72:75]
    ds_read_b64_tr_b16 v[128:129], v64 offset:43008
    v_mov_b32 v43, 0
    v_mfma_f32_16x16x32_bf16 v[84:87], a[228:231], v[140:143], v[84:87]
    ds_read_b64_tr_b16 v[130:131], v64 offset:44032
    buffer_atomic_add v43, v31, s[36:39], s18 offen offset:0 sc0 sc1
    v_mfma_f32_16x16x32_bf16 v[76:79], a[232:235], v[136:139], v[76:79]
    ds_read2st64_b64 v[144:147], v42 offset0:0 offset1:2
    ds_read2st64_b64 v[148:151], v42 offset0:4 offset1:6
    v_mfma_f32_16x16x32_bf16 v[88:91], a[232:235], v[140:143], v[88:91]
    ds_read_b64_tr_b16 v[132:133], v68 offset:43008
    v_fma_f32 v168, v168, v156, v156
    v_mfma_f32_16x16x32_bf16 v[80:83], a[236:239], v[136:139], v[80:83]
    ds_read_b64_tr_b16 v[134:135], v68 offset:44032
    v_fma_f32 v169, v169, v156, v156
    v_mfma_f32_16x16x32_bf16 v[92:95], a[236:239], v[140:143], v[92:95]
    v_rcp_f32 v168, v168
    v_rcp_f32 v169, v169
    v_mul_f32 v100, v100, v168
    v_mul_f32 v101, v101, v169
    v_cvt_pk_bf16_f32 v162, v100, v101
    v_mul_f32 v170, v102, v154
    v_mul_f32 v171, v103, v154
    v_exp_f32 v170, v170
    v_exp_f32 v171, v171
    v_mul_f32 v102, v102, v114
    v_mul_f32 v103, v103, v115
    v_fma_f32 v170, v170, v156, v156
    v_fma_f32 v171, v171, v156, v156
    v_rcp_f32 v170, v170
    v_rcp_f32 v171, v171
    v_mul_f32 v102, v102, v170
    v_mul_f32 v103, v103, v171
    v_cvt_pk_bf16_f32 v163, v102, v103
    buffer_store_dwordx4 v[160:163], v158, s[36:39], s55 offen sc1
    s_waitcnt lgkmcnt(8)
    v_mfma_f32_16x16x32_bf16 v[96:99], a[0:3], v[120:123], 0
    s_waitcnt lgkmcnt(6)
    ds_read_b64_tr_b16 v[136:137], v64 offset:45056
    v_mfma_f32_16x16x32_bf16 v[108:111], a[0:3], v[124:127], 0
    ds_read_b64_tr_b16 v[138:139], v64 offset:46080
    s_waitcnt lgkmcnt(5)
    v_add_f32 v144, v144, v146
    v_mfma_f32_16x16x32_bf16 v[100:103], a[4:7], v[120:123], 0
    v_add_f32 v145, v145, v147
    s_waitcnt lgkmcnt(4)
    v_add_f32 v148, v148, v150
    v_mfma_f32_16x16x32_bf16 v[112:115], a[4:7], v[124:127], 0
    ds_read_b64_tr_b16 v[140:141], v68 offset:45056
    v_add_f32 v149, v149, v151
    v_mfma_f32_16x16x32_bf16 v[104:107], a[8:11], v[120:123], 0
    ds_read_b64_tr_b16 v[142:143], v68 offset:46080
    v_add_f32 v144, v144, v148
    v_mfma_f32_16x16x32_bf16 v[116:119], a[8:11], v[124:127], 0
    v_add_f32 v145, v145, v149
    v_mul_f32 v144, 986500301, v144
    v_mfma_f32_16x16x32_bf16 v[96:99], a[12:15], v[128:131], v[96:99]
    s_waitcnt lgkmcnt(4)
    ds_read_b64_tr_b16 v[120:121], v64 offset:47104
    v_mul_f32 v145, 986500301, v145
    v_mfma_f32_16x16x32_bf16 v[108:111], a[12:15], v[132:135], v[108:111]
    s_add_u32 s58, s27, 15360
    ds_read_b64_tr_b16 v[122:123], v64 offset:48128
    buffer_load_dwordx4 a[0:3], v20, s[36:39], s58 offen sc1
    v_mfma_f32_16x16x32_bf16 v[100:103], a[16:19], v[128:131], v[100:103]
    v_cvt_pk_bf16_f32 v152, 0, v144
    v_cvt_pk_bf16_f32 v153, 0, v144
    v_mfma_f32_16x16x32_bf16 v[112:115], a[16:19], v[132:135], v[112:115]
    ds_read_b64_tr_b16 v[124:125], v68 offset:47104
    v_fma_f32 v145, -v144, v144, v145
    v_mfma_f32_16x16x32_bf16 v[104:107], a[20:23], v[128:131], v[104:107]
    s_add_u32 s58, s28, 0
    ds_read_b64_tr_b16 v[126:127], v68 offset:48128
    buffer_load_dwordx4 a[4:7], v16, s[36:39], s58 offen sc1
    v_mfma_f32_16x16x32_bf16 v[116:119], a[20:23], v[132:135], v[116:119]
    s_waitcnt lgkmcnt(6)
    v_max_f32 v145, 0, v145
    v_mfma_f32_16x16x32_bf16 v[96:99], a[24:27], v[136:139], v[96:99]
    s_waitcnt lgkmcnt(4)
    v_permlane32_swap_b32 v152, v153
    v_mfma_f32_16x16x32_bf16 v[108:111], a[24:27], v[140:143], v[108:111]
    ds_read_b64_tr_b16 v[128:129], v64 offset:49152
    v_cvt_pk_bf16_f32 v145, 0, v145
    v_mfma_f32_16x16x32_bf16 v[100:103], a[28:31], v[136:139], v[100:103]
    ds_read_b64_tr_b16 v[130:131], v64 offset:50176
    buffer_load_dwordx4 a[8:11], v17, s[36:39], s58 offen sc1
    v_mfma_f32_16x16x32_bf16 v[112:115], a[28:31], v[140:143], v[112:115]
    ds_read_b64_tr_b16 v[132:133], v68 offset:49152
    v_add_f32 v145, 0x3727c5ac, v145
    v_mfma_f32_16x16x32_bf16 v[104:107], a[32:35], v[136:139], v[104:107]
    ds_read_b64_tr_b16 v[134:135], v68 offset:50176
    v_cvt_pk_bf16_f32 v145, 0, v145
    v_mfma_f32_16x16x32_bf16 v[116:119], a[32:35], v[140:143], v[116:119]
    s_waitcnt lgkmcnt(6)
    v_sqrt_f32 v145, v145
    v_mfma_f32_16x16x32_bf16 v[96:99], a[36:39], v[120:123], v[96:99]
    s_waitcnt lgkmcnt(4)
    ds_read_b64_tr_b16 v[136:137], v65 offset:40960
    buffer_load_dwordx4 a[12:15], v18, s[36:39], s58 offen sc1
    v_mfma_f32_16x16x32_bf16 v[108:111], a[36:39], v[124:127], v[108:111]
    ds_read_b64_tr_b16 v[138:139], v65 offset:41984
    v_fma_f32 v72, -v180, v152, v72
    v_mfma_f32_16x16x32_bf16 v[100:103], a[40:43], v[120:123], v[100:103]
    v_fma_f32 v84, -v180, v153, v84
    v_cvt_pk_bf16_f32 v145, 0, v145
    v_mfma_f32_16x16x32_bf16 v[112:115], a[40:43], v[124:127], v[112:115]
Lwarm3_1:
    s_cbranch_execz Lwarm3_2
    ds_read_b64_tr_b16 v[140:141], v69 offset:40960
    v_fma_f32 v73, -v181, v152, v73
    v_mfma_f32_16x16x32_bf16 v[104:107], a[44:47], v[120:123], v[104:107]
    ds_read_b64_tr_b16 v[142:143], v69 offset:41984
    buffer_load_dwordx4 a[16:19], v19, s[36:39], s58 offen sc1
    v_mfma_f32_16x16x32_bf16 v[116:119], a[44:47], v[124:127], v[116:119]
    s_waitcnt lgkmcnt(6)
    v_rcp_f32 v154, v145
    v_mfma_f32_16x16x32_bf16 v[96:99], a[48:51], v[128:131], v[96:99]
    s_waitcnt lgkmcnt(4)
    ds_read_b64_tr_b16 v[120:121], v65 offset:43008
    v_mul_f32 v156, v145, v145
    v_mfma_f32_16x16x32_bf16 v[108:111], a[48:51], v[132:135], v[108:111]
    ds_read_b64_tr_b16 v[122:123], v65 offset:44032
    v_fma_f32 v85, -v181, v153, v85
    v_mfma_f32_16x16x32_bf16 v[100:103], a[52:55], v[128:131], v[100:103]
    buffer_load_dwordx4 a[20:23], v20, s[36:39], s58 offen sc1
    v_mul_f32 v154, 0xbfb8aa3b, v154
    v_mfma_f32_16x16x32_bf16 v[112:115], a[52:55], v[132:135], v[112:115]
    ds_read_b64_tr_b16 v[124:125], v69 offset:43008
    v_fma_f32 v74, -v182, v152, v74
    v_mfma_f32_16x16x32_bf16 v[104:107], a[56:59], v[128:131], v[104:107]
    ds_read_b64_tr_b16 v[126:127], v69 offset:44032
    v_fma_f32 v86, -v182, v153, v86
    v_mfma_f32_16x16x32_bf16 v[116:119], a[56:59], v[132:135], v[116:119]
    s_waitcnt lgkmcnt(6)
    v_fma_f32 v75, -v183, v152, v75
    v_fma_f32 v87, -v183, v153, v87
    v_mfma_f32_16x16x32_bf16 v[96:99], a[60:63], v[136:139], v[96:99]
    s_waitcnt lgkmcnt(4)
    ds_read_b64_tr_b16 v[128:129], v65 offset:45056
    v_fma_f32 v76, -v184, v152, v76
    v_mfma_f32_16x16x32_bf16 v[108:111], a[60:63], v[140:143], v[108:111]
    s_add_u32 s58, s28, 5120
    buffer_load_dwordx4 a[24:27], v16, s[36:39], s58 offen sc1
    v_fma_f32 v88, -v184, v153, v88
    v_mfma_f32_16x16x32_bf16 v[100:103], a[64:67], v[136:139], v[100:103]
    ds_read_b64_tr_b16 v[130:131], v65 offset:46080
    v_fma_f32 v77, -v185, v152, v77
    v_mfma_f32_16x16x32_bf16 v[112:115], a[64:67], v[140:143], v[112:115]
    v_fma_f32 v89, -v185, v153, v89
    v_fma_f32 v78, -v186, v152, v78
    v_mfma_f32_16x16x32_bf16 v[104:107], a[68:71], v[136:139], v[104:107]
    buffer_load_dwordx4 a[28:31], v17, s[36:39], s58 offen sc1
    v_fma_f32 v90, -v186, v153, v90
    v_mfma_f32_16x16x32_bf16 v[116:119], a[68:71], v[140:143], v[116:119]
    ds_read_b64_tr_b16 v[132:133], v69 offset:45056
    v_fma_f32 v79, -v187, v152, v79
    v_mfma_f32_16x16x32_bf16 v[48:51], v[136:139], v[136:139], 0
    v_fma_f32 v91, -v187, v153, v91
    v_fma_f32 v80, -v188, v152, v80
    v_mfma_f32_16x16x32_bf16 v[56:59], v[12:15], v[136:139], 0
    ds_read_b64_tr_b16 v[134:135], v69 offset:46080
    v_fma_f32 v92, -v188, v153, v92
    v_mfma_f32_16x16x32_bf16 v[52:55], v[140:143], v[140:143], 0
    buffer_load_dwordx4 a[32:35], v18, s[36:39], s58 offen sc1
    v_fma_f32 v81, -v189, v152, v81
    v_mfma_f32_16x16x32_bf16 v[60:63], v[12:15], v[140:143], 0
    s_waitcnt lgkmcnt(6)
    v_fma_f32 v93, -v189, v153, v93
    v_fma_f32 v82, -v190, v152, v82
    v_mfma_f32_16x16x32_bf16 v[96:99], a[72:75], v[120:123], v[96:99]
    s_waitcnt lgkmcnt(4)
    ds_read_b64_tr_b16 v[136:137], v65 offset:47104
    v_fma_f32 v94, -v190, v153, v94
    v_mfma_f32_16x16x32_bf16 v[108:111], a[72:75], v[124:127], v[108:111]
    v_fma_f32 v83, -v191, v152, v83
    v_fma_f32 v95, -v191, v153, v95
    v_mfma_f32_16x16x32_bf16 v[100:103], a[76:79], v[120:123], v[100:103]
    ds_read_b64_tr_b16 v[138:139], v65 offset:48128
    buffer_load_dwordx4 a[36:39], v19, s[36:39], s58 offen sc1
    v_mfma_f32_16x16x32_bf16 v[112:115], a[76:79], v[124:127], v[112:115]
    v_permlane32_swap_b32 v72, v84
    v_mfma_f32_16x16x32_bf16 v[104:107], a[80:83], v[120:123], v[104:107]
    v_permlane32_swap_b32 v73, v85
    v_mfma_f32_16x16x32_bf16 v[116:119], a[80:83], v[124:127], v[116:119]
    v_permlane32_swap_b32 v74, v86
    v_mfma_f32_16x16x32_bf16 v[48:51], v[120:123], v[120:123], v[48:51]
    ds_read_b64_tr_b16 v[140:141], v69 offset:47104
    buffer_load_dwordx4 a[40:43], v20, s[36:39], s58 offen sc1
    v_mfma_f32_16x16x32_bf16 v[56:59], v[12:15], v[120:123], v[56:59]
    v_permlane32_swap_b32 v75, v87
    v_mfma_f32_16x16x32_bf16 v[52:55], v[124:127], v[124:127], v[52:55]
    v_permlane32_swap_b32 v76, v88
    v_mfma_f32_16x16x32_bf16 v[60:63], v[12:15], v[124:127], v[60:63]
    s_waitcnt lgkmcnt(5)
    v_permlane32_swap_b32 v77, v89
    v_mfma_f32_16x16x32_bf16 v[96:99], a[84:87], v[128:131], v[96:99]
    s_waitcnt lgkmcnt(3)
    ds_read_b64_tr_b16 v[142:143], v69 offset:48128
    ds_read_b64_tr_b16 v[120:121], v65 offset:49152
    v_mfma_f32_16x16x32_bf16 v[108:111], a[84:87], v[132:135], v[108:111]
    s_add_u32 s58, s28, 10240
    ds_read_b64_tr_b16 v[122:123], v65 offset:50176
    buffer_load_dwordx4 a[44:47], v16, s[36:39], s58 offen sc1
    v_mfma_f32_16x16x32_bf16 v[100:103], a[88:91], v[128:131], v[100:103]
    v_permlane32_swap_b32 v78, v90
    v_mfma_f32_16x16x32_bf16 v[112:115], a[88:91], v[132:135], v[112:115]
    v_permlane32_swap_b32 v79, v91
    v_mfma_f32_16x16x32_bf16 v[104:107], a[92:95], v[128:131], v[104:107]
    ds_read_b64_tr_b16 v[38:39], v8 offset:40960
    ds_read_b64_tr_b16 v[178:179], v9 offset:40960
    v_mfma_f32_16x16x32_bf16 v[116:119], a[92:95], v[132:135], v[116:119]
    s_add_u32 s50, s44, 16
    s_waitcnt vmcnt(13)
    v_cmp_ne_u32 vcc, s50, v43
    s_nop 0
    s_and_b64 vcc, vcc, 0x1
    s_cbranch_scc1 Lslow35
Lgot36:
    v_permlane32_swap_b32 v80, v92
    v_mfma_f32_16x16x32_bf16 v[48:51], v[128:131], v[128:131], v[48:51]
    s_add_u32 s54, s29, 0
    ds_read_b64_tr_b16 v[124:125], v69 offset:49152
    buffer_load_dwordx4 a[48:51], v4, s[36:39], s54 offen offset:0 sc1
    v_mfma_f32_16x16x32_bf16 v[56:59], v[12:15], v[128:131], v[56:59]
    v_permlane32_swap_b32 v81, v93
    v_mfma_f32_16x16x32_bf16 v[52:55], v[132:135], v[132:135], v[52:55]
    ds_read_b64_tr_b16 v[126:127], v69 offset:50176
    buffer_load_dwordx4 a[52:55], v4, s[36:39], s54 offen offset:1024 sc1
    v_mfma_f32_16x16x32_bf16 v[60:63], v[12:15], v[132:135], v[60:63]
    s_waitcnt lgkmcnt(8)
    v_permlane32_swap_b32 v82, v94
    v_mfma_f32_16x16x32_bf16 v[96:99], a[96:99], v[136:139], v[96:99]
    s_waitcnt lgkmcnt(6)
    s_waitcnt vmcnt(14)
    ds_read_b64_tr_b16 v[128:129], v66 offset:40960
    buffer_atomic_add v27, v31, s[36:39], s14 offen offset:4 sc1
    v_mfma_f32_16x16x32_bf16 v[108:111], a[96:99], v[140:143], v[108:111]
    v_permlane32_swap_b32 v83, v95
    v_mfma_f32_16x16x32_bf16 v[100:103], a[100:103], v[136:139], v[100:103]
    ds_read_b64_tr_b16 v[130:131], v66 offset:41984
    buffer_load_dwordx4 a[56:59], v4, s[36:39], s54 offen offset:2048 sc1
    v_mfma_f32_16x16x32_bf16 v[112:115], a[100:103], v[140:143], v[112:115]
    v_mul_f32 v168, v80, v154
    v_mul_f32 v169, v81, v154
    v_mfma_f32_16x16x32_bf16 v[104:107], a[104:107], v[136:139], v[104:107]
    v_exp_f32 v168, v168
    v_mfma_f32_16x16x32_bf16 v[116:119], a[104:107], v[140:143], v[116:119]
    v_exp_f32 v169, v169
    v_mfma_f32_16x16x32_bf16 v[48:51], v[136:139], v[136:139], v[48:51]
    ds_read_b64_tr_b16 v[132:133], v70 offset:40960
    buffer_load_dwordx4 a[60:63], v4, s[36:39], s54 offen offset:3072 sc1
    v_mfma_f32_16x16x32_bf16 v[56:59], v[12:15], v[136:139], v[56:59]
    ds_read_b64_tr_b16 v[134:135], v70 offset:41984
    v_mul_f32 v80, v80, v92
    v_mfma_f32_16x16x32_bf16 v[52:55], v[140:143], v[140:143], v[52:55]
    v_mul_f32 v81, v81, v93
    v_fma_f32 v168, v168, v156, v156
    v_mfma_f32_16x16x32_bf16 v[60:63], v[12:15], v[140:143], v[60:63]
    s_waitcnt lgkmcnt(8)
    v_fma_f32 v169, v169, v156, v156
    v_mfma_f32_16x16x32_bf16 v[96:99], a[108:111], v[120:123], v[96:99]
    s_waitcnt lgkmcnt(4)
    v_rcp_f32 v168, v168
    v_mfma_f32_16x16x32_bf16 v[108:111], a[108:111], v[124:127], v[108:111]
    s_add_u32 s54, s30, 0
    ds_read_b64_tr_b16 v[136:137], v66 offset:43008
    buffer_load_dwordx4 a[64:67], v4, s[36:39], s54 offen offset:0 sc1
    v_mfma_f32_16x16x32_bf16 v[100:103], a[112:115], v[120:123], v[100:103]
    v_rcp_f32 v169, v169
    v_mfma_f32_16x16x32_bf16 v[112:115], a[112:115], v[124:127], v[112:115]
    ds_read_b64_tr_b16 v[138:139], v66 offset:44032
    v_mul_f32 v80, v80, v168
    v_mfma_f32_16x16x32_bf16 v[104:107], a[116:119], v[120:123], v[104:107]
    buffer_load_dwordx4 a[68:71], v4, s[36:39], s54 offen offset:1024 sc1
    v_mul_f32 v81, v81, v169
    v_mfma_f32_16x16x32_bf16 v[116:119], a[116:119], v[124:127], v[116:119]
    ds_read_b64_tr_b16 v[140:141], v70 offset:43008
    v_cvt_pk_bf16_f32 v164, v80, v81
    v_mfma_f32_16x16x32_bf16 v[48:51], v[120:123], v[120:123], v[48:51]
    v_mul_f32 v170, v82, v154
    v_mul_f32 v171, v83, v154
    v_mfma_f32_16x16x32_bf16 v[56:59], v[12:15], v[120:123], v[56:59]
    v_exp_f32 v170, v170
    v_mfma_f32_16x16x32_bf16 v[52:55], v[124:127], v[124:127], v[52:55]
    ds_read_b64_tr_b16 v[142:143], v70 offset:44032
    buffer_load_dwordx4 a[72:75], v4, s[36:39], s54 offen offset:2048 sc1
    v_mfma_f32_16x16x32_bf16 v[60:63], v[12:15], v[124:127], v[60:63]
    s_waitcnt lgkmcnt(6)
    v_exp_f32 v171, v171
    v_mfma_f32_16x16x32_bf16 v[96:99], a[120:123], v[128:131], v[96:99]
    s_waitcnt lgkmcnt(4)
    ds_read_b64_tr_b16 v[120:121], v66 offset:45056
    v_mul_f32 v82, v82, v94
    v_mfma_f32_16x16x32_bf16 v[108:111], a[120:123], v[132:135], v[108:111]
    ds_read_b64_tr_b16 v[122:123], v66 offset:46080
    v_mul_f32 v83, v83, v95
    v_mfma_f32_16x16x32_bf16 v[100:103], a[124:127], v[128:131], v[100:103]
    buffer_load_dwordx4 a[76:79], v4, s[36:39], s54 offen offset:3072 sc1
    v_fma_f32 v170, v170, v156, v156
    v_mfma_f32_16x16x32_bf16 v[112:115], a[124:127], v[132:135], v[112:115]
    ds_read_b64_tr_b16 v[124:125], v70 offset:45056
    v_fma_f32 v171, v171, v156, v156
    v_mfma_f32_16x16x32_bf16 v[104:107], a[128:131], v[128:131], v[104:107]
    v_rcp_f32 v170, v170
    v_mfma_f32_16x16x32_bf16 v[116:119], a[128:131], v[132:135], v[116:119]
    s_waitcnt lgkmcnt(5)
    v_rcp_f32 v171, v171
    v_mfma_f32_16x16x32_bf16 v[96:99], a[132:135], v[136:139], v[96:99]
    s_waitcnt lgkmcnt(3)
    ds_read_b64_tr_b16 v[126:127], v70 offset:46080
    v_mul_f32 v82, v82, v170
    v_mfma_f32_16x16x32_bf16 v[108:111], a[132:135], v[140:143], v[108:111]
    s_add_u32 s54, s31, 0
    ds_read_b64_tr_b16 v[128:129], v66 offset:47104
    buffer_load_dwordx4 a[80:83], v4, s[36:39], s54 offen offset:0 sc1
    v_mfma_f32_16x16x32_bf16 v[100:103], a[136:139], v[136:139], v[100:103]
    ds_read_b64_tr_b16 v[130:131], v66 offset:48128
    v_mul_f32 v83, v83, v171
    v_mfma_f32_16x16x32_bf16 v[112:115], a[136:139], v[140:143], v[112:115]
    ds_read_b64_tr_b16 v[132:133], v70 offset:47104
    v_cvt_pk_bf16_f32 v165, v82, v83
    v_mfma_f32_16x16x32_bf16 v[104:107], a[140:143], v[136:139], v[104:107]
    ds_read_b64_tr_b16 v[134:135], v70 offset:48128
    buffer_load_dwordx4 a[84:87], v4, s[36:39], s54 offen offset:1024 sc1
    v_mfma_f32_16x16x32_bf16 v[116:119], a[140:143], v[140:143], v[116:119]
    s_waitcnt lgkmcnt(6)
    v_mul_f32 v168, v72, v154
    v_mul_f32 v169, v73, v154
    v_mfma_f32_16x16x32_bf16 v[96:99], a[144:147], v[120:123], v[96:99]
    s_waitcnt lgkmcnt(4)
    v_permlane16_swap_b32 v164, v166
    v_mfma_f32_16x16x32_bf16 v[108:111], a[144:147], v[124:127], v[108:111]
    ds_read_b64_tr_b16 v[136:137], v66 offset:49152
    ds_read_b64_tr_b16 v[138:139], v66 offset:50176
    v_mfma_f32_16x16x32_bf16 v[100:103], a[148:151], v[120:123], v[100:103]
    ds_read_b64_tr_b16 v[140:141], v70 offset:49152
    buffer_load_dwordx4 a[88:91], v4, s[36:39], s54 offen offset:2048 sc1
    v_mfma_f32_16x16x32_bf16 v[112:115], a[148:151], v[124:127], v[112:115]
    v_permlane16_swap_b32 v165, v167
    v_mfma_f32_16x16x32_bf16 v[104:107], a[152:155], v[120:123], v[104:107]
    s_add_u32 s55, s10, 3145728
    ds_read_b64_tr_b16 v[142:143], v70 offset:50176
    buffer_store_dwordx4 v[164:167], v159, s[36:39], s55 offen offset:512 sc1
    v_mfma_f32_16x16x32_bf16 v[116:119], a[152:155], v[124:127], v[116:119]
    s_waitcnt lgkmcnt(6)
    v_exp_f32 v168, v168
    v_mfma_f32_16x16x32_bf16 v[96:99], a[156:159], v[128:131], v[96:99]
    s_waitcnt lgkmcnt(4)
    ds_read_b64_tr_b16 v[120:121], v67 offset:40960
    buffer_load_dwordx4 a[92:95], v4, s[36:39], s54 offen offset:3072 sc1
    v_mfma_f32_16x16x32_bf16 v[108:111], a[156:159], v[132:135], v[108:111]
    v_exp_f32 v169, v169
    v_mfma_f32_16x16x32_bf16 v[100:103], a[160:163], v[128:131], v[100:103]
    ds_read_b64_tr_b16 v[122:123], v67 offset:41984
    v_mul_f32 v72, v72, v84
    v_mfma_f32_16x16x32_bf16 v[112:115], a[160:163], v[132:135], v[112:115]
    ds_read_b64_tr_b16 v[124:125], v71 offset:40960
    v_mul_f32 v73, v73, v85
    v_mfma_f32_16x16x32_bf16 v[104:107], a[164:167], v[128:131], v[104:107]
    ds_read_b64_tr_b16 v[126:127], v71 offset:41984
    buffer_load_dwordx4 a[96:99], v17, s[36:39], s58 offen sc1
    v_mfma_f32_16x16x32_bf16 v[116:119], a[164:167], v[132:135], v[116:119]
    s_waitcnt lgkmcnt(6)
    v_fma_f32 v168, v168, v156, v156
    v_fma_f32 v169, v169, v156, v156
    v_mfma_f32_16x16x32_bf16 v[96:99], a[168:171], v[136:139], v[96:99]
    s_waitcnt lgkmcnt(4)
    ds_read_b64_tr_b16 v[128:129], v67 offset:43008
    v_mov_b32 v43, 0
    v_mfma_f32_16x16x32_bf16 v[108:111], a[168:171], v[140:143], v[108:111]
    ds_read_b64_tr_b16 v[130:131], v67 offset:44032
    buffer_atomic_add v43, v31, s[36:39], s18 offen offset:4 sc0 sc1
    v_mfma_f32_16x16x32_bf16 v[100:103], a[172:175], v[136:139], v[100:103]
    ds_read_b64_tr_b16 v[132:133], v71 offset:43008
    buffer_load_dwordx4 a[100:103], v18, s[36:39], s58 offen sc1
    v_mfma_f32_16x16x32_bf16 v[112:115], a[172:175], v[140:143], v[112:115]
    v_rcp_f32 v168, v168
    v_mfma_f32_16x16x32_bf16 v[104:107], a[176:179], v[136:139], v[104:107]
    v_rcp_f32 v169, v169
    v_mfma_f32_16x16x32_bf16 v[116:119], a[176:179], v[140:143], v[116:119]
    s_waitcnt lgkmcnt(5)
    ds_read_b64_tr_b16 v[134:135], v71 offset:44032
    v_mul_f32 v72, v72, v168
    v_mfma_f32_16x16x32_bf16 v[96:99], a[180:183], v[120:123], v[96:99]
    s_waitcnt lgkmcnt(4)
    ds_read_b64_tr_b16 v[136:137], v67 offset:45056
    buffer_load_dwordx4 a[104:107], v19, s[36:39], s58 offen sc1
    v_mfma_f32_16x16x32_bf16 v[108:111], a[180:183], v[124:127], v[108:111]
    ds_read_b64_tr_b16 v[138:139], v67 offset:46080
    v_mul_f32 v73, v73, v169
    v_mfma_f32_16x16x32_bf16 v[100:103], a[184:187], v[120:123], v[100:103]
    v_cvt_pk_bf16_f32 v160, v72, v73
    v_mul_f32 v170, v74, v154
    v_mfma_f32_16x16x32_bf16 v[112:115], a[184:187], v[124:127], v[112:115]
    ds_read_b64_tr_b16 v[140:141], v71 offset:45056
    v_mul_f32 v171, v75, v154
    v_mfma_f32_16x16x32_bf16 v[104:107], a[188:191], v[120:123], v[104:107]
    ds_read_b64_tr_b16 v[142:143], v71 offset:46080
    buffer_load_dwordx4 a[108:111], v20, s[36:39], s58 offen sc1
    v_mfma_f32_16x16x32_bf16 v[116:119], a[188:191], v[124:127], v[116:119]
    s_waitcnt lgkmcnt(6)
    v_exp_f32 v170, v170
    v_mfma_f32_16x16x32_bf16 v[96:99], a[192:195], v[128:131], v[96:99]
    s_waitcnt lgkmcnt(4)
    v_exp_f32 v171, v171
    v_mfma_f32_16x16x32_bf16 v[108:111], a[192:195], v[132:135], v[108:111]
    ds_read_b64_tr_b16 v[120:121], v67 offset:47104
    v_mul_f32 v74, v74, v86
    v_mfma_f32_16x16x32_bf16 v[100:103], a[196:199], v[128:131], v[100:103]
Lwarm3_2:
    s_cbranch_execz Lwarm3_3
    s_add_u32 s58, s28, 15360
    ds_read_b64_tr_b16 v[122:123], v67 offset:48128
    buffer_load_dwordx4 a[112:115], v16, s[36:39], s58 offen sc1
    v_mfma_f32_16x16x32_bf16 v[112:115], a[196:199], v[132:135], v[112:115]
    ds_read_b64_tr_b16 v[124:125], v71 offset:47104
    v_cndmask_b32 v57, v48, v49, s[20:21]
    v_mfma_f32_16x16x32_bf16 v[104:107], a[200:203], v[128:131], v[104:107]
    ds_read_b64_tr_b16 v[126:127], v71 offset:48128
    v_cndmask_b32 v61, v52, v53, s[20:21]
    v_mfma_f32_16x16x32_bf16 v[116:119], a[200:203], v[132:135], v[116:119]
    s_waitcnt lgkmcnt(6)
    v_cndmask_b32 v57, v57, v50, s[22:23]
    v_cndmask_b32 v61, v61, v54, s[22:23]
    v_mfma_f32_16x16x32_bf16 v[96:99], a[204:207], v[136:139], v[96:99]
    s_waitcnt lgkmcnt(4)
    ds_read_b64_tr_b16 v[128:129], v67 offset:49152
    v_cndmask_b32 v57, v57, v51, s[24:25]
    v_mfma_f32_16x16x32_bf16 v[108:111], a[204:207], v[140:143], v[108:111]
    ds_read_b64_tr_b16 v[130:131], v67 offset:50176
    v_cndmask_b32 v61, v61, v55, s[24:25]
    v_mfma_f32_16x16x32_bf16 v[100:103], a[208:211], v[136:139], v[100:103]
    ds_write2_b64 v29, v[56:57], v[60:61] offset0:0 offset1:1
    buffer_load_dwordx4 a[116:119], v17, s[36:39], s58 offen sc1
    v_mfma_f32_16x16x32_bf16 v[112:115], a[208:211], v[140:143], v[112:115]
    ds_read_b64_tr_b16 v[132:133], v71 offset:49152
    v_mul_f32 v75, v75, v87
    v_mfma_f32_16x16x32_bf16 v[104:107], a[212:215], v[136:139], v[104:107]
    ds_read_b64_tr_b16 v[134:135], v71 offset:50176
    buffer_load_dwordx4 a[120:123], v18, s[36:39], s58 offen sc1
    v_mfma_f32_16x16x32_bf16 v[116:119], a[212:215], v[140:143], v[116:119]
    s_waitcnt lgkmcnt(7)
    v_fma_f32 v170, v170, v156, v156
    v_fma_f32 v171, v171, v156, v156
    v_mfma_f32_16x16x32_bf16 v[96:99], a[216:219], v[120:123], v[96:99]
    s_waitcnt lgkmcnt(5)
    v_rcp_f32 v170, v170
    v_mfma_f32_16x16x32_bf16 v[108:111], a[216:219], v[124:127], v[108:111]
    s_waitcnt lgkmcnt(0)
    s_barrier
    v_rcp_f32 v171, v171
    v_mfma_f32_16x16x32_bf16 v[100:103], a[220:223], v[120:123], v[100:103]
    buffer_load_dwordx4 a[124:127], v19, s[36:39], s58 offen sc1
    v_mul_f32 v74, v74, v170
    v_mfma_f32_16x16x32_bf16 v[112:115], a[220:223], v[124:127], v[112:115]
    v_mul_f32 v75, v75, v171
    v_cvt_pk_bf16_f32 v161, v74, v75
    v_mfma_f32_16x16x32_bf16 v[104:107], a[224:227], v[120:123], v[104:107]
    v_mul_f32 v168, v76, v154
    v_mul_f32 v169, v77, v154
    v_mfma_f32_16x16x32_bf16 v[116:119], a[224:227], v[124:127], v[116:119]
    v_exp_f32 v168, v168
    v_mfma_f32_16x16x32_bf16 v[96:99], a[228:231], v[128:131], v[96:99]
    buffer_load_dwordx4 a[128:131], v20, s[36:39], s58 offen sc1
    v_mfma_f32_16x16x32_bf16 v[108:111], a[228:231], v[132:135], v[108:111]
    v_exp_f32 v169, v169
    v_mul_f32 v76, v76, v88
    v_mul_f32 v77, v77, v89
    v_fma_f32 v168, v168, v156, v156
    v_fma_f32 v169, v169, v156, v156
    v_rcp_f32 v168, v168
    v_rcp_f32 v169, v169
    v_mul_f32 v76, v76, v168
    v_mul_f32 v77, v77, v169
    v_cvt_pk_bf16_f32 v162, v76, v77
    v_mul_f32 v170, v78, v154
    v_mul_f32 v171, v79, v154
    v_exp_f32 v170, v170
    v_exp_f32 v171, v171
    v_mul_f32 v78, v78, v90
    v_mul_f32 v79, v79, v91
    v_fma_f32 v170, v170, v156, v156
    v_fma_f32 v171, v171, v156, v156
    v_rcp_f32 v170, v170
    v_rcp_f32 v171, v171
    v_mul_f32 v78, v78, v170
    v_mul_f32 v79, v79, v171
    v_cvt_pk_bf16_f32 v163, v78, v79
    buffer_store_dwordx4 v[160:163], v158, s[36:39], s55 offen sc1
    v_mfma_f32_16x16x32_bf16 v[100:103], a[232:235], v[128:131], v[100:103]
    ds_read2st64_b64 v[144:147], v42 offset0:8 offset1:10
    ds_read2st64_b64 v[148:151], v42 offset0:12 offset1:14
    v_mfma_f32_16x16x32_bf16 v[112:115], a[232:235], v[132:135], v[112:115]
    v_lshlrev_b32 v48, 16, v32
    v_and_b32 v49, 0xffff0000, v32
    v_mfma_f32_16x16x32_bf16 v[104:107], a[236:239], v[128:131], v[104:107]
    v_lshlrev_b32 v50, 16, v33
    v_and_b32 v51, 0xffff0000, v33
    v_mfma_f32_16x16x32_bf16 v[116:119], a[236:239], v[132:135], v[116:119]
    v_perm_b32 v64, v172, v172, s59
    v_and_b32 v65, s60, v172
    v_perm_b32 v66, v173, v173, s59
    v_and_b32 v67, s60, v173
    s_waitcnt vmcnt(24)
    v_mfma_f32_16x16x32_bf16 v[52:55], v[196:199], a[48:51], 0
    s_waitcnt vmcnt(23)
    s_add_u32 s50, s44, 16
    s_waitcnt vmcnt(9)
    v_cmp_ne_u32 vcc, s50, v43
    s_nop 0
    s_and_b64 vcc, vcc, 0x1
    s_cbranch_scc1 Lslow38
Lgot39:
    ds_read_b128 a[132:135], v10 offset:0
    ds_read_b128 a[136:139], v10 offset:1024
    s_add_u32 s54, s29, 1572864
    buffer_load_dwordx4 v[72:75], v4, s[36:39], s54 offen offset:0 sc1
    v_mfma_f32_16x16x32_bf16 v[52:55], v[216:219], a[52:55], v[52:55]
    ds_read_b128 a[140:143], v10 offset:2048
    ds_read_b128 a[144:147], v10 offset:3072
    s_waitcnt lgkmcnt(5)
    v_add_f32 v144, v144, v146
    v_add_f32 v145, v145, v147
    s_waitcnt lgkmcnt(4)
    v_add_f32 v148, v148, v150
    v_mfma_f32_16x16x32_bf16 v[52:55], v[236:239], a[56:59], v[52:55]
    ds_read_b128 a[148:151], v10 offset:4096
    ds_read_b128 a[152:155], v10 offset:5120
    v_add_f32 v149, v149, v151
    v_add_f32 v144, v144, v148
    v_add_f32 v145, v145, v149
    v_mfma_f32_16x16x32_bf16 v[56:59], v[200:203], a[48:51], 0
    ds_read_b128 a[156:159], v10 offset:6144
    ds_read_b128 a[160:163], v10 offset:7168
    v_mul_f32 v144, 986500301, v144
    v_mul_f32 v145, 986500301, v145
    v_cvt_pk_bf16_f32 v152, 0, v144
    v_mfma_f32_16x16x32_bf16 v[56:59], v[220:223], a[52:55], v[56:59]
    ds_read_b128 a[164:167], v10 offset:8192
    ds_read_b128 a[168:171], v10 offset:9216
    buffer_load_dwordx4 v[76:79], v4, s[36:39], s54 offen offset:1024 sc1
    v_cvt_pk_bf16_f32 v153, 0, v144
    v_fma_f32 v145, -v144, v144, v145
    v_mfma_f32_16x16x32_bf16 v[56:59], v[240:243], a[56:59], v[56:59]
    ds_read_b128 a[172:175], v10 offset:10240
    ds_read_b128 a[176:179], v10 offset:11264
    ds_read_b128 a[180:183], v10 offset:12288
    ds_read_b128 a[184:187], v10 offset:13312
    v_max_f32 v145, 0, v145
    v_mfma_f32_16x16x32_bf16 v[60:63], v[204:207], a[48:51], 0
    v_permlane32_swap_b32 v152, v153
    v_cvt_pk_bf16_f32 v145, 0, v145
    v_add_f32 v145, 0x3727c5ac, v145
    v_cvt_pk_bf16_f32 v145, 0, v145
    v_mfma_f32_16x16x32_bf16 v[60:63], v[224:227], a[52:55], v[60:63]
    ds_read_b128 a[188:191], v10 offset:14336
    ds_read_b128 a[192:195], v10 offset:15360
    ds_read_b128 a[196:199], v10 offset:16384
    ds_read_b128 a[200:203], v10 offset:17408
    v_mfma_f32_16x16x32_bf16 v[60:63], v[244:247], a[56:59], v[60:63]
    buffer_load_dwordx4 v[80:83], v4, s[36:39], s54 offen offset:2048 sc1
    v_sqrt_f32 v145, v145
    v_fma_f32 v96, -v180, v152, v96
    v_fma_f32 v108, -v180, v153, v108
    v_mfma_f32_16x16x32_bf16 v[48:51], v[192:195], a[48:51], v[48:51]
    v_cvt_pk_bf16_f32 v145, 0, v145
    v_fma_f32 v97, -v181, v152, v97
    v_rcp_f32 v154, v145
    v_mul_f32 v156, v145, v145
    v_mfma_f32_16x16x32_bf16 v[48:51], v[212:215], a[52:55], v[48:51]
    v_fma_f32 v109, -v181, v153, v109
    v_mul_f32 v154, 0xbfb8aa3b, v154
    v_fma_f32 v98, -v182, v152, v98
    v_fma_f32 v110, -v182, v153, v110
    v_fma_f32 v99, -v183, v152, v99
    v_mfma_f32_16x16x32_bf16 v[48:51], v[232:235], a[56:59], v[48:51]
    v_fma_f32 v111, -v183, v153, v111
    v_fma_f32 v100, -v184, v152, v100
    v_fma_f32 v112, -v184, v153, v112
    v_fma_f32 v101, -v185, v152, v101
    v_fma_f32 v113, -v185, v153, v113
    v_mfma_f32_16x16x32_bf16 v[64:67], v[208:211], a[48:51], v[64:67]
    buffer_load_dwordx4 v[84:87], v4, s[36:39], s54 offen offset:3072 sc1
    v_fma_f32 v102, -v186, v152, v102
    v_fma_f32 v114, -v186, v153, v114
    v_fma_f32 v103, -v187, v152, v103
    v_fma_f32 v115, -v187, v153, v115
    v_mfma_f32_16x16x32_bf16 v[64:67], v[228:231], a[52:55], v[64:67]
    v_fma_f32 v104, -v188, v152, v104
    v_fma_f32 v116, -v188, v153, v116
    v_fma_f32 v105, -v189, v152, v105
    v_fma_f32 v117, -v189, v153, v117
    v_fma_f32 v106, -v190, v152, v106
    v_mfma_f32_16x16x32_bf16 v[64:67], v[248:251], a[56:59], v[64:67]
    v_fma_f32 v118, -v190, v153, v118
    v_fma_f32 v107, -v191, v152, v107
    v_fma_f32 v119, -v191, v153, v119
    v_permlane32_swap_b32 v96, v108
    v_mfma_f32_16x16x32_bf16 v[52:55], a[240:243], a[60:63], v[52:55]
    s_waitcnt lgkmcnt(15)
    v_permlane32_swap_b32 v97, v109
    v_permlane32_swap_b32 v98, v110
    v_mfma_f32_16x16x32_bf16 v[52:55], a[132:135], a[64:67], v[52:55]
    s_waitcnt lgkmcnt(12)
    v_permlane32_swap_b32 v99, v111
    v_permlane32_swap_b32 v100, v112
    v_mfma_f32_16x16x32_bf16 v[52:55], a[152:155], a[68:71], v[52:55]
    s_add_u32 s54, s30, 1572864
    buffer_load_dwordx4 v[88:91], v4, s[36:39], s54 offen offset:0 sc1
    v_permlane32_swap_b32 v101, v113
    v_permlane32_swap_b32 v102, v114
    v_mfma_f32_16x16x32_bf16 v[56:59], a[244:247], a[60:63], v[56:59]
    v_permlane32_swap_b32 v103, v115
    v_permlane32_swap_b32 v104, v116
    v_mfma_f32_16x16x32_bf16 v[56:59], a[136:139], a[64:67], v[56:59]
    s_waitcnt lgkmcnt(11)
    v_permlane32_swap_b32 v105, v117
    v_permlane32_swap_b32 v106, v118
    v_mfma_f32_16x16x32_bf16 v[56:59], a[156:159], a[68:71], v[56:59]
    buffer_load_dwordx4 v[92:95], v4, s[36:39], s54 offen offset:1024 sc1
    v_permlane32_swap_b32 v107, v119
    v_mul_f32 v168, v104, v154
    v_mul_f32 v169, v105, v154
    v_mfma_f32_16x16x32_bf16 v[60:63], a[248:251], a[60:63], v[60:63]
    v_exp_f32 v168, v168
    v_exp_f32 v169, v169
    v_mul_f32 v104, v104, v116
    v_mfma_f32_16x16x32_bf16 v[60:63], a[140:143], a[64:67], v[60:63]
    s_waitcnt lgkmcnt(10)
    s_waitcnt vmcnt(6)
    buffer_atomic_add v27, v31, s[36:39], s14 offen offset:8 sc1
    v_mul_f32 v105, v105, v117
    v_fma_f32 v168, v168, v156, v156
    v_fma_f32 v169, v169, v156, v156
    v_mfma_f32_16x16x32_bf16 v[60:63], a[160:163], a[68:71], v[60:63]
    v_rcp_f32 v168, v168
    v_rcp_f32 v169, v169
    v_mul_f32 v104, v104, v168
    v_mfma_f32_16x16x32_bf16 v[48:51], v[252:255], a[60:63], v[48:51]
    buffer_load_dwordx4 v[120:123], v4, s[36:39], s54 offen offset:2048 sc1
    v_mul_f32 v105, v105, v169
    v_cvt_pk_bf16_f32 v164, v104, v105
    v_mul_f32 v170, v106, v154
    v_mul_f32 v171, v107, v154
    v_mfma_f32_16x16x32_bf16 v[48:51], v[44:47], a[64:67], v[48:51]
    v_exp_f32 v170, v170
    v_exp_f32 v171, v171
    v_mul_f32 v106, v106, v118
    v_mfma_f32_16x16x32_bf16 v[48:51], a[148:151], a[68:71], v[48:51]
    v_mul_f32 v107, v107, v119
    v_fma_f32 v170, v170, v156, v156
    v_fma_f32 v171, v171, v156, v156
    v_rcp_f32 v170, v170
    v_mfma_f32_16x16x32_bf16 v[64:67], a[252:255], a[60:63], v[64:67]
    v_rcp_f32 v171, v171
    v_mul_f32 v106, v106, v170
    v_mul_f32 v107, v107, v171
    v_cvt_pk_bf16_f32 v165, v106, v107
    v_mfma_f32_16x16x32_bf16 v[64:67], a[144:147], a[64:67], v[64:67]
    s_waitcnt lgkmcnt(9)
    buffer_load_dwordx4 v[124:127], v4, s[36:39], s54 offen offset:3072 sc1
    v_mul_f32 v168, v96, v154
    v_mul_f32 v169, v97, v154
    v_permlane16_swap_b32 v164, v166
    v_mfma_f32_16x16x32_bf16 v[64:67], a[164:167], a[68:71], v[64:67]
    s_waitcnt lgkmcnt(7)
    v_permlane16_swap_b32 v165, v167
    s_add_u32 s55, s10, 4718592
    v_mfma_f32_16x16x32_bf16 v[52:55], a[172:175], a[72:75], v[52:55]
    s_waitcnt lgkmcnt(2)
    buffer_store_dwordx4 v[164:167], v159, s[36:39], s55 offen offset:512 sc1
    v_exp_f32 v168, v168
    v_exp_f32 v169, v169
    v_mfma_f32_16x16x32_bf16 v[52:55], a[192:195], a[76:79], v[52:55]
    v_mul_f32 v96, v96, v108
    v_mul_f32 v97, v97, v109
    v_fma_f32 v168, v168, v156, v156
    v_fma_f32 v169, v169, v156, v156
    v_mfma_f32_16x16x32_bf16 v[52:55], a[8:11], a[80:83], v[52:55]
    s_add_u32 s54, s31, 1572864
    buffer_load_dwordx4 v[128:131], v4, s[36:39], s54 offen offset:0 sc1
    v_rcp_f32 v168, v168
    v_rcp_f32 v169, v169
    v_mfma_f32_16x16x32_bf16 v[56:59], a[176:179], a[72:75], v[56:59]
    s_waitcnt lgkmcnt(1)
    v_mul_f32 v96, v96, v168
    v_mul_f32 v97, v97, v169
    v_cvt_pk_bf16_f32 v160, v96, v97
    v_mul_f32 v170, v98, v154
    v_mul_f32 v171, v99, v154
    v_mfma_f32_16x16x32_bf16 v[56:59], a[196:199], a[76:79], v[56:59]
    v_exp_f32 v170, v170
    v_exp_f32 v171, v171
    v_mul_f32 v98, v98, v110
    v_mfma_f32_16x16x32_bf16 v[56:59], a[12:15], a[80:83], v[56:59]
    v_mul_f32 v99, v99, v111
    v_fma_f32 v170, v170, v156, v156
    v_fma_f32 v171, v171, v156, v156
    v_rcp_f32 v170, v170
    v_mfma_f32_16x16x32_bf16 v[60:63], a[180:183], a[72:75], v[60:63]
    s_waitcnt lgkmcnt(0)
    buffer_load_dwordx4 v[132:135], v4, s[36:39], s54 offen offset:1024 sc1
    v_rcp_f32 v171, v171
    v_mul_f32 v98, v98, v170
    v_mul_f32 v99, v99, v171
    v_mfma_f32_16x16x32_bf16 v[60:63], a[200:203], a[76:79], v[60:63]
    v_cvt_pk_bf16_f32 v161, v98, v99
    v_mul_f32 v168, v100, v154
    v_mul_f32 v169, v101, v154
    v_exp_f32 v168, v168
    v_mfma_f32_16x16x32_bf16 v[60:63], a[16:19], a[80:83], v[60:63]
    v_exp_f32 v169, v169
    v_mul_f32 v100, v100, v112
    v_mul_f32 v101, v101, v113
    v_fma_f32 v168, v168, v156, v156
    v_mfma_f32_16x16x32_bf16 v[48:51], a[168:171], a[72:75], v[48:51]
    v_fma_f32 v169, v169, v156, v156
    v_rcp_f32 v168, v168
    v_rcp_f32 v169, v169
    v_mfma_f32_16x16x32_bf16 v[48:51], a[188:191], a[76:79], v[48:51]
    buffer_load_dwordx4 v[136:139], v4, s[36:39], s54 offen offset:2048 sc1
    v_mul_f32 v100, v100, v168
    v_mul_f32 v101, v101, v169
    v_cvt_pk_bf16_f32 v162, v100, v101
    v_mul_f32 v170, v102, v154
    v_mfma_f32_16x16x32_bf16 v[48:51], a[4:7], a[80:83], v[48:51]
    v_mul_f32 v171, v103, v154
    v_exp_f32 v170, v170
    v_exp_f32 v171, v171
    v_mfma_f32_16x16x32_bf16 v[64:67], a[184:187], a[72:75], v[64:67]
    v_mul_f32 v102, v102, v114
    v_mul_f32 v103, v103, v115
    v_fma_f32 v170, v170, v156, v156
    v_fma_f32 v171, v171, v156, v156
    v_mfma_f32_16x16x32_bf16 v[64:67], a[0:3], a[76:79], v[64:67]
Lwarm3_3:
    s_cbranch_execz Lwarm3_4
    v_rcp_f32 v170, v170
    v_rcp_f32 v171, v171
    v_mul_f32 v102, v102, v170
    v_mfma_f32_16x16x32_bf16 v[64:67], a[20:23], a[80:83], v[64:67]
    buffer_load_dwordx4 v[140:143], v4, s[36:39], s54 offen offset:3072 sc1
    v_mul_f32 v103, v103, v171
    v_cvt_pk_bf16_f32 v163, v102, v103
    v_mfma_f32_16x16x32_bf16 v[52:55], a[28:31], a[84:87], v[52:55]
    buffer_store_dwordx4 v[160:163], v158, s[36:39], s55 offen sc1
    v_mfma_f32_16x16x32_bf16 v[52:55], a[96:99], a[88:91], v[52:55]
    v_mov_b32 v43, 0
    v_mfma_f32_16x16x32_bf16 v[52:55], a[116:119], a[92:95], v[52:55]
    buffer_atomic_add v43, v31, s[36:39], s18 offen offset:8 sc0 sc1
    v_mfma_f32_16x16x32_bf16 v[56:59], a[32:35], a[84:87], v[56:59]
    s_xor_b32 s57, s45, 0
    s_lshl_b32 s57, s57, 6
    s_sub_u32 s57, s57, 256
    v_add_u32 v12, s57, v22
    s_xor_b32 s57, s45, 1
    s_lshl_b32 s57, s57, 6
    v_mfma_f32_16x16x32_bf16 v[56:59], a[100:103], a[88:91], v[56:59]
    s_sub_u32 s57, s57, 256
    v_add_u32 v13, s57, v22
    s_xor_b32 s57, s45, 2
    s_lshl_b32 s57, s57, 6
    s_sub_u32 s57, s57, 256
    v_add_u32 v14, s57, v22
    v_mfma_f32_16x16x32_bf16 v[56:59], a[120:123], a[92:95], v[56:59]
    s_xor_b32 s57, s45, 3
    s_lshl_b32 s57, s57, 6
    s_sub_u32 s57, s57, 256
    v_add_u32 v15, s57, v22
    v_lshlrev_b32 v96, 16, v34
    v_and_b32 v97, 0xffff0000, v34
    v_mfma_f32_16x16x32_bf16 v[60:63], a[36:39], a[84:87], v[60:63]
    v_lshlrev_b32 v98, 16, v35
    v_and_b32 v99, 0xffff0000, v35
    v_perm_b32 v112, v174, v174, s59
    v_and_b32 v113, s60, v174
    v_perm_b32 v114, v175, v175, s59
    v_mfma_f32_16x16x32_bf16 v[60:63], a[104:107], a[88:91], v[60:63]
    v_and_b32 v115, s60, v175
    v_mfma_f32_16x16x32_bf16 v[60:63], a[124:127], a[92:95], v[60:63]
    v_mfma_f32_16x16x32_bf16 v[48:51], a[24:27], a[84:87], v[48:51]
    v_mfma_f32_16x16x32_bf16 v[48:51], a[44:47], a[88:91], v[48:51]
    v_mfma_f32_16x16x32_bf16 v[48:51], a[112:115], a[92:95], v[48:51]
    v_mfma_f32_16x16x32_bf16 v[64:67], a[40:43], a[84:87], v[64:67]
    v_mfma_f32_16x16x32_bf16 v[64:67], a[108:111], a[88:91], v[64:67]
    v_mfma_f32_16x16x32_bf16 v[64:67], a[128:131], a[92:95], v[64:67]
    s_waitcnt vmcnt(15)
    v_mfma_f32_16x16x32_bf16 v[100:103], v[196:199], v[72:75], 0
    s_waitcnt vmcnt(14)
    v_mfma_f32_16x16x32_bf16 v[100:103], v[216:219], v[76:79], v[100:103]
    s_waitcnt vmcnt(13)
    ds_write_b128 v13, v[52:55] offset:0
    v_mfma_f32_16x16x32_bf16 v[100:103], v[236:239], v[80:83], v[100:103]
    v_mfma_f32_16x16x32_bf16 v[104:107], v[200:203], v[72:75], 0
    v_mfma_f32_16x16x32_bf16 v[104:107], v[220:223], v[76:79], v[104:107]
    v_mfma_f32_16x16x32_bf16 v[104:107], v[240:243], v[80:83], v[104:107]
    ds_write_b128 v14, v[56:59] offset:0
    v_mfma_f32_16x16x32_bf16 v[108:111], v[204:207], v[72:75], 0
    v_mfma_f32_16x16x32_bf16 v[108:111], v[224:227], v[76:79], v[108:111]
    v_mfma_f32_16x16x32_bf16 v[108:111], v[244:247], v[80:83], v[108:111]
    s_waitcnt vmcnt(1)
    buffer_atomic_add v27, v31, s[36:39], s14 offen offset:12 sc1
    v_mfma_f32_16x16x32_bf16 v[96:99], v[192:195], v[72:75], v[96:99]
    ds_write_b128 v15, v[60:63] offset:0
    v_mfma_f32_16x16x32_bf16 v[96:99], v[212:215], v[76:79], v[96:99]
    s_add_u32 s50, s44, 16
    s_waitcnt vmcnt(1)
    v_cmp_ne_u32 vcc, s50, v43
    s_nop 0
    s_and_b64 vcc, vcc, 0x1
    s_cbranch_scc1 Lslow41
Lgot42:
    s_add_u32 s54, s29, 3145728
    buffer_load_dwordx4 v[144:147], v4, s[36:39], s54 offen offset:0 sc1
    v_mfma_f32_16x16x32_bf16 v[96:99], v[232:235], v[80:83], v[96:99]
    v_mfma_f32_16x16x32_bf16 v[112:115], v[208:211], v[72:75], v[112:115]
    v_mfma_f32_16x16x32_bf16 v[112:115], v[228:231], v[76:79], v[112:115]
    ds_write_b128 v12, v[48:51] offset:0
    v_mfma_f32_16x16x32_bf16 v[112:115], v[248:251], v[80:83], v[112:115]
    buffer_load_dwordx4 v[148:151], v4, s[36:39], s54 offen offset:1024 sc1
    v_mfma_f32_16x16x32_bf16 v[100:103], a[240:243], v[84:87], v[100:103]
    v_mfma_f32_16x16x32_bf16 v[100:103], a[132:135], v[88:91], v[100:103]
    v_mfma_f32_16x16x32_bf16 v[100:103], a[152:155], v[92:95], v[100:103]
    ds_write_b128 v22, v[64:67] offset:0
    v_mfma_f32_16x16x32_bf16 v[104:107], a[244:247], v[84:87], v[104:107]
    buffer_load_dwordx4 v[152:155], v4, s[36:39], s54 offen offset:2048 sc1
    v_mfma_f32_16x16x32_bf16 v[104:107], a[136:139], v[88:91], v[104:107]
    v_mfma_f32_16x16x32_bf16 v[104:107], a[156:159], v[92:95], v[104:107]
    v_mfma_f32_16x16x32_bf16 v[108:111], a[248:251], v[84:87], v[108:111]
    v_mfma_f32_16x16x32_bf16 v[108:111], a[140:143], v[88:91], v[108:111]
    buffer_load_dwordx4 v[156:159], v4, s[36:39], s54 offen offset:3072 sc1
    v_mfma_f32_16x16x32_bf16 v[108:111], a[160:163], v[92:95], v[108:111]
    v_mfma_f32_16x16x32_bf16 v[96:99], v[252:255], v[84:87], v[96:99]
    v_lshlrev_b32 v48, 16, v36
    v_and_b32 v49, 0xffff0000, v36
    v_mfma_f32_16x16x32_bf16 v[96:99], v[44:47], v[88:91], v[96:99]
    v_lshlrev_b32 v50, 16, v37
    v_and_b32 v51, 0xffff0000, v37
    v_mfma_f32_16x16x32_bf16 v[96:99], a[148:151], v[92:95], v[96:99]
    s_add_u32 s54, s30, 3145728
    buffer_load_dwordx4 v[160:163], v4, s[36:39], s54 offen offset:0 sc1
    v_perm_b32 v64, v176, v176, s59
    v_mfma_f32_16x16x32_bf16 v[112:115], a[252:255], v[84:87], v[112:115]
    v_and_b32 v65, s60, v176
    v_perm_b32 v66, v177, v177, s59
    v_mfma_f32_16x16x32_bf16 v[112:115], a[144:147], v[88:91], v[112:115]
    v_and_b32 v67, s60, v177
    v_min_u32 v24, 239, v0
    v_mfma_f32_16x16x32_bf16 v[112:115], a[164:167], v[92:95], v[112:115]
    v_mul_u32_u24 v23, 6554, v24
    v_lshrrev_b32 v23, 16, v23
    v_mfma_f32_16x16x32_bf16 v[100:103], a[172:175], v[120:123], v[100:103]
    buffer_load_dwordx4 v[164:167], v4, s[36:39], s54 offen offset:1024 sc1
    v_lshlrev_b32 v6, 5, v24
    v_mfma_f32_16x16x32_bf16 v[100:103], a[192:195], v[124:127], v[100:103]
    v_lshl_add_u32 v6, v23, 4, v6
    v_add_u32 v16, 77824, v6
    v_mfma_f32_16x16x32_bf16 v[100:103], a[8:11], v[128:131], v[100:103]
    v_add_u32 v17, 85888, v6
    v_min_u32 v6, 5328, v6
    v_mfma_f32_16x16x32_bf16 v[104:107], a[176:179], v[120:123], v[104:107]
    v_add_u32 v18, 93952, v6
    v_mul_u32_u24 v6, 10, v23
    v_mfma_f32_16x16x32_bf16 v[104:107], a[196:199], v[124:127], v[104:107]
    buffer_load_dwordx4 v[168:171], v4, s[36:39], s54 offen offset:2048 sc1
    v_sub_u32 v24, v24, v6
    v_mfma_f32_16x16x32_bf16 v[104:107], a[12:15], v[128:131], v[104:107]
    v_lshlrev_b32 v24, 4, v24
    v_add_u32 v6, 0, v23
    v_mfma_f32_16x16x32_bf16 v[108:111], a[180:183], v[120:123], v[108:111]
    v_and_b32 v19, 3, v6
    v_bfe_u32 v7, v6, 2, 1
    v_mfma_f32_16x16x32_bf16 v[108:111], a[200:203], v[124:127], v[108:111]
    v_lshl_add_u32 v19, v7, 8, v19
    v_bfe_u32 v7, v6, 3, 1
    v_mfma_f32_16x16x32_bf16 v[108:111], a[16:19], v[128:131], v[108:111]
    buffer_load_dwordx4 v[180:183], v4, s[36:39], s54 offen offset:3072 sc1
    v_lshl_add_u32 v19, v7, 4, v19
    v_mfma_f32_16x16x32_bf16 v[96:99], a[168:171], v[120:123], v[96:99]
    v_lshrrev_b32 v7, 4, v6
    v_lshl_add_u32 v19, v7, 9, v19
    v_mfma_f32_16x16x32_bf16 v[96:99], a[188:191], v[124:127], v[96:99]
    v_mul_u32_u24 v19, 1280, v19
    v_add_u32 v7, 16, v0
    v_mfma_f32_16x16x32_bf16 v[96:99], a[4:7], v[128:131], v[96:99]
    v_lshrrev_b32 v7, 8, v7
    v_lshl_add_u32 v7, v7, 30, v24
    v_mfma_f32_16x16x32_bf16 v[112:115], a[184:187], v[120:123], v[112:115]
    s_add_u32 s54, s31, 3145728
    buffer_load_dwordx4 v[184:187], v4, s[36:39], s54 offen offset:0 sc1
    v_add_u32 v19, v19, v7
    v_mfma_f32_16x16x32_bf16 v[112:115], a[0:3], v[124:127], v[112:115]
    v_add_u32 v6, 24, v23
    v_and_b32 v20, 3, v6
    v_mfma_f32_16x16x32_bf16 v[112:115], a[20:23], v[128:131], v[112:115]
    v_bfe_u32 v7, v6, 2, 1
    v_lshl_add_u32 v20, v7, 8, v20
    v_mfma_f32_16x16x32_bf16 v[100:103], a[28:31], v[132:135], v[100:103]
    v_bfe_u32 v7, v6, 3, 1
    v_lshl_add_u32 v20, v7, 4, v20
    v_mfma_f32_16x16x32_bf16 v[100:103], a[96:99], v[136:139], v[100:103]
    buffer_load_dwordx4 v[188:191], v4, s[36:39], s54 offen offset:1024 sc1
    v_lshrrev_b32 v7, 4, v6
    v_mfma_f32_16x16x32_bf16 v[100:103], a[116:119], v[140:143], v[100:103]
    v_lshl_add_u32 v20, v7, 9, v20
    v_mul_u32_u24 v20, 1280, v20
    v_mfma_f32_16x16x32_bf16 v[104:107], a[32:35], v[132:135], v[104:107]
    v_add_u32 v7, 16, v0
    v_lshrrev_b32 v7, 8, v7
    v_mfma_f32_16x16x32_bf16 v[104:107], a[100:103], v[136:139], v[104:107]
    v_lshl_add_u32 v7, v7, 30, v24
    v_add_u32 v20, v20, v7
    v_mfma_f32_16x16x32_bf16 v[104:107], a[120:123], v[140:143], v[104:107]
    buffer_load_dwordx4 v[116:119], v4, s[36:39], s54 offen offset:2048 sc1
    v_mov_b32 v43, 0
    v_mfma_f32_16x16x32_bf16 v[108:111], a[36:39], v[132:135], v[108:111]
    buffer_atomic_add v43, v31, s[36:39], s18 offen offset:12 sc0 sc1
    v_add_u32 v6, 48, v23
    v_mfma_f32_16x16x32_bf16 v[108:111], a[104:107], v[136:139], v[108:111]
    v_and_b32 v21, 3, v6
    v_bfe_u32 v7, v6, 2, 1
    v_mfma_f32_16x16x32_bf16 v[108:111], a[124:127], v[140:143], v[108:111]
    v_lshl_add_u32 v21, v7, 8, v21
    v_bfe_u32 v7, v6, 3, 1
    v_mfma_f32_16x16x32_bf16 v[96:99], a[24:27], v[132:135], v[96:99]
    buffer_load_dwordx4 v[68:71], v4, s[36:39], s54 offen offset:3072 sc1
    v_lshl_add_u32 v21, v7, 4, v21
    v_mfma_f32_16x16x32_bf16 v[96:99], a[44:47], v[136:139], v[96:99]
    v_lshrrev_b32 v7, 4, v6
    v_lshl_add_u32 v21, v7, 9, v21
    v_mfma_f32_16x16x32_bf16 v[96:99], a[112:115], v[140:143], v[96:99]
    v_mul_u32_u24 v21, 1280, v21
    v_add_u32 v7, 96, v0
    v_mfma_f32_16x16x32_bf16 v[112:115], a[40:43], v[132:135], v[112:115]
    v_lshrrev_b32 v7, 8, v7
    v_lshl_add_u32 v7, v7, 30, v24
    v_mfma_f32_16x16x32_bf16 v[112:115], a[108:111], v[136:139], v[112:115]
    v_add_u32 v21, v21, v7
    v_mfma_f32_16x16x32_bf16 v[112:115], a[128:131], v[140:143], v[112:115]
    s_waitcnt vmcnt(12)
    v_mfma_f32_16x16x32_bf16 v[52:55], v[196:199], v[144:147], 0
    s_waitcnt vmcnt(11)
    v_mfma_f32_16x16x32_bf16 v[52:55], v[216:219], v[148:151], v[52:55]
    s_waitcnt vmcnt(10)
    ds_write_b128 v13, v[100:103] offset:5376
    v_mfma_f32_16x16x32_bf16 v[52:55], v[236:239], v[152:155], v[52:55]
    v_mfma_f32_16x16x32_bf16 v[56:59], v[200:203], v[144:147], 0
    v_mfma_f32_16x16x32_bf16 v[56:59], v[220:223], v[148:151], v[56:59]
    v_mfma_f32_16x16x32_bf16 v[56:59], v[240:243], v[152:155], v[56:59]
    ds_write_b128 v14, v[104:107] offset:5376
    v_mfma_f32_16x16x32_bf16 v[60:63], v[204:207], v[144:147], 0
    v_mfma_f32_16x16x32_bf16 v[60:63], v[224:227], v[148:151], v[60:63]
    v_mfma_f32_16x16x32_bf16 v[60:63], v[244:247], v[152:155], v[60:63]
    v_mfma_f32_16x16x32_bf16 v[48:51], v[192:195], v[144:147], v[48:51]
    ds_write_b128 v15, v[108:111] offset:5376
    v_mfma_f32_16x16x32_bf16 v[48:51], v[212:215], v[148:151], v[48:51]
    v_mfma_f32_16x16x32_bf16 v[48:51], v[232:235], v[152:155], v[48:51]
    v_mfma_f32_16x16x32_bf16 v[64:67], v[208:211], v[144:147], v[64:67]
    v_mfma_f32_16x16x32_bf16 v[64:67], v[228:231], v[148:151], v[64:67]
    ds_write_b128 v12, v[96:99] offset:5376
    v_mfma_f32_16x16x32_bf16 v[64:67], v[248:251], v[152:155], v[64:67]
    s_waitcnt vmcnt(9)
    v_mfma_f32_16x16x32_bf16 v[52:55], a[240:243], v[156:159], v[52:55]
    s_waitcnt vmcnt(8)
    v_mfma_f32_16x16x32_bf16 v[52:55], a[132:135], v[160:163], v[52:55]
    s_waitcnt vmcnt(7)
    v_mfma_f32_16x16x32_bf16 v[52:55], a[152:155], v[164:167], v[52:55]
    ds_write_b128 v22, v[112:115] offset:5376
    v_mfma_f32_16x16x32_bf16 v[56:59], a[244:247], v[156:159], v[56:59]
    v_mfma_f32_16x16x32_bf16 v[56:59], a[136:139], v[160:163], v[56:59]
    v_mfma_f32_16x16x32_bf16 v[56:59], a[156:159], v[164:167], v[56:59]
    v_mfma_f32_16x16x32_bf16 v[60:63], a[248:251], v[156:159], v[60:63]
    v_mfma_f32_16x16x32_bf16 v[60:63], a[140:143], v[160:163], v[60:63]
    v_mfma_f32_16x16x32_bf16 v[60:63], a[160:163], v[164:167], v[60:63]
    v_mfma_f32_16x16x32_bf16 v[48:51], v[252:255], v[156:159], v[48:51]
    s_add_u32 s50, s44, 16
    s_waitcnt vmcnt(1)
    v_cmp_ne_u32 vcc, s50, v43
    s_nop 0
    s_and_b64 vcc, vcc, 0x1
    s_cbranch_scc1 Lslow44
Lgot45:
    v_lshlrev_b32 v96, 16, v38
    v_and_b32 v97, 0xffff0000, v38
    v_mfma_f32_16x16x32_bf16 v[48:51], v[44:47], v[160:163], v[48:51]
    s_add_u32 s54, s29, 4718592
    buffer_load_dwordx4 a[48:51], v4, s[36:39], s54 offen offset:0 sc1
    v_lshlrev_b32 v98, 16, v39
    v_mfma_f32_16x16x32_bf16 v[48:51], a[148:151], v[164:167], v[48:51]
    v_and_b32 v99, 0xffff0000, v39
    v_perm_b32 v112, v178, v178, s59
    v_mfma_f32_16x16x32_bf16 v[64:67], a[252:255], v[156:159], v[64:67]
    buffer_load_dwordx4 a[52:55], v4, s[36:39], s54 offen offset:1024 sc1
    v_and_b32 v113, s60, v178
    v_mfma_f32_16x16x32_bf16 v[64:67], a[144:147], v[160:163], v[64:67]
    v_perm_b32 v114, v179, v179, s59
    v_and_b32 v115, s60, v179
    v_mfma_f32_16x16x32_bf16 v[64:67], a[164:167], v[164:167], v[64:67]
    v_mfma_f32_16x16x32_bf16 v[52:55], a[172:175], v[168:171], v[52:55]
    buffer_load_dwordx4 a[56:59], v4, s[36:39], s54 offen offset:2048 sc1
    v_mfma_f32_16x16x32_bf16 v[52:55], a[192:195], v[180:183], v[52:55]
    v_mfma_f32_16x16x32_bf16 v[52:55], a[8:11], v[184:187], v[52:55]
    v_mfma_f32_16x16x32_bf16 v[56:59], a[176:179], v[168:171], v[56:59]
    buffer_load_dwordx4 a[60:63], v4, s[36:39], s54 offen offset:3072 sc1
    v_mfma_f32_16x16x32_bf16 v[56:59], a[196:199], v[180:183], v[56:59]
    v_mfma_f32_16x16x32_bf16 v[56:59], a[12:15], v[184:187], v[56:59]
    v_mfma_f32_16x16x32_bf16 v[60:63], a[180:183], v[168:171], v[60:63]
    s_add_u32 s54, s30, 4718592
    buffer_load_dwordx4 a[64:67], v4, s[36:39], s54 offen offset:0 sc1
    v_mfma_f32_16x16x32_bf16 v[60:63], a[200:203], v[180:183], v[60:63]
    v_mfma_f32_16x16x32_bf16 v[60:63], a[16:19], v[184:187], v[60:63]
    v_mfma_f32_16x16x32_bf16 v[48:51], a[168:171], v[168:171], v[48:51]
    buffer_load_dwordx4 a[68:71], v4, s[36:39], s54 offen offset:1024 sc1
    v_mfma_f32_16x16x32_bf16 v[48:51], a[188:191], v[180:183], v[48:51]
    v_mfma_f32_16x16x32_bf16 v[48:51], a[4:7], v[184:187], v[48:51]
    v_mfma_f32_16x16x32_bf16 v[64:67], a[184:187], v[168:171], v[64:67]
    buffer_load_dwordx4 a[72:75], v4, s[36:39], s54 offen offset:2048 sc1
    v_mfma_f32_16x16x32_bf16 v[64:67], a[0:3], v[180:183], v[64:67]
    v_mfma_f32_16x16x32_bf16 v[64:67], a[20:23], v[184:187], v[64:67]
    v_mfma_f32_16x16x32_bf16 v[52:55], a[28:31], v[188:191], v[52:55]
    buffer_load_dwordx4 a[76:79], v4, s[36:39], s54 offen offset:3072 sc1
    v_mfma_f32_16x16x32_bf16 v[52:55], a[96:99], v[116:119], v[52:55]
    s_waitcnt vmcnt(8)
    v_mfma_f32_16x16x32_bf16 v[52:55], a[116:119], v[68:71], v[52:55]
    v_mfma_f32_16x16x32_bf16 v[56:59], a[32:35], v[188:191], v[56:59]
    s_add_u32 s54, s31, 4718592
    buffer_load_dwordx4 a[80:83], v4, s[36:39], s54 offen offset:0 sc1
    v_mfma_f32_16x16x32_bf16 v[56:59], a[100:103], v[116:119], v[56:59]
    v_mfma_f32_16x16x32_bf16 v[56:59], a[120:123], v[68:71], v[56:59]
    v_mfma_f32_16x16x32_bf16 v[60:63], a[36:39], v[188:191], v[60:63]
    buffer_load_dwordx4 a[84:87], v4, s[36:39], s54 offen offset:1024 sc1
    v_mfma_f32_16x16x32_bf16 v[60:63], a[104:107], v[116:119], v[60:63]
Lwarm3_4:
    s_cbranch_execz Lwarm_ret3
    v_mfma_f32_16x16x32_bf16 v[60:63], a[124:127], v[68:71], v[60:63]
    v_mfma_f32_16x16x32_bf16 v[48:51], a[24:27], v[188:191], v[48:51]
    buffer_load_dwordx4 a[88:91], v4, s[36:39], s54 offen offset:2048 sc1
    v_mfma_f32_16x16x32_bf16 v[48:51], a[44:47], v[116:119], v[48:51]
    v_mfma_f32_16x16x32_bf16 v[48:51], a[112:115], v[68:71], v[48:51]
    v_mfma_f32_16x16x32_bf16 v[64:67], a[40:43], v[188:191], v[64:67]
    buffer_load_dwordx4 a[92:95], v4, s[36:39], s54 offen offset:3072 sc1
    v_mfma_f32_16x16x32_bf16 v[64:67], a[108:111], v[116:119], v[64:67]
    v_mfma_f32_16x16x32_bf16 v[64:67], a[128:131], v[68:71], v[64:67]
    s_waitcnt vmcnt(11)
    v_mfma_f32_16x16x32_bf16 v[100:103], v[196:199], a[48:51], 0
    s_waitcnt vmcnt(10)
    v_mfma_f32_16x16x32_bf16 v[100:103], v[216:219], a[52:55], v[100:103]
    s_waitcnt vmcnt(9)
    ds_write_b128 v13, v[52:55] offset:10752
    v_mfma_f32_16x16x32_bf16 v[100:103], v[236:239], a[56:59], v[100:103]
    v_mfma_f32_16x16x32_bf16 v[104:107], v[200:203], a[48:51], 0
    ds_write_b128 v14, v[56:59] offset:10752
    v_mfma_f32_16x16x32_bf16 v[104:107], v[220:223], a[52:55], v[104:107]
    v_mfma_f32_16x16x32_bf16 v[104:107], v[240:243], a[56:59], v[104:107]
    ds_write_b128 v15, v[60:63] offset:10752
    v_mfma_f32_16x16x32_bf16 v[108:111], v[204:207], a[48:51], 0
    v_mfma_f32_16x16x32_bf16 v[108:111], v[224:227], a[52:55], v[108:111]
    ds_write_b128 v12, v[48:51] offset:10752
    v_mfma_f32_16x16x32_bf16 v[108:111], v[244:247], a[56:59], v[108:111]
    v_mfma_f32_16x16x32_bf16 v[96:99], v[192:195], a[48:51], v[96:99]
    ds_write_b128 v22, v[64:67] offset:10752
    v_mfma_f32_16x16x32_bf16 v[96:99], v[212:215], a[52:55], v[96:99]
    v_mfma_f32_16x16x32_bf16 v[96:99], v[232:235], a[56:59], v[96:99]
    v_mfma_f32_16x16x32_bf16 v[112:115], v[208:211], a[48:51], v[112:115]
    v_mfma_f32_16x16x32_bf16 v[112:115], v[228:231], a[52:55], v[112:115]
    s_waitcnt lgkmcnt(0)
    s_barrier
    ds_read_b128 v[120:123], v16 offset:0
    ds_read_b128 v[124:127], v16 offset:16
    v_mfma_f32_16x16x32_bf16 v[112:115], v[248:251], a[56:59], v[112:115]
    s_waitcnt vmcnt(8)
    ds_read_b128 v[128:131], v16 offset:21504
    ds_read_b128 v[132:135], v16 offset:21520
    v_mfma_f32_16x16x32_bf16 v[100:103], a[240:243], a[60:63], v[100:103]
    s_waitcnt vmcnt(7)
    ds_read_b128 v[136:139], v16 offset:43008
    ds_read_b128 v[140:143], v16 offset:43024
    v_mfma_f32_16x16x32_bf16 v[100:103], a[132:135], a[64:67], v[100:103]
    s_waitcnt vmcnt(6)
    ds_read_b128 v[144:147], v16 offset:64512
    ds_read_b128 v[148:151], v16 offset:64528
    v_mfma_f32_16x16x32_bf16 v[100:103], a[152:155], a[68:71], v[100:103]
    v_mfma_f32_16x16x32_bf16 v[104:107], a[244:247], a[60:63], v[104:107]
    v_mfma_f32_16x16x32_bf16 v[104:107], a[136:139], a[64:67], v[104:107]
    v_mfma_f32_16x16x32_bf16 v[104:107], a[156:159], a[68:71], v[104:107]
    s_waitcnt lgkmcnt(5)
    v_add_f32 v120, v120, v128
    v_add_f32 v121, v121, v129
    v_mfma_f32_16x16x32_bf16 v[108:111], a[248:251], a[60:63], v[108:111]
    v_add_f32 v122, v122, v130
    v_add_f32 v123, v123, v131
    v_mfma_f32_16x16x32_bf16 v[108:111], a[140:143], a[64:67], v[108:111]
    s_waitcnt lgkmcnt(4)
    v_add_f32 v124, v124, v132
    v_add_f32 v125, v125, v133
    v_mfma_f32_16x16x32_bf16 v[108:111], a[160:163], a[68:71], v[108:111]
    v_add_f32 v126, v126, v134
    v_add_f32 v127, v127, v135
    v_mfma_f32_16x16x32_bf16 v[96:99], v[252:255], a[60:63], v[96:99]
    ds_read_b128 v[152:155], v17 offset:0
    ds_read_b128 v[156:159], v17 offset:16
    v_mfma_f32_16x16x32_bf16 v[96:99], v[44:47], a[64:67], v[96:99]
    ds_read_b128 v[160:163], v17 offset:21504
    ds_read_b128 v[164:167], v17 offset:21520
    v_mfma_f32_16x16x32_bf16 v[96:99], a[148:151], a[68:71], v[96:99]
    ds_read_b128 v[180:183], v17 offset:43008
    ds_read_b128 v[184:187], v17 offset:43024
    v_mfma_f32_16x16x32_bf16 v[112:115], a[252:255], a[60:63], v[112:115]
    ds_read_b128 v[88:91], v17 offset:64512
    ds_read_b128 v[92:95], v17 offset:64528
    v_mfma_f32_16x16x32_bf16 v[112:115], a[144:147], a[64:67], v[112:115]
    s_waitcnt lgkmcnt(9)
    v_add_f32 v136, v136, v144
    v_add_f32 v137, v137, v145
    v_mfma_f32_16x16x32_bf16 v[112:115], a[164:167], a[68:71], v[112:115]
    s_waitcnt vmcnt(5)
    v_add_f32 v138, v138, v146
    v_add_f32 v139, v139, v147
    v_mfma_f32_16x16x32_bf16 v[112:115], a[184:187], a[72:75], v[112:115]
    s_waitcnt vmcnt(4)
    s_waitcnt lgkmcnt(8)
    v_add_f32 v140, v140, v148
    v_add_f32 v141, v141, v149
    v_mfma_f32_16x16x32_bf16 v[112:115], a[0:3], a[76:79], v[112:115]
    s_waitcnt vmcnt(3)
    v_add_f32 v142, v142, v150
    v_add_f32 v143, v143, v151
    v_mfma_f32_16x16x32_bf16 v[112:115], a[20:23], a[80:83], v[112:115]
    s_waitcnt vmcnt(2)
    v_add_f32 v120, v120, v136
    v_add_f32 v121, v121, v137
    v_mfma_f32_16x16x32_bf16 v[112:115], a[40:43], a[84:87], v[112:115]
    s_waitcnt vmcnt(1)
    v_add_f32 v122, v122, v138
    v_add_f32 v123, v123, v139
    v_mfma_f32_16x16x32_bf16 v[112:115], a[108:111], a[88:91], v[112:115]
    s_waitcnt vmcnt(0)
    v_add_f32 v124, v124, v140
    v_add_f32 v125, v125, v141
    v_mfma_f32_16x16x32_bf16 v[112:115], a[128:131], a[92:95], v[112:115]
    v_add_f32 v126, v126, v142
    v_add_f32 v127, v127, v143
    v_mfma_f32_16x16x32_bf16 v[100:103], a[172:175], a[72:75], v[100:103]
    v_cvt_pk_bf16_f32 v72, v120, v121
    v_cvt_pk_bf16_f32 v73, v122, v123
    v_mfma_f32_16x16x32_bf16 v[100:103], a[192:195], a[76:79], v[100:103]
    v_cvt_pk_bf16_f32 v74, v124, v125
    v_cvt_pk_bf16_f32 v75, v126, v127
    v_mfma_f32_16x16x32_bf16 v[100:103], a[8:11], a[80:83], v[100:103]
    ds_write_b128 v22, v[112:115] offset:16128
    buffer_store_dwordx4 v[72:75], v19, s[40:43], s13 offen nt
    v_mfma_f32_16x16x32_bf16 v[100:103], a[28:31], a[84:87], v[100:103]
    s_waitcnt lgkmcnt(6)
    v_add_f32 v152, v152, v160
    v_add_f32 v153, v153, v161
    v_mfma_f32_16x16x32_bf16 v[100:103], a[96:99], a[88:91], v[100:103]
    v_add_f32 v154, v154, v162
    v_add_f32 v155, v155, v163
    v_mfma_f32_16x16x32_bf16 v[100:103], a[116:119], a[92:95], v[100:103]
    s_waitcnt lgkmcnt(5)
    v_add_f32 v156, v156, v164
    v_add_f32 v157, v157, v165
    v_mfma_f32_16x16x32_bf16 v[104:107], a[176:179], a[72:75], v[104:107]
    v_add_f32 v158, v158, v166
    v_add_f32 v159, v159, v167
    v_mfma_f32_16x16x32_bf16 v[104:107], a[196:199], a[76:79], v[104:107]
    s_waitcnt lgkmcnt(2)
    v_add_f32 v180, v180, v88
    v_add_f32 v181, v181, v89
    v_mfma_f32_16x16x32_bf16 v[104:107], a[12:15], a[80:83], v[104:107]
    ds_write_b128 v13, v[100:103] offset:16128
    v_add_f32 v182, v182, v90
    v_mfma_f32_16x16x32_bf16 v[104:107], a[32:35], a[84:87], v[104:107]
    v_add_f32 v183, v183, v91
    s_waitcnt lgkmcnt(2)
    v_add_f32 v184, v184, v92
    v_mfma_f32_16x16x32_bf16 v[104:107], a[100:103], a[88:91], v[104:107]
    v_add_f32 v185, v185, v93
    v_add_f32 v186, v186, v94
    v_mfma_f32_16x16x32_bf16 v[104:107], a[120:123], a[92:95], v[104:107]
    v_add_f32 v187, v187, v95
    v_add_f32 v152, v152, v180
    v_mfma_f32_16x16x32_bf16 v[108:111], a[180:183], a[72:75], v[108:111]
    v_add_f32 v153, v153, v181
    v_add_f32 v154, v154, v182
    v_mfma_f32_16x16x32_bf16 v[108:111], a[200:203], a[76:79], v[108:111]
    v_add_f32 v155, v155, v183
    v_add_f32 v156, v156, v184
    v_mfma_f32_16x16x32_bf16 v[108:111], a[16:19], a[80:83], v[108:111]
    ds_write_b128 v14, v[104:107] offset:16128
    v_add_f32 v157, v157, v185
    v_mfma_f32_16x16x32_bf16 v[108:111], a[36:39], a[84:87], v[108:111]
    v_add_f32 v158, v158, v186
    v_add_f32 v159, v159, v187
    v_mfma_f32_16x16x32_bf16 v[108:111], a[104:107], a[88:91], v[108:111]
    v_cvt_pk_bf16_f32 v76, v152, v153
    v_cvt_pk_bf16_f32 v77, v154, v155
    v_mfma_f32_16x16x32_bf16 v[108:111], a[124:127], a[92:95], v[108:111]
    v_cvt_pk_bf16_f32 v78, v156, v157
    v_cvt_pk_bf16_f32 v79, v158, v159
    v_mfma_f32_16x16x32_bf16 v[96:99], a[168:171], a[72:75], v[96:99]
    buffer_store_dwordx4 v[76:79], v20, s[40:43], s13 offen nt
    v_mfma_f32_16x16x32_bf16 v[96:99], a[188:191], a[76:79], v[96:99]
    v_mfma_f32_16x16x32_bf16 v[96:99], a[4:7], a[80:83], v[96:99]
    s_nop 1
    ds_write_b128 v15, v[108:111] offset:16128
    v_mfma_f32_16x16x32_bf16 v[96:99], a[24:27], a[84:87], v[96:99]
    v_mfma_f32_16x16x32_bf16 v[96:99], a[44:47], a[88:91], v[96:99]
    v_mfma_f32_16x16x32_bf16 v[96:99], a[112:115], a[92:95], v[96:99]
    s_nop 7
    ds_write_b128 v12, v[96:99] offset:16128
    s_waitcnt lgkmcnt(0)
    s_barrier
    ds_read_b128 v[120:123], v18 offset:0
    ds_read_b128 v[124:127], v18 offset:16
    ds_read_b128 v[128:131], v18 offset:21504
    ds_read_b128 v[132:135], v18 offset:21520
    ds_read_b128 v[136:139], v18 offset:43008
    ds_read_b128 v[140:143], v18 offset:43024
    ds_read_b128 v[144:147], v18 offset:64512
    ds_read_b128 v[148:151], v18 offset:64528
    s_waitcnt lgkmcnt(5)
    v_pk_add_f32 v[120:121], v[120:121], v[128:129]
    v_pk_add_f32 v[122:123], v[122:123], v[130:131]
    s_waitcnt lgkmcnt(4)
    v_pk_add_f32 v[124:125], v[124:125], v[132:133]
    v_pk_add_f32 v[126:127], v[126:127], v[134:135]
    s_waitcnt lgkmcnt(1)
    v_pk_add_f32 v[136:137], v[136:137], v[144:145]
    v_pk_add_f32 v[138:139], v[138:139], v[146:147]
    s_waitcnt lgkmcnt(0)
    v_pk_add_f32 v[140:141], v[140:141], v[148:149]
    v_pk_add_f32 v[142:143], v[142:143], v[150:151]
    v_pk_add_f32 v[120:121], v[120:121], v[136:137]
    v_pk_add_f32 v[122:123], v[122:123], v[138:139]
    v_pk_add_f32 v[124:125], v[124:125], v[140:141]
    v_pk_add_f32 v[126:127], v[126:127], v[142:143]
    v_cvt_pk_bf16_f32 v80, v120, v121
    v_cvt_pk_bf16_f32 v81, v122, v123
    v_cvt_pk_bf16_f32 v82, v124, v125
    v_cvt_pk_bf16_f32 v83, v126, v127
    buffer_store_dwordx4 v[80:83], v21, s[40:43], s13 offen nt
    s_or_b32 s54, s2, s45
    s_cmp_lg_u32 s54, 0
    s_cselect_b32 s54, 1073741824, 0
    buffer_store_dword v11, v31, s[36:39], s54 offen
    s_endpgm
Lslow2:
    s_mov_b32 s69, 0
Lpoll1:
    s_mov_b64 exec, vcc
    s_add_u32 s54, s64, 0
    buffer_load_dwordx4 v[160:163], v4, s[36:39], s54 offen offset:0 sc1
    buffer_load_dwordx4 v[164:167], v4, s[36:39], s54 offen offset:1024 sc1
    buffer_load_dwordx4 v[168:171], v4, s[36:39], s54 offen offset:2048 sc1
    s_add_u32 s54, s65, 0
    buffer_load_dwordx4 v[176:179], v4, s[36:39], s54 offen offset:0 sc1
    buffer_load_dwordx4 v[180:183], v4, s[36:39], s54 offen offset:1024 sc1
    buffer_load_dwordx4 v[184:187], v4, s[36:39], s54 offen offset:2048 sc1
    s_waitcnt vmcnt(0)
    v_xor_b32 v5, s44, v163
    v_bitop3_b32 v5, v5, v167, s44 bitop3:0xf6
    v_bitop3_b32 v5, v5, v171, s44 bitop3:0xf6
    v_bitop3_b32 v5, v5, v179, s44 bitop3:0xf6
    v_bitop3_b32 v5, v5, v183, s44 bitop3:0xf6
    v_bitop3_b32 v5, v5, v187, s44 bitop3:0xf6
    v_cmp_ne_u32 vcc, 0, v5
    s_mov_b64 exec, -1
    s_cbranch_vccz Lgot3
    s_add_u32 s69, s69, 1
    s_cmp_lt_u32 s69, 32768
    s_cbranch_scc1 Lpoll1
    s_branch Lgot3
Lslow5:
    s_mov_b32 s69, 0
Lpoll4:
    s_mov_b64 exec, vcc
    s_mov_b32 s51, 288768
    v_lshlrev_b32 v40, 2, v2
    buffer_load_dword v40, v40, s[36:39], s51 offen sc1
    s_waitcnt vmcnt(0)
    v_cmp_ne_u32 vcc, s44, v40
    s_mov_b64 exec, -1
    s_cbranch_vccz Lgot6
    s_add_u32 s69, s69, 1
    s_cmp_lt_u32 s69, 32768
    s_cbranch_scc1 Lpoll4
    s_branch Lgot6
Lslow8:
    s_mov_b32 s69, 0
Lpoll7:
    s_mov_b64 exec, vcc
    s_add_u32 s54, s55, 0
    buffer_load_dwordx4 v[84:87], v4, s[36:39], s54 offen offset:0 sc1
    buffer_load_dwordx4 v[88:91], v4, s[36:39], s54 offen offset:1024 sc1
    buffer_load_dwordx4 v[92:95], v4, s[36:39], s54 offen offset:2048 sc1
    buffer_load_dwordx4 v[96:99], v4, s[36:39], s54 offen offset:3072 sc1
    s_add_u32 s54, s59, 0
    buffer_load_dwordx4 v[148:151], v4, s[36:39], s54 offen offset:0 sc1
    buffer_load_dwordx4 v[152:155], v4, s[36:39], s54 offen offset:1024 sc1
    buffer_load_dwordx4 v[156:159], v4, s[36:39], s54 offen offset:2048 sc1
    buffer_load_dwordx4 v[160:163], v4, s[36:39], s54 offen offset:3072 sc1
    s_waitcnt vmcnt(0)
    v_xor_b32 v5, s44, v87
    v_bitop3_b32 v5, v5, v91, s44 bitop3:0xf6
    v_bitop3_b32 v5, v5, v95, s44 bitop3:0xf6
    v_bitop3_b32 v5, v5, v99, s44 bitop3:0xf6
    v_bitop3_b32 v5, v5, v151, s44 bitop3:0xf6
    v_bitop3_b32 v5, v5, v155, s44 bitop3:0xf6
    v_bitop3_b32 v5, v5, v159, s44 bitop3:0xf6
    v_bitop3_b32 v5, v5, v163, s44 bitop3:0xf6
    v_cmp_ne_u32 vcc, 0, v5
    s_mov_b64 exec, -1
    s_cbranch_vccz Lgot9
    s_add_u32 s69, s69, 1
    s_cmp_lt_u32 s69, 32768
    s_cbranch_scc1 Lpoll7
    s_branch Lgot9
Lslow11:
    s_mov_b32 s69, 0
Lpoll10:
    s_mov_b64 exec, vcc
    s_add_u32 s54, s55, 4096
    buffer_load_dwordx4 v[100:103], v4, s[36:39], s54 offen offset:0 sc1
    buffer_load_dwordx4 v[104:107], v4, s[36:39], s54 offen offset:1024 sc1
    buffer_load_dwordx4 v[108:111], v4, s[36:39], s54 offen offset:2048 sc1
    s_add_u32 s54, s59, 4096
    buffer_load_dwordx4 v[164:167], v4, s[36:39], s54 offen offset:0 sc1
    buffer_load_dwordx4 v[168:171], v4, s[36:39], s54 offen offset:1024 sc1
    buffer_load_dwordx4 v[172:175], v4, s[36:39], s54 offen offset:2048 sc1
    s_waitcnt vmcnt(0)
    v_xor_b32 v5, s44, v103
    v_bitop3_b32 v5, v5, v107, s44 bitop3:0xf6
    v_bitop3_b32 v5, v5, v111, s44 bitop3:0xf6
    v_bitop3_b32 v5, v5, v167, s44 bitop3:0xf6
    v_bitop3_b32 v5, v5, v171, s44 bitop3:0xf6
    v_bitop3_b32 v5, v5, v175, s44 bitop3:0xf6
    v_cmp_ne_u32 vcc, 0, v5
    s_mov_b64 exec, -1
    s_cbranch_vccz Lgot12
    s_add_u32 s69, s69, 1
    s_cmp_lt_u32 s69, 32768
    s_cbranch_scc1 Lpoll10
    s_branch Lgot12
Lslow14:
    s_mov_b32 s69, 0
Lpoll13:
    s_mov_b64 exec, vcc
    v_mov_b32 v24, 0
    buffer_atomic_add v24, v22, s[36:39], 0 offen offset:16 sc0 sc1
    s_waitcnt vmcnt(0)
    v_cmp_ne_u32 vcc, s50, v24
    s_mov_b64 exec, -1
    s_cbranch_vccz Lgot15
    s_add_u32 s69, s69, 1
    s_cmp_lt_u32 s69, 32768
    s_cbranch_scc1 Lpoll13
    s_branch Lgot15
Lslow17:
    s_mov_b32 s69, 0
Lpoll16:
    s_mov_b64 exec, vcc
    v_mov_b32 v24, 0
    buffer_atomic_add v24, v26, s[36:39], s16 offen offset:0 sc0 sc1
    s_waitcnt vmcnt(0)
    v_cmp_ne_u32 vcc, s50, v24
    s_mov_b64 exec, -1
    s_cbranch_vccz Lgot18
    s_add_u32 s69, s69, 1
    s_cmp_lt_u32 s69, 32768
    s_cbranch_scc1 Lpoll16
    s_branch Lgot18
Lslow20:
    s_mov_b32 s69, 0
Lpoll19:
    s_mov_b64 exec, vcc
    v_mov_b32 v24, 0
    buffer_atomic_add v24, v22, s[36:39], 0 offen offset:16 sc0 sc1
    s_waitcnt vmcnt(0)
    v_cmp_ne_u32 vcc, s50, v24
    s_mov_b64 exec, -1
    s_cbranch_vccz Lgot21
    s_add_u32 s69, s69, 1
    s_cmp_lt_u32 s69, 32768
    s_cbranch_scc1 Lpoll19
    s_branch Lgot21
Lslow23:
    s_mov_b32 s69, 0
Lpoll22:
    s_mov_b64 exec, vcc
    v_mov_b32 v24, 0
    buffer_atomic_add v24, v23, s[36:39], s16 offen offset:0 sc0 sc1
    s_waitcnt vmcnt(0)
    v_cmp_ne_u32 vcc, s50, v24
    s_mov_b64 exec, -1
    s_cbranch_vccz Lgot24
    s_add_u32 s69, s69, 1
    s_cmp_lt_u32 s69, 32768
    s_cbranch_scc1 Lpoll22
    s_branch Lgot24
Lslow26:
    s_mov_b32 s69, 0
Lpoll25:
    s_mov_b64 exec, vcc
    v_mov_b32 v24, 0
    buffer_atomic_add v24, v23, s[36:39], s16 offen offset:4 sc0 sc1
    s_waitcnt vmcnt(0)
    v_cmp_ne_u32 vcc, s50, v24
    s_mov_b64 exec, -1
    s_cbranch_vccz Lgot27
    s_add_u32 s69, s69, 1
    s_cmp_lt_u32 s69, 32768
    s_cbranch_scc1 Lpoll25
    s_branch Lgot27
Lslow29:
    s_mov_b32 s69, 0
Lpoll28:
    s_mov_b64 exec, vcc
    v_mov_b32 v43, 0
    buffer_atomic_add v43, v155, s[36:39], s16 offen offset:12 sc0 sc1
    s_waitcnt vmcnt(0)
    v_cmp_ne_u32 vcc, s50, v43
    s_mov_b64 exec, -1
    s_cbranch_vccz Lgot30
    s_add_u32 s69, s69, 1
    s_cmp_lt_u32 s69, 32768
    s_cbranch_scc1 Lpoll28
    s_branch Lgot30
Lslow32:
    s_mov_b32 s69, 0
Lpoll31:
    s_mov_b64 exec, vcc
    v_mov_b32 v24, 0
    buffer_atomic_add v24, v23, s[36:39], s16 offen offset:8 sc0 sc1
    s_waitcnt vmcnt(0)
    v_cmp_ne_u32 vcc, s50, v24
    s_mov_b64 exec, -1
    s_cbranch_vccz Lgot33
    s_add_u32 s69, s69, 1
    s_cmp_lt_u32 s69, 32768
    s_cbranch_scc1 Lpoll31
    s_branch Lgot33
Lslow35:
    s_mov_b32 s69, 0
Lpoll34:
    s_mov_b64 exec, vcc
    v_mov_b32 v43, 0
    buffer_atomic_add v43, v31, s[36:39], s18 offen offset:0 sc0 sc1
    s_waitcnt vmcnt(0)
    v_cmp_ne_u32 vcc, s50, v43
    s_mov_b64 exec, -1
    s_cbranch_vccz Lgot36
    s_add_u32 s69, s69, 1
    s_cmp_lt_u32 s69, 32768
    s_cbranch_scc1 Lpoll34
    s_branch Lgot36
Lslow38:
    s_mov_b32 s69, 0
Lpoll37:
    s_mov_b64 exec, vcc
    v_mov_b32 v43, 0
    buffer_atomic_add v43, v31, s[36:39], s18 offen offset:4 sc0 sc1
    s_waitcnt vmcnt(0)
    v_cmp_ne_u32 vcc, s50, v43
    s_mov_b64 exec, -1
    s_cbranch_vccz Lgot39
    s_add_u32 s69, s69, 1
    s_cmp_lt_u32 s69, 32768
    s_cbranch_scc1 Lpoll37
    s_branch Lgot39
Lslow41:
    s_mov_b32 s69, 0
Lpoll40:
    s_mov_b64 exec, vcc
    v_mov_b32 v43, 0
    buffer_atomic_add v43, v31, s[36:39], s18 offen offset:8 sc0 sc1
    s_waitcnt vmcnt(0)
    v_cmp_ne_u32 vcc, s50, v43
    s_mov_b64 exec, -1
    s_cbranch_vccz Lgot42
    s_add_u32 s69, s69, 1
    s_cmp_lt_u32 s69, 32768
    s_cbranch_scc1 Lpoll40
    s_branch Lgot42
Lslow44:
    s_mov_b32 s69, 0
Lpoll43:
    s_mov_b64 exec, vcc
    v_mov_b32 v43, 0
    buffer_atomic_add v43, v31, s[36:39], s18 offen offset:12 sc0 sc1
    s_waitcnt vmcnt(0)
    v_cmp_ne_u32 vcc, s50, v43
    s_mov_b64 exec, -1
    s_cbranch_vccz Lgot45
    s_add_u32 s69, s69, 1
    s_cmp_lt_u32 s69, 32768
    s_cbranch_scc1 Lpoll43
    s_branch Lgot45
.p2align 7
.type Ltab,@object
Ltab:
.short 3072,3072,3072,0,256,512,768,128
.short 384,640,896,4,260,516,772,132
.short 388,644,900,8,264,520,776,136
.short 392,648,904,12,268,524,780,140
.short 396,652,908,16,272,528,784,144
.short 400,656,912,20,276,532,788,148
.short 404,660,916,24,280,536,792,152
.short 408,664,920,28,284,540,796,156
.short 412,668,924,32,288,544,800,160
.short 416,672,928,36,292,548,804,164
.short 420,676,932,40,296,552,808,168
.short 424,680,936,44,300,556,812,172
.short 428,684,940,48,304,560,816,176
.short 432,688,944,52,308,564,820,180
.short 436,692,948,56,312,568,824,184
.short 440,696,952,60,316,572,828,188
.short 444,700,956,64,320,576,832,192
.short 448,704,960,68,324,580,836,196
.short 452,708,964,72,328,584,840,200
.short 456,712,968,76,332,588,844,204
.short 460,716,972,80,336,592,848,208
.short 464,720,976,84,340,596,852,212
.short 468,724,980,88,344,600,856,216
.short 472,728,984,92,348,604,860,220
.short 476,732,988,96,352,608,864,224
.short 480,736,992,100,356,612,868,228
.short 484,740,996,104,360,616,872,232
.short 488,744,1000,108,364,620,876,236
.short 492,748,1004,112,368,624,880,240
.short 496,752,1008,116,372,628,884,244
.short 500,756,1012,120,376,632,888,248
.short 504,760,1016,124,380,636,892,252
.short 508,764,1020,1024,1024,1280,1536,1536
.short 1536,1792,1028,1028,1028,1284,1540,1540
.short 1540,1796,1032,1032,1032,1288,1544,1544
.short 1544,1800,1036,1036,1036,1292,1548,1548
.short 1548,1804,1040,1040,1040,1296,1552,1552
.short 1552,1808,1044,1044,1044,1300,1556,1556
.short 1556,1812,1048,1048,1048,1304,1560,1560
.short 1560,1816,1052,1052,1052,1308,1564,1564
.short 1564,1820,1056,1056,1056,1312,1568,1568
.short 1568,1824,1060,1060,1060,1316,1572,1572
.short 1572,1828,1064,1064,1064,1320,1576,1576
.short 1576,1832,1068,1068,1068,1324,1580,1580
.short 1580,1836,1072,1072,1072,1328,1584,1584
.short 1584,1840,1076,1076,1076,1332,1588,1588
.short 1588,1844,1080,1080,1080,1336,1592,1592
.short 1592,1848,1084,1084,1084,1340,1596,1596
.short 1596,1852,1088,1088,1088,1344,1600,1600
.short 1600,1856,1092,1092,1092,1348,1604,1604
.short 1604,1860,1096,1096,1096,1352,1608,1608
.short 1608,1864,1100,1100,1100,1356,1612,1612
.short 1612,1868,1104,1104,1104,1360,1616,1616
.short 1616,1872,1108,1108,1108,1364,1620,1620
.short 1620,1876,1112,1112,1112,1368,1624,1624
.short 1624,1880,1116,1116,1116,1372,1628,1628
.short 1628,1884,1120,1120,1120,1376,1632,1632
.short 1632,1888,1124,1124,1124,1380,1636,1636
.short 1636,1892,1128,1128,1128,1384,1640,1640
.short 1640,1896,1132,1132,1132,1388,1644,1644
.short 1644,1900,1136,1136,1136,1392,1648,1648
.short 1648,1904,1140,1140,1140,1396,1652,1652
.short 1652,1908,1144,1144,1144,1400,1656,1656
.short 1656,1912,1148,1148,1148,1404,1660,1660
.short 384,640,896,1660,1916,1152,1408,1156
.short 388,644,900,1408,1156,1156,1412,1160
.short 392,648,904,1412,1160,1160,1416,1164
.short 396,652,908,1416,1164,1164,1420,1168
.short 400,656,912,1420,1168,1168,1424,1172
.short 404,660,916,1424,1172,1172,1428,1176
.short 408,664,920,1428,1176,1176,1432,1180
.short 412,668,924,1432,1180,1180,1436,1184
.short 416,672,928,1436,1184,1184,1440,1188
.short 420,676,932,1440,1188,1188,1444,1192
.short 424,680,936,1444,1192,1192,1448,1196
.short 428,684,940,1448,1196,1196,1452,1200
.short 432,688,944,1452,1200,1200,1456,1204
.short 436,692,948,1456,1204,1204,1460,1208
.short 440,696,952,1460,1208,1208,1464,1212
.short 444,700,956,1464,1212,1212,1468,1216
.short 448,704,960,1468,1216,1216,1472,1220
.short 452,708,964,1472,1220,1220,1476,1224
.short 456,712,968,1476,1224,1224,1480,1228
.short 460,716,972,1480,1228,1228,1484,1232
.short 464,720,976,1484,1232,1232,1488,1236
.short 468,724,980,1488,1236,1236,1492,1240
.short 472,728,984,1492,1240,1240,1496,1244
.short 476,732,988,1496,1244,1244,1500,1248
.short 480,736,992,1500,1248,1248,1504,1252
.short 484,740,996,1504,1252,1252,1508,1256
.short 488,744,1000,1508,1256,1256,1512,1260
.short 492,748,1004,1512,1260,1260,1516,1264
.short 496,752,1008,1516,1264,1264,1520,1268
.short 500,756,1012,1520,1268,1268,1524,1272
.short 504,760,1016,1524,1272,1272,1528,1276
.short 508,764,1020,1528,1276,1276,1532,1664
.short 1536,1792,1028,1532,1664,1664,1920,1668
.short 1540,1796,1032,1920,1668,1668,1924,1672
.short 1544,1800,1036,1924,1672,1672,1928,1676
.short 1548,1804,1040,1928,1676,1676,1932,1680
.short 1552,1808,1044,1932,1680,1680,1936,1684
.short 1556,1812,1048,1936,1684,1684,1940,1688
.short 1560,1816,1052,1940,1688,1688,1944,1692
.short 1564,1820,1056,1944,1692,1692,1948,1696
.short 1568,1824,1060,1948,1696,1696,1952,1700
.short 1572,1828,1064,1952,1700,1700,1956,1704
.short 1576,1832,1068,1956,1704,1704,1960,1708
.short 1580,1836,1072,1960,1708,1708,1964,1712
.short 1584,1840,1076,1964,1712,1712,1968,1716
.short 1588,1844,1080,1968,1716,1716,1972,1720
.short 1592,1848,1084,1972,1720,1720,1976,1724
.short 1596,1852,1088,1976,1724,1724,1980,1728
.short 1600,1856,1092,1980,1728,1728,1984,1732
.short 1604,1860,1096,1984,1732,1732,1988,1736
.short 1608,1864,1100,1988,1736,1736,1992,1740
.short 1612,1868,1104,1992,1740,1740,1996,1744
.short 1616,1872,1108,1996,1744,1744,2000,1748
.short 1620,1876,1112,2000,1748,1748,2004,1752
.short 1624,1880,1116,2004,1752,1752,2008,1756
.short 1628,1884,1120,2008,1756,1756,2012,1760
.short 1632,1888,1124,2012,1760,1760,2016,1764
.short 1636,1892,1128,2016,1764,1764,2020,1768
.short 1640,1896,1132,2020,1768,1768,2024,1772
.short 1644,1900,1136,2024,1772,1772,2028,1776
.short 1648,1904,1140,2028,1776,1776,2032,1780
.short 1652,1908,1144,2032,1780,1780,2036,1784
.short 1656,1912,1148,2036,1784,1784,2040,1788
.short 1660,1916,1152,2040,1788,1788,2044,2048
.short 3072,3072,3072,3072,3072,3072,3072,3072
.short 3072,3072,3072,3072,3072,3072,3072,3072
.short 3072,3072,3072,3072,3072,3072,3072,3072
.short 3072,3072,3072,3072,3072,3072,3072,3072
.short 3072,3072,3072,3072,3072,3072,3072,3072
.short 3072,3072,3072,3072,3072,3072,3072,3072
.short 3072,3072,3072,3072,3072,3072,3072,3072
.short 3072,3072,3072,3072,3072,3072,3072,3072
.short 3072,3072,3072,3072,3072,3072,3072,3072
.short 3072,3072,3072,3072,3072,3072,3072,3072
.short 3072,3072,3072,3072,3072,3072,3072,3072
.short 3072,3072,3072,3072,3072,3072,3072,3072
.short 3072,3072,3072,3072,3072,3072,3072,3072
.short 3072,3072,3072,3072,3072,3072,3072,3072
.short 3072,3072,3072,3072,3072,3072,3072,3072
.short 3072,3072,3072,3072,3072,3072,3072,3072
.short 3072,3072,3072,3072,2048,2048,2048,2048
.short 3072,3072,3072,3072,3072,2048,2048,2048
.short 3072,3072,3072,3072,3072,3072,2048,2048
.short 3072,3072,3072,3072,3072,3072,3072,2048
.short 3072,3072,3072,3072,3072,3072,3072,3072
.short 3072,3072,3072,3072,3072,3072,3072,3072
.short 3072,3072,3072,3072,3072,3072,3072,3072
.short 3072,3072,3072,3072,3072,3072,3072,3072
.short 3072,3072,3072,3072,3072,3072,3072,3072
.short 3072,3072,3072,3072,3072,3072,3072,3072
.short 3072,3072,3072,3072,3072,3072,3072,3072
.short 3072,3072,3072,3072,3072,3072,3072,3072
.short 3072,3072,3072,3072,3072,3072,3072,3072
.short 3072,3072,3072,3072,3072,3072,3072,3072
.short 3072,3072,3072,3072,3072,3072,3072,3072
.short 3072,3072,3072,3072,3072,3072,3072,3072
.short 2048,2048,2048,2044,2044,2044,1788,1788
.short 2048,2048,2048,2048,2044,2044,2044,1788
.short 2048,2048,2048,2048,2048,2044,2044,2044
.short 2048,2048,2048,2048,2048,2048,2044,2044
.short 2048,2048,2048,2048,2048,2048,2048,2044
.short 3072,2048,2048,2048,2048,2048,2048,2048
.short 3072,3072,2048,2048,2048,2048,2048,2048
.short 3072,3072,3072,2048,2048,2048,2048,2048
.short 3072,3072,3072,3072,2048,2048,2048,2048
.short 3072,3072,3072,3072,3072,2048,2048,2048
.short 3072,3072,3072,3072,3072,3072,2048,2048
.short 3072,3072,3072,3072,3072,3072,3072,2048
.short 3072,3072,3072,3072,3072,3072,3072,3072
.short 3072,3072,3072,3072,3072,3072,3072,3072
.short 3072,3072,3072,3072,3072,3072,3072,3072
.short 3072,3072,3072,3072,3072,3072,3072,3072
.short 1788,1788,1788,2040,2040,2040,1784,1784
.short 1788,1788,1788,1788,2040,2040,2040,1784
.short 1788,1788,1788,1788,1788,2040,2040,2040
.short 2044,1788,1788,1788,1788,1788,2040,2040
.short 2044,2044,1788,1788,1788,1788,1788,2040
.short 2044,2044,2044,1788,1788,1788,1788,1788
.short 2048,2044,2044,2044,1788,1788,1788,1788
.short 2048,2048,2044,2044,2044,1788,1788,1788
.short 2048,2048,2048,2044,2044,2044,1788,1788
.short 2048,2048,2048,2048,2044,2044,2044,1788
.short 2048,2048,2048,2048,2048,2044,2044,2044
.short 2048,2048,2048,2048,2048,2048,2044,2044
.short 2048,2048,2048,2048,2048,2048,2048,2044
.short 3072,2048,2048,2048,2048,2048,2048,2048
.short 3072,3072,2048,2048,2048,2048,2048,2048
.short 3072,3072,3072,2048,2048,2048,2048,2048
.short 2052,2056,0,0,0,0,0,0
.short 2060,2064,0,0,0,0,0,0
.short 2068,2072,0,0,0,0,0,0
.short 2076,2080,0,0,0,0,0,0
.short 2084,2088,0,0,0,0,0,0
.short 2092,2096,0,0,0,0,0,0
.short 2100,2104,0,0,0,0,0,0
.short 2108,2112,0,0,0,0,0,0
.short 2116,2120,0,0,0,0,0,0
.short 2124,2128,0,0,0,0,0,0
.short 2132,2136,0,0,0,0,0,0
.short 2140,2144,0,0,0,0,0,0
.short 2148,2152,0,0,0,0,0,0
.short 2156,2160,0,0,0,0,0,0
.short 2164,2168,0,0,0,0,0,0
.short 2172,2304,0,0,0,0,0,0
.short 2308,2312,0,0,0,0,0,0
.short 2316,2320,0,0,0,0,0,0
.short 2324,2328,0,0,0,0,0,0
.short 2332,2336,0,0,0,0,0,0
.short 2340,2344,0,0,0,0,0,0
.short 2348,2352,0,0,0,0,0,0
.short 2356,2360,0,0,0,0,0,0
.short 2364,2368,0,0,0,0,0,0
.short 2372,2376,0,0,0,0,0,0
.short 2380,2384,0,0,0,0,0,0
.short 2388,2392,0,0,0,0,0,0
.short 2396,2400,0,0,0,0,0,0
.short 2404,2408,0,0,0,0,0,0
.short 2412,2416,0,0,0,0,0,0
.short 2420,2424,0,0,0,0,0,0
.short 2428,2560,0,0,0,0,0,0
.short 2564,2568,0,0,0,0,0,0
.short 2572,2576,0,0,0,0,0,0
.short 2580,2584,0,0,0,0,0,0
.short 2588,2592,0,0,0,0,0,0
.short 2596,2600,0,0,0,0,0,0
.short 2604,2608,0,0,0,0,0,0
.short 2612,2616,0,0,0,0,0,0
.short 2620,2624,0,0,0,0,0,0
.short 2628,2632,0,0,0,0,0,0
.short 2636,2640,0,0,0,0,0,0
.short 2644,2648,0,0,0,0,0,0
.short 2652,2656,0,0,0,0,0,0
.short 2660,2664,0,0,0,0,0,0
.short 2668,2672,0,0,0,0,0,0
.short 2676,2680,0,0,0,0,0,0
.short 2684,2816,0,0,0,0,0,0
.short 2820,2824,0,0,0,0,0,0
.short 2828,2832,0,0,0,0,0,0
.short 2836,2840,0,0,0,0,0,0
.short 2844,2848,0,0,0,0,0,0
.short 2852,2856,0,0,0,0,0,0
.short 2860,2864,0,0,0,0,0,0
.short 2868,2872,0,0,0,0,0,0
.short 2876,2880,0,0,0,0,0,0
.short 2884,2888,0,0,0,0,0,0
.short 2892,2896,0,0,0,0,0,0
.short 2900,2904,0,0,0,0,0,0
.short 2908,2912,0,0,0,0,0,0
.short 2916,2920,0,0,0,0,0,0
.short 2924,2928,0,0,0,0,0,0
.short 2932,2936,0,0,0,0,0,0
.short 2940,2176,0,0,0,0,0,0
.short 0,0,0,0,0,16256,16256,16256
.short 0,0,0,0,0,0,16256,16256
.short 0,0,0,0,0,0,0,16256
.short 0,0,0,0,0,0,0,0
.short 0,0,0,0,0,0,0,0
.short 0,0,0,0,0,0,0,0
.short 0,0,0,0,0,0,0,0
.short 0,0,0,0,0,0,0,0
.short 0,0,0,0,0,0,0,0
.short 0,0,0,0,0,0,0,0
.short 0,0,0,0,0,0,0,0
.short 0,0,0,0,0,0,0,0
.short 0,0,0,0,0,0,0,0
.short 0,0,0,0,0,0,0,0
.short 0,0,0,0,0,0,0,0
.short 0,0,0,0,0,0,0,0
.short 16256,16256,16256,16256,0,0,0,0
.short 16256,16256,16256,16256,16256,0,0,0
.short 16256,16256,16256,16256,16256,16256,0,0
.short 16256,16256,16256,16256,16256,16256,16256,0
.short 0,16256,16256,16256,16256,16256,16256,16256
.short 0,0,16256,16256,16256,16256,16256,16256
.short 0,0,0,16256,16256,16256,16256,16256
.short 0,0,0,0,16256,16256,16256,16256
.short 0,0,0,0,0,16256,16256,16256
.short 0,0,0,0,0,0,16256,16256
.short 0,0,0,0,0,0,0,16256
.short 0,0,0,0,0,0,0,0
.short 0,0,0,0,0,0,0,0
.short 0,0,0,0,0,0,0,0
.short 0,0,0,0,0,0,0,0
.short 0,0,0,0,0,0,0,0
.short 0,0,0,0,0,0,0,0
.short 0,0,0,0,0,0,0,0
.short 0,0,0,0,0,0,0,0
.short 0,0,0,0,0,0,0,0
.short 0,0,0,0,0,0,0,0
.short 16256,0,0,0,0,0,0,0
.short 16256,16256,0,0,0,0,0,0
.short 16256,16256,16256,0,0,0,0,0
.short 16256,16256,16256,16256,0,0,0,0
.short 16256,16256,16256,16256,16256,0,0,0
.short 16256,16256,16256,16256,16256,16256,0,0
.short 16256,16256,16256,16256,16256,16256,16256,0
.short 0,16256,16256,16256,16256,16256,16256,16256
.short 0,0,16256,16256,16256,16256,16256,16256
.short 0,0,0,16256,16256,16256,16256,16256
.short 0,0,0,0,16256,16256,16256,16256
.short 0,0,0,0,0,0,0,0
.short 0,0,0,0,0,0,0,0
.short 0,0,0,0,0,0,0,0
.short 0,0,0,0,0,0,0,0
.short 0,0,0,0,0,0,0,0
.short 0,0,0,0,0,0,0,0
.short 0,0,0,0,0,0,0,0
.short 0,0,0,0,0,0,0,0
.short 0,0,0,0,0,0,0,0
.short 0,0,0,0,0,0,0,0
.short 0,0,0,0,0,0,0,0
.short 0,0,0,0,0,0,0,0
.short 0,0,0,0,0,0,0,0
.short 16256,0,0,0,0,0,0,0
.short 16256,16256,0,0,0,0,0,0
.short 16256,16256,16256,0,0,0,0,0
.short 0,0,0,0,16256,16256,16256,16256
.short 0,0,0,0,0,16256,16256,16256
.short 0,0,0,0,0,0,16256,16256
.short 0,0,0,0,0,0,0,16256
.short 0,0,0,0,0,0,0,0
.short 0,0,0,0,0,0,0,0
.short 0,0,0,0,0,0,0,0
.short 0,0,0,0,0,0,0,0
.short 0,0,0,0,0,0,0,0
.short 0,0,0,0,0,0,0,0
.short 0,0,0,0,0,0,0,0
.short 0,0,0,0,0,0,0,0
.short 0,0,0,0,0,0,0,0
.short 0,0,0,0,0,0,0,0
.short 0,0,0,0,0,0,0,0
.short 0,0,0,0,0,0,0,0
.short 16256,16256,16256,16256,16256,0,0,0
.short 16256,16256,16256,16256,16256,16256,0,0
.short 16256,16256,16256,16256,16256,16256,16256,0
.short 16256,16256,16256,16256,16256,16256,16256,16256
.short 16256,16256,16256,16256,16256,16256,16256,16256
.short 0,16256,16256,16256,16256,16256,16256,16256
.short 0,0,16256,16256,16256,16256,16256,16256
.short 0,0,0,16256,16256,16256,16256,16256
.short 0,0,0,0,16256,16256,16256,16256
.short 0,0,0,0,0,16256,16256,16256
.short 0,0,0,0,0,0,16256,16256
.short 0,0,0,0,0,0,0,16256
.short 0,0,0,0,0,0,0,0
.short 0,0,0,0,0,0,0,0
.short 0,0,0,0,0,0,0,0
.short 0,0,0,0,0,0,0,0
.short 0,0,0,0,0,0,0,0
.short 0,0,0,0,0,0,0,0
.short 0,0,0,0,0,0,0,0
.short 0,0,0,0,0,0,0,0
.short 16256,0,0,0,0,0,0,0
.short 16256,16256,0,0,0,0,0,0
.short 16256,16256,16256,0,0,0,0,0
.short 16256,16256,16256,16256,0,0,0,0
.short 16256,16256,16256,16256,16256,0,0,0
.short 16256,16256,16256,16256,16256,16256,0,0
.short 16256,16256,16256,16256,16256,16256,16256,0
.short 16256,16256,16256,16256,16256,16256,16256,16256
.short 16256,16256,16256,16256,16256,16256,16256,16256
.short 0,16256,16256,16256,16256,16256,16256,16256
.short 0,0,16256,16256,16256,16256,16256,16256
.short 0,0,0,16256,16256,16256,16256,16256
.short 0,0,0,0,0,0,0,0
.short 0,0,0,0,0,0,0,0
.short 0,0,0,0,0,0,0,0
.short 0,0,0,0,0,0,0,0
.short 0,0,0,0,0,0,0,0
.short 0,0,0,0,0,0,0,0
.short 0,0,0,0,0,0,0,0
.short 0,0,0,0,0,0,0,0
.short 0,0,0,0,0,0,0,0
.short 0,0,0,0,0,0,0,0
.short 0,0,0,0,0,0,0,0
.short 0,0,0,0,0,0,0,0
.short 16256,0,0,0,0,0,0,0
.short 16256,16256,0,0,0,0,0,0
.short 16256,16256,16256,0,0,0,0,0
.short 16256,16256,16256,16256,0,0,0,0
.size Ltab, .-Ltab
Lcode_end:
.section .rodata,"a"
.p2align 6
.amdhsa_kernel sequential_preLN__ssm_conv_s4__swiglu_ffn__prompt_kernel
  .amdhsa_next_free_vgpr 512
  .amdhsa_next_free_sgpr 102
  .amdhsa_accum_offset 256
  .amdhsa_group_segment_fixed_size 0
  .amdhsa_kernarg_size 128
  .amdhsa_user_sgpr_count 2
  .amdhsa_user_sgpr_kernarg_segment_ptr 1
  .amdhsa_system_sgpr_workgroup_id_x 1
.end_amdhsa_kernel
```
